```python
import torch

def _softmax(x, axis=-1):
    return torch.softmax(x, dim=axis)
def _gelu(x):
    return torch.nn.functional.gelu(x, approximate="tanh")
def _silu(x):
    return torch.nn.functional.silu(x)
def _sigmoid(x):
    return torch.sigmoid(x)
def _layernorm(x, axis=-1, eps=1e-5):
    m = x.mean(dim=axis, keepdim=True)
    v = x.var(dim=axis, keepdim=True, unbiased=False)
    return (x - m) / torch.sqrt(v + eps)
def _scatter_add(tgt, idx, src, axis=0):
    return tgt.clone().index_add_(axis, idx, src)
def _segment_sum(src, seg, n):
    out = torch.zeros((n,) + src.shape[1:], dtype=src.dtype)
    return out.index_add_(0, seg, src)
def _pad(x, pw):
    flat = tuple(v for pair in reversed(pw) for v in pair)
    return torch.nn.functional.pad(x, flat)

kernel_name = 'sequential_preLN__ssm_conv_h3__glu_gated_swiglu__prompt'

def setup_inputs():

    _w = (lambda a: (lambda t: t.to(torch.bfloat16) if t.is_floating_point() else t)(torch.as_tensor(a)))
    def _A_setup():
        B, S, D = 1, 2048, 640
        ks = 4
        return {
            "q": _w((lambda *s: torch.randn(*s, dtype=torch.bfloat16) * 0.05)(B, S, D)),
            "k": _w((lambda *s: torch.randn(*s, dtype=torch.bfloat16) * 0.2)(B, S, D)),
            "v": _w((lambda *s: torch.randn(*s, dtype=torch.bfloat16) * 0.2)(B, S, D)),
            "shift_k": _w((lambda *s: torch.randn(*s, dtype=torch.bfloat16) * 0.2)(D, ks) * 0.5),
            "ssm_k": _w((lambda *s: torch.randn(*s, dtype=torch.bfloat16) * 0.4)(D, S) * (1.0 / S ** 0.5)),
            "ssm_D": _w((lambda *s: torch.randn(*s, dtype=torch.bfloat16) * 0.2)(D)),
        }
    _A_in = _A_setup()

    def _B_setup():
        B, S, D, F = 1, 2048, 640, 1728
        return {
            "x": _w((lambda *s: torch.randn(*s, dtype=torch.bfloat16) * 0.05)(B, S, D)),
            "w1": _w((lambda *s: torch.randn(*s, dtype=torch.bfloat16) * 0.2)(D, F) * (2.0 / D) ** 0.5),
            "w3": _w((lambda *s: torch.randn(*s, dtype=torch.bfloat16) * 0.2)(D, F) * (2.0 / D) ** 0.5),
            "w2": _w((lambda *s: torch.randn(*s, dtype=torch.bfloat16) * 0.2)(F, D) * (2.0 / F) ** 0.5),
        }
    _B_in = _B_setup()

    return {
        "A_q": _A_in["q"],
        "A_k": _A_in["k"],
        "A_v": _A_in["v"],
        "A_shift_k": _A_in["shift_k"],
        "A_ssm_k": _A_in["ssm_k"],
        "A_ssm_D": _A_in["ssm_D"],
        "B_x": _B_in["x"],
        "B_w1": _B_in["w1"],
        "B_w3": _B_in["w3"],
        "B_w2": _B_in["w2"],
    }

def reference(A_q, A_k, A_v, A_shift_k, A_ssm_k, A_ssm_D, B_x, B_w1, B_w3, B_w2):
    def _A_ref(q, k, v, shift_k, ssm_k, ssm_D):
        B, S, D = q.shape
        ks = shift_k.shape[-1]
        k_pad = _pad(k, ((0, 0), (ks - 1, 0), (0, 0)))
        k_shift = torch.zeros_like(k)
        for t in range(ks):
            k_shift = k_shift + k_pad[:, t:t + S, :] * shift_k[:, ks - 1 - t][None, None, :]
        kv = k_shift * v
        L = 2 * S
        kv_pad = _pad(kv, ((0, 0), (0, S), (0, 0)))
        kf_pad = _pad(ssm_k, ((0, 0), (0, S)))
        kv_f = (lambda x, axes=(-2,-1): torch.fft.rfft2(x.float(), dim=axes))(kv_pad[:, None, :, :], axes=(1, 2))
        kf_f = (lambda x, axes=(-2,-1): torch.fft.rfft2(x.float(), dim=axes))(kf_pad[:, None, :], axes=(1, 2))
        kf_f = (lambda x, *d: x.permute(*d))(kf_f, 1, 2, 0)
        y_f = kv_f * kf_f[None, :, :, :]
        y = (lambda x, s, axes=(-2,-1): torch.fft.irfft2(x, s=s, dim=axes).to(torch.bfloat16))(y_f, (1, L), axes=(1, 2))[:, 0, :S, :]
        y = y + kv * ssm_D[None, None, :]
        return q * y

    def _B_ref(x, w1, w3, w2):
        gate = torch.einsum("bsd,df->bsf", x, w1)
        up = torch.einsum("bsd,df->bsf", x, w3)
        h = _silu(gate) * up
        out = torch.einsum("bsf,fd->bsd", h, w2)
        return out

    x = A_q
    h = x + _A_ref(_layernorm(x, axis=-1), A_k, A_v, A_shift_k, A_ssm_k, A_ssm_D)
    h2 = h + _B_ref(_layernorm(h, axis=-1), B_w1, B_w3, B_w2)
    return h2
```

```asm
; @launch kernel=p0_kernel grid=(256,1,1) block=(512,1,1) lds=0
; @launch kernel=conv_kernel grid=(240,1,1) block=(512,1,1) lds=104704
; @launch kernel=g12_kernel grid=(256,1,1) block=(256,1,1) lds=163840
.amdgcn_target "amdgcn-amd-amdhsa--gfx950"
.text
.globl p0_kernel
.p2align 8
.type p0_kernel,@function
p0_kernel:
    s_cmp_ge_u32 s2, 256
    s_cbranch_scc1 p0_end
    s_load_dwordx2 s[4:5], s[0:1], 0
    s_load_dwordx2 s[8:9], s[0:1], 8
    s_load_dwordx2 s[12:13], s[0:1], 16
    s_load_dwordx2 s[16:17], s[0:1], 24
    s_load_dwordx2 s[20:21], s[0:1], 32
    s_load_dwordx2 s[24:25], s[0:1], 96
    s_and_b32 s28, s2, 7
    s_lshr_b32 s29, s2, 3
    s_lshl_b32 s30, s28, 5
    s_add_u32 s30, s30, s29
    s_mul_i32 s31, s30, 10240
    v_lshrrev_b32 v1, 6, v0
    s_nop 0
    v_readfirstlane_b32 s32, v1
    s_mov_b32 s6, 2621440
    s_mov_b32 s7, 0x00020000
    s_mov_b32 s10, 2621440
    s_mov_b32 s11, 0x00020000
    s_mov_b32 s14, 2621440
    s_mov_b32 s15, 0x00020000
    s_mov_b32 s18, 5120
    s_mov_b32 s19, 0x00020000
    s_mov_b32 s22, 2621440
    s_mov_b32 s23, 0x00020000
    s_mov_b32 s26, 12468224
    s_mov_b32 s27, 0x00020000
    s_waitcnt lgkmcnt(0)
    s_cmp_ge_u32 s32, 5
    s_cbranch_scc1 p0_other
    v_lshlrev_b32 v1, 2, v0
    v_add_u32 v1, s31, v1
    v_subrev_u32 v2, 3840, v1
    v_add_u32 v3, 5120, v1
    v_lshlrev_b32 v4, 4, v0
    buffer_load_dword v8, v2, s[8:11], 0 offen offset:0
    buffer_load_dword v9, v2, s[8:11], 0 offen offset:1280
    buffer_load_dword v10, v2, s[8:11], 0 offen offset:2560
    buffer_load_dword v11, v1, s[8:11], 0 offen offset:0
    buffer_load_dword v12, v1, s[8:11], 0 offen offset:1280
    buffer_load_dword v13, v1, s[8:11], 0 offen offset:2560
    buffer_load_dword v14, v1, s[8:11], 0 offen offset:3840
    buffer_load_dword v15, v3, s[8:11], 0 offen offset:0
    buffer_load_dword v16, v3, s[8:11], 0 offen offset:1280
    buffer_load_dword v17, v3, s[8:11], 0 offen offset:2560
    buffer_load_dword v18, v3, s[8:11], 0 offen offset:3840
    buffer_load_dwordx4 v[28:31], v4, s[16:19], 0 offen
    buffer_load_dword v19, v1, s[12:15], 0 offen offset:0
    buffer_load_dword v20, v1, s[12:15], 0 offen offset:1280
    buffer_load_dword v21, v1, s[12:15], 0 offen offset:2560
    buffer_load_dword v22, v1, s[12:15], 0 offen offset:3840
    buffer_load_dword v23, v3, s[12:15], 0 offen offset:0
    buffer_load_dword v24, v3, s[12:15], 0 offen offset:1280
    buffer_load_dword v25, v3, s[12:15], 0 offen offset:2560
    buffer_load_dword v26, v3, s[12:15], 0 offen offset:3840
    v_lshrrev_b32 v5, 2, v0
    v_lshlrev_b32 v5, 15, v5
    s_lshl_b32 s33, s30, 7
    v_add_u32 v5, s33, v5
    s_lshr_b32 s33, s30, 1
    v_and_b32 v6, 3, v0
    v_lshlrev_b32 v6, 1, v6
    v_add_u32 v6, s33, v6
    v_add_u32 v7, 1, v6
    v_and_b32 v6, 7, v6
    v_and_b32 v7, 7, v7
    v_lshlrev_b32 v6, 4, v6
    v_lshlrev_b32 v7, 4, v7
    v_add_u32 v6, v5, v6
    v_add_u32 v7, v5, v7
    s_waitcnt vmcnt(8)
    v_lshlrev_b32 v32, 16, v28
    v_lshlrev_b32 v33, 16, v30
    v_and_b32 v34, 0xffff0000, v28
    v_and_b32 v35, 0xffff0000, v30
    v_lshlrev_b32 v36, 16, v29
    v_lshlrev_b32 v37, 16, v31
    v_and_b32 v38, 0xffff0000, v29
    v_and_b32 v39, 0xffff0000, v31
    v_lshlrev_b32 v40, 16, v8
    v_and_b32 v41, 0xffff0000, v8
    v_lshlrev_b32 v42, 16, v9
    v_and_b32 v43, 0xffff0000, v9
    v_lshlrev_b32 v44, 16, v10
    v_and_b32 v45, 0xffff0000, v10
    v_lshlrev_b32 v46, 16, v11
    v_and_b32 v47, 0xffff0000, v11
    v_lshlrev_b32 v48, 16, v12
    v_and_b32 v49, 0xffff0000, v12
    v_lshlrev_b32 v50, 16, v13
    v_and_b32 v51, 0xffff0000, v13
    v_lshlrev_b32 v52, 16, v14
    v_and_b32 v53, 0xffff0000, v14
    v_lshlrev_b32 v54, 16, v15
    v_and_b32 v55, 0xffff0000, v15
    v_lshlrev_b32 v56, 16, v16
    v_and_b32 v57, 0xffff0000, v16
    v_lshlrev_b32 v58, 16, v17
    v_and_b32 v59, 0xffff0000, v17
    v_lshlrev_b32 v60, 16, v18
    v_and_b32 v61, 0xffff0000, v18
    v_pk_mul_f32 v[64:65], v[38:39], v[40:41]
    v_pk_mul_f32 v[66:67], v[38:39], v[42:43]
    v_pk_mul_f32 v[68:69], v[38:39], v[44:45]
    v_pk_mul_f32 v[70:71], v[38:39], v[46:47]
    v_pk_mul_f32 v[72:73], v[38:39], v[48:49]
    v_pk_mul_f32 v[74:75], v[38:39], v[50:51]
    v_pk_mul_f32 v[76:77], v[38:39], v[52:53]
    v_pk_mul_f32 v[78:79], v[38:39], v[54:55]
    v_pk_fma_f32 v[64:65], v[36:37], v[42:43], v[64:65]
    v_pk_fma_f32 v[66:67], v[36:37], v[44:45], v[66:67]
    v_pk_fma_f32 v[68:69], v[36:37], v[46:47], v[68:69]
    v_pk_fma_f32 v[70:71], v[36:37], v[48:49], v[70:71]
    v_pk_fma_f32 v[72:73], v[36:37], v[50:51], v[72:73]
    v_pk_fma_f32 v[74:75], v[36:37], v[52:53], v[74:75]
    v_pk_fma_f32 v[76:77], v[36:37], v[54:55], v[76:77]
    v_pk_fma_f32 v[78:79], v[36:37], v[56:57], v[78:79]
    v_pk_fma_f32 v[64:65], v[34:35], v[44:45], v[64:65]
    v_pk_fma_f32 v[66:67], v[34:35], v[46:47], v[66:67]
    v_pk_fma_f32 v[68:69], v[34:35], v[48:49], v[68:69]
    v_pk_fma_f32 v[70:71], v[34:35], v[50:51], v[70:71]
    v_pk_fma_f32 v[72:73], v[34:35], v[52:53], v[72:73]
    v_pk_fma_f32 v[74:75], v[34:35], v[54:55], v[74:75]
    v_pk_fma_f32 v[76:77], v[34:35], v[56:57], v[76:77]
    v_pk_fma_f32 v[78:79], v[34:35], v[58:59], v[78:79]
    v_pk_fma_f32 v[64:65], v[32:33], v[46:47], v[64:65]
    v_pk_fma_f32 v[66:67], v[32:33], v[48:49], v[66:67]
    v_pk_fma_f32 v[68:69], v[32:33], v[50:51], v[68:69]
    v_pk_fma_f32 v[70:71], v[32:33], v[52:53], v[70:71]
    v_pk_fma_f32 v[72:73], v[32:33], v[54:55], v[72:73]
    v_pk_fma_f32 v[74:75], v[32:33], v[56:57], v[74:75]
    v_pk_fma_f32 v[76:77], v[32:33], v[58:59], v[76:77]
    v_pk_fma_f32 v[78:79], v[32:33], v[60:61], v[78:79]
    s_waitcnt vmcnt(0)
    v_lshlrev_b32 v40, 16, v19
    v_and_b32 v41, 0xffff0000, v19
    v_lshlrev_b32 v42, 16, v20
    v_and_b32 v43, 0xffff0000, v20
    v_lshlrev_b32 v44, 16, v21
    v_and_b32 v45, 0xffff0000, v21
    v_lshlrev_b32 v46, 16, v22
    v_and_b32 v47, 0xffff0000, v22
    v_lshlrev_b32 v48, 16, v23
    v_and_b32 v49, 0xffff0000, v23
    v_lshlrev_b32 v50, 16, v24
    v_and_b32 v51, 0xffff0000, v24
    v_lshlrev_b32 v52, 16, v25
    v_and_b32 v53, 0xffff0000, v25
    v_lshlrev_b32 v54, 16, v26
    v_and_b32 v55, 0xffff0000, v26
    v_pk_mul_f32 v[64:65], v[64:65], v[40:41]
    v_pk_mul_f32 v[66:67], v[66:67], v[42:43]
    v_pk_mul_f32 v[68:69], v[68:69], v[44:45]
    v_pk_mul_f32 v[70:71], v[70:71], v[46:47]
    v_pk_mul_f32 v[72:73], v[72:73], v[48:49]
    v_pk_mul_f32 v[74:75], v[74:75], v[50:51]
    v_pk_mul_f32 v[76:77], v[76:77], v[52:53]
    v_pk_mul_f32 v[78:79], v[78:79], v[54:55]
    v_cvt_pk_bf16_f32 v80, v64, v66
    v_cvt_pk_bf16_f32 v81, v68, v70
    v_cvt_pk_bf16_f32 v82, v72, v74
    v_cvt_pk_bf16_f32 v83, v76, v78
    v_cvt_pk_bf16_f32 v84, v65, v67
    v_cvt_pk_bf16_f32 v85, v69, v71
    v_cvt_pk_bf16_f32 v86, v73, v75
    v_cvt_pk_bf16_f32 v87, v77, v79
    buffer_store_dwordx4 v[80:83], v6, s[24:27], 0 offen
    buffer_store_dwordx4 v[84:87], v7, s[24:27], 0 offen
    s_endpgm
p0_other:
    s_cmp_eq_u32 s32, 7
    s_cbranch_scc1 p0_w7
    v_subrev_u32 v1, 320, v0
    v_lshrrev_b32 v2, 4, v1
    v_mul_u32_u24 v3, 1280, v2
    v_and_b32 v4, 15, v1
    v_lshlrev_b32 v5, 4, v4
    v_add3_u32 v3, v3, v5, s31
    buffer_load_dwordx4 v[8:11], v3, s[4:7], 0 offen offset:0
    buffer_load_dwordx4 v[12:15], v3, s[4:7], 0 offen offset:256
    buffer_load_dwordx4 v[16:19], v3, s[4:7], 0 offen offset:512
    buffer_load_dwordx4 v[20:23], v3, s[4:7], 0 offen offset:768
    buffer_load_dwordx4 v[24:27], v3, s[4:7], 0 offen offset:1024
    s_lshl_b32 s33, s30, 6
    s_add_u32 s33, s33, 2621440
    v_lshlrev_b32 v2, 3, v2
    v_add_u32 v2, s33, v2
    v_mov_b32 v30, 0
    v_mov_b32 v31, 0
    s_waitcnt vmcnt(0)
    v_lshlrev_b32 v32, 16, v8
    v_and_b32 v33, 0xffff0000, v8
    v_pk_add_f32 v[30:31], v[30:31], v[32:33]
    v_lshlrev_b32 v34, 16, v9
    v_and_b32 v35, 0xffff0000, v9
    v_pk_add_f32 v[30:31], v[30:31], v[34:35]
    v_lshlrev_b32 v36, 16, v10
    v_and_b32 v37, 0xffff0000, v10
    v_pk_add_f32 v[30:31], v[30:31], v[36:37]
    v_lshlrev_b32 v38, 16, v11
    v_and_b32 v39, 0xffff0000, v11
    v_pk_add_f32 v[30:31], v[30:31], v[38:39]
    v_lshlrev_b32 v40, 16, v12
    v_and_b32 v41, 0xffff0000, v12
    v_pk_add_f32 v[30:31], v[30:31], v[40:41]
    v_lshlrev_b32 v42, 16, v13
    v_and_b32 v43, 0xffff0000, v13
    v_pk_add_f32 v[30:31], v[30:31], v[42:43]
    v_lshlrev_b32 v44, 16, v14
    v_and_b32 v45, 0xffff0000, v14
    v_pk_add_f32 v[30:31], v[30:31], v[44:45]
    v_lshlrev_b32 v46, 16, v15
    v_and_b32 v47, 0xffff0000, v15
    v_pk_add_f32 v[30:31], v[30:31], v[46:47]
    v_lshlrev_b32 v48, 16, v16
    v_and_b32 v49, 0xffff0000, v16
    v_pk_add_f32 v[30:31], v[30:31], v[48:49]
    v_lshlrev_b32 v50, 16, v17
    v_and_b32 v51, 0xffff0000, v17
    v_pk_add_f32 v[30:31], v[30:31], v[50:51]
    v_lshlrev_b32 v52, 16, v18
    v_and_b32 v53, 0xffff0000, v18
    v_pk_add_f32 v[30:31], v[30:31], v[52:53]
    v_lshlrev_b32 v54, 16, v19
    v_and_b32 v55, 0xffff0000, v19
    v_pk_add_f32 v[30:31], v[30:31], v[54:55]
    v_lshlrev_b32 v56, 16, v20
    v_and_b32 v57, 0xffff0000, v20
    v_pk_add_f32 v[30:31], v[30:31], v[56:57]
    v_lshlrev_b32 v58, 16, v21
    v_and_b32 v59, 0xffff0000, v21
    v_pk_add_f32 v[30:31], v[30:31], v[58:59]
    v_lshlrev_b32 v60, 16, v22
    v_and_b32 v61, 0xffff0000, v22
    v_pk_add_f32 v[30:31], v[30:31], v[60:61]
    v_lshlrev_b32 v62, 16, v23
    v_and_b32 v63, 0xffff0000, v23
    v_pk_add_f32 v[30:31], v[30:31], v[62:63]
    v_lshlrev_b32 v64, 16, v24
    v_and_b32 v65, 0xffff0000, v24
    v_pk_add_f32 v[30:31], v[30:31], v[64:65]
    v_lshlrev_b32 v66, 16, v25
    v_and_b32 v67, 0xffff0000, v25
    v_pk_add_f32 v[30:31], v[30:31], v[66:67]
    v_lshlrev_b32 v68, 16, v26
    v_and_b32 v69, 0xffff0000, v26
    v_pk_add_f32 v[30:31], v[30:31], v[68:69]
    v_lshlrev_b32 v70, 16, v27
    v_and_b32 v71, 0xffff0000, v27
    v_pk_add_f32 v[30:31], v[30:31], v[70:71]
    v_add_f32 v30, v30, v31
    s_nop 1
    v_add_f32_dpp v30, v30, v30 row_ror:8 row_mask:0xf bank_mask:0xf
    s_nop 1
    v_add_f32_dpp v30, v30, v30 row_ror:4 row_mask:0xf bank_mask:0xf
    s_nop 1
    v_add_f32_dpp v30, v30, v30 row_ror:2 row_mask:0xf bank_mask:0xf
    s_nop 1
    v_add_f32_dpp v30, v30, v30 row_ror:1 row_mask:0xf bank_mask:0xf
    v_mul_f32 v30, 0xbacccccd, v30
    v_mov_b32 v28, 0
    v_mov_b32 v29, 0
    v_mov_b32 v31, v30
    v_pk_add_f32 v[32:33], v[32:33], v[30:31]
    v_pk_fma_f32 v[28:29], v[32:33], v[32:33], v[28:29]
    v_pk_add_f32 v[34:35], v[34:35], v[30:31]
    v_pk_fma_f32 v[28:29], v[34:35], v[34:35], v[28:29]
    v_pk_add_f32 v[36:37], v[36:37], v[30:31]
    v_pk_fma_f32 v[28:29], v[36:37], v[36:37], v[28:29]
    v_pk_add_f32 v[38:39], v[38:39], v[30:31]
    v_pk_fma_f32 v[28:29], v[38:39], v[38:39], v[28:29]
    v_pk_add_f32 v[40:41], v[40:41], v[30:31]
    v_pk_fma_f32 v[28:29], v[40:41], v[40:41], v[28:29]
    v_pk_add_f32 v[42:43], v[42:43], v[30:31]
    v_pk_fma_f32 v[28:29], v[42:43], v[42:43], v[28:29]
    v_pk_add_f32 v[44:45], v[44:45], v[30:31]
    v_pk_fma_f32 v[28:29], v[44:45], v[44:45], v[28:29]
    v_pk_add_f32 v[46:47], v[46:47], v[30:31]
    v_pk_fma_f32 v[28:29], v[46:47], v[46:47], v[28:29]
    v_pk_add_f32 v[48:49], v[48:49], v[30:31]
    v_pk_fma_f32 v[28:29], v[48:49], v[48:49], v[28:29]
    v_pk_add_f32 v[50:51], v[50:51], v[30:31]
    v_pk_fma_f32 v[28:29], v[50:51], v[50:51], v[28:29]
    v_pk_add_f32 v[52:53], v[52:53], v[30:31]
    v_pk_fma_f32 v[28:29], v[52:53], v[52:53], v[28:29]
    v_pk_add_f32 v[54:55], v[54:55], v[30:31]
    v_pk_fma_f32 v[28:29], v[54:55], v[54:55], v[28:29]
    v_pk_add_f32 v[56:57], v[56:57], v[30:31]
    v_pk_fma_f32 v[28:29], v[56:57], v[56:57], v[28:29]
    v_pk_add_f32 v[58:59], v[58:59], v[30:31]
    v_pk_fma_f32 v[28:29], v[58:59], v[58:59], v[28:29]
    v_pk_add_f32 v[60:61], v[60:61], v[30:31]
    v_pk_fma_f32 v[28:29], v[60:61], v[60:61], v[28:29]
    v_pk_add_f32 v[62:63], v[62:63], v[30:31]
    v_pk_fma_f32 v[28:29], v[62:63], v[62:63], v[28:29]
    v_pk_add_f32 v[64:65], v[64:65], v[30:31]
    v_pk_fma_f32 v[28:29], v[64:65], v[64:65], v[28:29]
    v_pk_add_f32 v[66:67], v[66:67], v[30:31]
    v_pk_fma_f32 v[28:29], v[66:67], v[66:67], v[28:29]
    v_pk_add_f32 v[68:69], v[68:69], v[30:31]
    v_pk_fma_f32 v[28:29], v[68:69], v[68:69], v[28:29]
    v_pk_add_f32 v[70:71], v[70:71], v[30:31]
    v_pk_fma_f32 v[28:29], v[70:71], v[70:71], v[28:29]
    v_add_f32 v28, v28, v29
    s_nop 1
    v_add_f32_dpp v28, v28, v28 row_ror:8 row_mask:0xf bank_mask:0xf
    s_nop 1
    v_add_f32_dpp v28, v28, v28 row_ror:4 row_mask:0xf bank_mask:0xf
    s_nop 1
    v_add_f32_dpp v28, v28, v28 row_ror:2 row_mask:0xf bank_mask:0xf
    s_nop 1
    v_add_f32_dpp v28, v28, v28 row_ror:1 row_mask:0xf bank_mask:0xf
    v_mov_b32 v29, 0x3727c5ac
    v_fmac_f32 v29, 0x3acccccd, v28
    v_rsq_f32 v28, v29
    v_cmp_eq_u32 vcc, 0, v4
    v_mul_f32 v29, v30, v28
    s_and_saveexec_b64 s[34:35], vcc
    buffer_store_dwordx2 v[28:29], v2, s[24:27], 0 offen
    s_endpgm
p0_w7:
    v_and_b32 v1, 63, v0
    s_lshl_b32 s33, s2, 6
    s_add_u32 s33, s33, 2637824
    v_and_b32 v2, 7, v1
    v_lshlrev_b32 v2, 3, v2
    v_mov_b32 v4, 0
    v_mov_b32 v5, 0
    v_lshlrev_b32 v3, 7, v1
    buffer_load_dword v6, v3, s[20:23], s31 offen
    buffer_load_dword v7, v3, s[20:23], s31 offen offset:2048
    s_getpc_b64 s[36:37]
p0_pc:
    s_add_u32 s36, s36, conv_kernel-p0_pc
    s_addc_u32 s37, s37, 0
    v_lshl_add_u32 v10, v1, 5, s29
    v_lshlrev_b32 v10, 7, v10
    v_min_u32 v10, g_end-conv_kernel, v10
    v_mov_b32 v11, s37
    v_add_co_u32 v10, vcc, s36, v10
    v_addc_co_u32 v11, vcc, 0, v11, vcc
    global_load_dword v12, v[10:11], off
    buffer_store_dwordx2 v[4:5], v2, s[24:27], s33 offen
    s_add_u32 s34, s33, 32768
    v_mov_b32 v8, -1
    v_mov_b32 v9, -1
    buffer_store_dwordx2 v[4:5], v2, s[24:27], s34 offen
    s_add_u32 s35, s33, 16384
    buffer_store_dwordx2 v[8:9], v2, s[24:27], s35 offen
    s_waitcnt vmcnt(0)
    s_endpgm
p0_end:
    s_endpgm
.globl conv_kernel
.p2align 8
.type conv_kernel,@function
conv_kernel:
    s_cmp_ge_u32 s2, 240
    s_cbranch_scc1 conv_end
    s_load_dwordx2 s[4:5], s[0:1], 0
    s_load_dwordx2 s[20:21], s[0:1], 32
    s_load_dwordx2 s[24:25], s[0:1], 96
    s_load_dwordx2 s[8:9], s[0:1], 40
    s_load_dwordx2 s[12:13], s[0:1], 56
    s_load_dwordx2 s[16:17], s[0:1], 64
    s_and_b32 s28, s2, 7
    s_lshr_b32 s29, s2, 3
    s_mul_i32 s30, s29, 43
    s_lshr_b32 s30, s30, 7
    s_mul_i32 s31, s30, 3
    s_sub_u32 s31, s29, s31
    s_mul_i32 s28, s28, 10
    s_add_u32 s30, s30, s28
    v_lshrrev_b32 v1, 6, v0
    s_nop 0
    v_readfirstlane_b32 s32, v1
    v_and_b32 v1, 63, v0
    s_lshl_b32 s33, s30, 3
    s_add_u32 s33, s33, s32
    s_lshl_b32 s34, s33, 1
    s_and_b32 s34, s34, 0xfffffffc
    s_lshl_b32 s43, s33, 12
    s_mul_i32 s42, s32, 4224
    s_add_u32 s42, s42, 128
    s_lshl_b32 s40, s32, 10
    s_add_u32 s40, s40, 35072
    s_lshl_b32 s41, s30, 15
    v_lshlrev_b32 v37, 4, v0
    v_lshlrev_b32 v38, 4, v1
    s_mov_b32 s6, 2621440
    s_mov_b32 s7, 0x00020000
    s_mov_b32 s22, 2621440
    s_mov_b32 s23, 0x00020000
    s_mov_b32 s26, 12468224
    s_mov_b32 s27, 0x00020000
    s_mov_b32 s14, 2211840
    s_mov_b32 s15, 0x00020000
    s_mov_b32 s18, 2211840
    s_mov_b32 s19, 0x00020000
    s_waitcnt lgkmcnt(0)
    s_load_dword s44, s[8:9], s34
    s_add_u32 m0, s40, 0
    s_add_u32 s45, s41, 0
    buffer_load_dwordx4 v37, s[24:27], s45 offen lds
    s_mov_b32 m0, s42
    s_nop 0
    buffer_load_dwordx4 v38, s[20:23], s43 offen offset:0 lds
    s_add_u32 m0, s40, 8192
    s_add_u32 s45, s41, 8192
    buffer_load_dwordx4 v37, s[24:27], s45 offen lds
    s_mov_b32 m0, s42
    s_nop 0
    buffer_load_dwordx4 v38, s[20:23], s43 offen offset:1024 lds
    s_add_u32 m0, s40, 16384
    s_add_u32 s45, s41, 16384
    buffer_load_dwordx4 v37, s[24:27], s45 offen lds
    s_mov_b32 m0, s42
    s_nop 0
    buffer_load_dwordx4 v38, s[20:23], s43 offen offset:2048 lds
    s_cmp_eq_u32 s31, 0
    s_cbranch_scc1 conv_nd
    s_add_u32 m0, s40, 24576
    s_add_u32 s45, s41, 24576
    buffer_load_dwordx4 v37, s[24:27], s45 offen lds
    s_mov_b32 m0, s42
    s_nop 0
    buffer_load_dwordx4 v38, s[20:23], s43 offen offset:3072 lds
conv_nd:
    v_mov_b32 v39, 0
    v_lshlrev_b32 v10, 2, v0
    v_min_u32 v10, 1276, v10
    v_and_b32 v11, 31, v1
    v_lshlrev_b32 v11, 2, v11
    v_add_u32 v11, s42, v11
    v_subrev_u32 v11, 128, v11
    v_lshrrev_b32 v12, 4, v1
    v_bfe_u32 v13, v1, 2, 2
    v_and_b32 v14, 3, v1
    v_lshlrev_b32 v15, 5, v14
    v_lshl_add_u32 v15, v13, 3, v15
    v_lshl_add_u32 v15, v12, 6, v15
    v_add_u32 v15, s42, v15
    v_subrev_u32 v2, 96, v15
    v_sub_u32 v15, v14, v13
    v_lshlrev_b32 v15, 2, v15
    v_lshlrev_b32 v16, 5, v12
    v_sub_u32 v15, v15, v16
    v_add_u32 v16, 128, v15
    v_lshrrev_b32 v17, 3, v16
    v_lshlrev_b32 v17, 7, v17
    v_and_b32 v18, 7, v16
    v_lshl_add_u32 v17, v18, 1, v17
    v_add_u32 v17, 33792, v17
    v_lshrrev_b32 v18, 4, v16
    v_add_u32 v18, s32, v18
    v_add_u32 v19, 3, v18
    v_and_b32 v19, 7, v19
    v_lshl_add_u32 v3, v19, 4, v17
    v_add_u32 v19, 7, v18
    v_and_b32 v19, 7, v19
    v_lshl_add_u32 v5, v19, 4, v17
    v_add_u32 v16, 112, v15
    v_lshrrev_b32 v17, 3, v16
    v_lshlrev_b32 v17, 7, v17
    v_and_b32 v18, 7, v16
    v_lshl_add_u32 v17, v18, 1, v17
    v_add_u32 v17, 33792, v17
    v_lshrrev_b32 v18, 4, v16
    v_add_u32 v18, s32, v18
    v_add_u32 v19, 3, v18
    v_and_b32 v19, 7, v19
    v_lshl_add_u32 v4, v19, 4, v17
    v_add_u32 v19, 7, v18
    v_and_b32 v19, 7, v19
    v_lshl_add_u32 v6, v19, 4, v17
    v_lshrrev_b32 v17, 3, v1
    v_lshlrev_b32 v17, 7, v17
    v_and_b32 v18, 7, v1
    v_lshl_add_u32 v17, v18, 1, v17
    v_add_u32 v17, 35072, v17
    v_add_u32 v18, s32, v12
    v_add_u32 v19, 0, v18
    v_and_b32 v19, 7, v19
    v_lshl_add_u32 v7, v19, 4, v17
    v_add_u32 v19, 4, v18
    v_and_b32 v19, 7, v19
    v_lshl_add_u32 v8, v19, 4, v17
    s_sub_u32 s50, s30, s28
    s_lshl_b32 s50, s50, 3
    s_add_u32 s50, s50, s32
    s_and_b32 s51, s2, 7
    s_lshr_b32 s56, s51, 1
    s_mul_i32 s56, s56, 896
    s_mul_i32 s57, s50, 27648
    s_add_u32 s56, s56, s57
    v_lshrrev_b32 v17, 3, v1
    v_mul_u32_u24 v17, 3456, v17
    v_and_b32 v18, 7, v1
    v_min_u32 v18, 6, v18
    v_lshl_add_u32 v17, v18, 7, v17
    v_add_u32 v32, s56, v17
    v_mov_b32 v14, 0
    v_mov_b32 v15, 0
    s_waitcnt lgkmcnt(0)
    ds_write_b32 v10, v39 offset:33792
    ds_write_b32 v11, v39
    s_lshl_b32 s35, s44, 16
    s_and_b32 s44, s44, 0xffff0000
    s_bitcmp1_b32 s33, 0
    s_cselect_b32 s44, s44, s35
    s_cmp_eq_u32 s31, 1
    s_cbranch_scc1 conv_s1
    s_cmp_eq_u32 s31, 2
    s_cbranch_scc1 conv_s2
    v_add_u32 v36, 0, v0
    v_mul_u32_u24 v37, 1280, v36
    v_lshlrev_b32 v38, 3, v36
    s_lshl_b32 s45, s30, 4
    s_mov_b32 s46, 2621440
    buffer_load_dwordx2 v[22:23], v38, s[24:27], s46 offen
    s_add_u32 s46, s46, 4096
    buffer_load_dwordx2 v[28:29], v38, s[24:27], s46 offen
    s_add_u32 s46, s46, 4096
    buffer_load_dwordx2 v[34:35], v38, s[24:27], s46 offen
    s_lshl_b32 s49, s30, 4
    s_mul_i32 s45, s32, 4608
    s_add_u32 s45, s45, 67840
    v_lshlrev_b32 v9, 2, v1
    v_add_u32 v9, s45, v9
    s_waitcnt vmcnt(3)
    s_waitcnt lgkmcnt(0)
    s_barrier
    ds_read_b64_tr_b16 v[64:65], v2 offset:0
    ds_read_b64_tr_b16 v[66:67], v2 offset:32
    ds_read_b64_tr_b16 a[0:1], v3 offset:0
    ds_read_b64_tr_b16 a[2:3], v4 offset:0
    ds_read_b64_tr_b16 a[4:5], v5 offset:1024
    ds_read_b64_tr_b16 a[6:7], v6 offset:1024
    ds_read_b64_tr_b16 a[8:9], v3 offset:2048
    ds_read_b64_tr_b16 a[10:11], v4 offset:2048
    ds_read_b64_tr_b16 a[12:13], v5 offset:3072
    ds_read_b64_tr_b16 a[14:15], v6 offset:3072
    ds_read_b64_tr_b16 v[68:69], v2 offset:256
    ds_read_b64_tr_b16 v[70:71], v2 offset:288
    ds_read_b64_tr_b16 a[16:17], v3 offset:4096
    ds_read_b64_tr_b16 a[18:19], v4 offset:4096
    s_waitcnt lgkmcnt(10)
    v_mfma_f32_16x16x32_bf16 v[40:43], v[64:67], a[0:3], 0
    ds_read_b64_tr_b16 a[20:21], v5 offset:5120
    ds_read_b64_tr_b16 a[22:23], v6 offset:5120
    s_waitcnt lgkmcnt(10)
    v_mfma_f32_16x16x32_bf16 v[44:47], v[64:67], a[4:7], 0
    ds_read_u16_d16_hi v14, v7 offset:0
    s_waitcnt lgkmcnt(9)
    v_mfma_f32_16x16x32_bf16 v[48:51], v[64:67], a[8:11], 0
    s_add_u32 s49, s49, 0
    buffer_load_dwordx4 v[18:21], v37, s[4:7], s49 offen
    v_add_f32_dpp v10, v39, v42 wave_ror:1 row_mask:0xf bank_mask:0xf
    v_add_f32_dpp v11, v39, v41 wave_ror:1 row_mask:0xf bank_mask:0xf
    s_waitcnt lgkmcnt(7)
    v_mfma_f32_16x16x32_bf16 v[52:55], v[64:67], a[12:15], 0
    v_add_f32_dpp v16, v39, v40 wave_ror:1 row_mask:0xf bank_mask:0xf
    v_add_f32_dpp v10, v43, v42 wave_shr:1 row_mask:0xf bank_mask:0xf
    ds_read_b64_tr_b16 v[72:73], v2 offset:512
    ds_read_b64_tr_b16 v[74:75], v2 offset:544
    s_waitcnt lgkmcnt(7)
    v_mfma_f32_16x16x32_bf16 v[48:51], v[68:71], a[0:3], v[48:51]
    v_add_f32_dpp v11, v10, v41 wave_shr:1 row_mask:0xf bank_mask:0xf
    v_mfma_f32_16x16x32_bf16 v[52:55], v[68:71], a[4:7], v[52:55]
    ds_read_b64_tr_b16 a[24:25], v3 offset:6144
    ds_read_b64_tr_b16 a[26:27], v4 offset:6144
    s_waitcnt lgkmcnt(7)
    v_mfma_f32_16x16x32_bf16 v[56:59], v[64:67], a[16:19], 0
    v_add_f32_dpp v16, v11, v40 wave_shr:1 row_mask:0xf bank_mask:0xf
    ds_read_b64_tr_b16 a[28:29], v5 offset:7168
    ds_read_b64_tr_b16 a[30:31], v6 offset:7168
    s_waitcnt lgkmcnt(6)
    v_fmac_f32 v16, s44, v14
    ds_write_b32 v9, v16 offset:0
    v_mfma_f32_16x16x32_bf16 v[60:63], v[64:67], a[20:23], 0
    ds_read_u16_d16_hi v15, v8 offset:1024
    v_mfma_f32_16x16x32_bf16 v[56:59], v[68:71], a[8:11], v[56:59]
    v_add_f32_dpp v12, v43, v46 wave_ror:1 row_mask:0xf bank_mask:0xf
    v_add_f32_dpp v13, v10, v45 wave_ror:1 row_mask:0xf bank_mask:0xf
    v_add_f32_dpp v17, v11, v44 wave_ror:1 row_mask:0xf bank_mask:0xf
    v_mfma_f32_16x16x32_bf16 v[60:63], v[68:71], a[12:15], v[60:63]
    v_add_f32_dpp v12, v47, v46 wave_shr:1 row_mask:0xf bank_mask:0xf
    s_waitcnt lgkmcnt(6)
    v_mfma_f32_16x16x32_bf16 v[56:59], v[72:75], a[0:3], v[56:59]
    v_add_f32_dpp v13, v12, v45 wave_shr:1 row_mask:0xf bank_mask:0xf
    v_mfma_f32_16x16x32_bf16 v[60:63], v[72:75], a[4:7], v[60:63]
    ds_read_b64_tr_b16 v[76:77], v2 offset:768
    ds_read_b64_tr_b16 v[78:79], v2 offset:800
    v_add_f32_dpp v17, v13, v44 wave_shr:1 row_mask:0xf bank_mask:0xf
    s_waitcnt lgkmcnt(2)
    v_fmac_f32 v17, s44, v15
    ds_write_b32 v9, v17 offset:256
    v_mfma_f32_16x16x32_bf16 v[40:43], v[64:67], a[24:27], 0
    s_add_u32 s49, s49, 655360
    buffer_load_dwordx4 v[24:27], v37, s[4:7], s49 offen
    ds_read_u16_d16_hi v14, v7 offset:2048
    v_add_f32_dpp v10, v47, v50 wave_ror:1 row_mask:0xf bank_mask:0xf
    v_add_f32_dpp v11, v12, v49 wave_ror:1 row_mask:0xf bank_mask:0xf
    v_add_f32_dpp v16, v13, v48 wave_ror:1 row_mask:0xf bank_mask:0xf
    v_add_f32_dpp v10, v51, v50 wave_shr:1 row_mask:0xf bank_mask:0xf
    s_nop 1
    v_add_f32_dpp v11, v10, v49 wave_shr:1 row_mask:0xf bank_mask:0xf
    s_nop 1
    v_add_f32_dpp v16, v11, v48 wave_shr:1 row_mask:0xf bank_mask:0xf
    s_waitcnt lgkmcnt(0)
    v_fmac_f32 v16, s44, v14
    ds_write_b32 v9, v16 offset:512
    v_mfma_f32_16x16x32_bf16 v[44:47], v[64:67], a[28:31], 0
    ds_read_u16_d16_hi v15, v8 offset:3072
    v_add_f32_dpp v12, v51, v54 wave_ror:1 row_mask:0xf bank_mask:0xf
    v_add_f32_dpp v13, v10, v53 wave_ror:1 row_mask:0xf bank_mask:0xf
    ds_read_b64_tr_b16 a[32:33], v3 offset:8192
    ds_read_b64_tr_b16 a[34:35], v4 offset:8192
    v_mfma_f32_16x16x32_bf16 v[40:43], v[68:71], a[16:19], v[40:43]
    v_add_f32_dpp v17, v11, v52 wave_ror:1 row_mask:0xf bank_mask:0xf
    ds_read_b64_tr_b16 a[36:37], v5 offset:9216
    ds_read_b64_tr_b16 a[38:39], v6 offset:9216
    v_mfma_f32_16x16x32_bf16 v[44:47], v[68:71], a[20:23], v[44:47]
    v_add_f32_dpp v12, v55, v54 wave_shr:1 row_mask:0xf bank_mask:0xf
    v_mfma_f32_16x16x32_bf16 v[40:43], v[72:75], a[8:11], v[40:43]
    v_mfma_f32_16x16x32_bf16 v[44:47], v[72:75], a[12:15], v[44:47]
    v_add_f32_dpp v13, v12, v53 wave_shr:1 row_mask:0xf bank_mask:0xf
    v_mfma_f32_16x16x32_bf16 v[40:43], v[76:79], a[0:3], v[40:43]
    v_mfma_f32_16x16x32_bf16 v[44:47], v[76:79], a[4:7], v[44:47]
    v_add_f32_dpp v17, v13, v52 wave_shr:1 row_mask:0xf bank_mask:0xf
    s_waitcnt lgkmcnt(4)
    v_fmac_f32 v17, s44, v15
    ds_write_b32 v9, v17 offset:768
    s_waitcnt lgkmcnt(3)
    v_mfma_f32_16x16x32_bf16 v[48:51], v[64:67], a[32:35], 0
    ds_read_u16_d16_hi v14, v7 offset:4096
    v_add_f32_dpp v10, v55, v58 wave_ror:1 row_mask:0xf bank_mask:0xf
    v_add_f32_dpp v11, v12, v57 wave_ror:1 row_mask:0xf bank_mask:0xf
    v_add_f32_dpp v16, v13, v56 wave_ror:1 row_mask:0xf bank_mask:0xf
    v_add_f32_dpp v10, v59, v58 wave_shr:1 row_mask:0xf bank_mask:0xf
    s_nop 1
    v_add_f32_dpp v11, v10, v57 wave_shr:1 row_mask:0xf bank_mask:0xf
    s_nop 1
    v_add_f32_dpp v16, v11, v56 wave_shr:1 row_mask:0xf bank_mask:0xf
    s_waitcnt lgkmcnt(0)
    v_fmac_f32 v16, s44, v14
    ds_write_b32 v9, v16 offset:1024
    v_mfma_f32_16x16x32_bf16 v[52:55], v[64:67], a[36:39], 0
    ds_read_u16_d16_hi v15, v8 offset:5120
    v_add_f32_dpp v12, v59, v62 wave_ror:1 row_mask:0xf bank_mask:0xf
    v_add_f32_dpp v13, v10, v61 wave_ror:1 row_mask:0xf bank_mask:0xf
    ds_read_b64_tr_b16 v[80:81], v2 offset:1024
    ds_read_b64_tr_b16 v[82:83], v2 offset:1056
    v_mfma_f32_16x16x32_bf16 v[48:51], v[68:71], a[24:27], v[48:51]
    s_add_u32 s49, s49, 655360
    buffer_load_dwordx4 v[30:33], v37, s[4:7], s49 offen
    v_mfma_f32_16x16x32_bf16 v[52:55], v[68:71], a[28:31], v[52:55]
    v_add_f32_dpp v17, v11, v60 wave_ror:1 row_mask:0xf bank_mask:0xf
    v_add_f32_dpp v12, v63, v62 wave_shr:1 row_mask:0xf bank_mask:0xf
    ds_read_b64_tr_b16 a[40:41], v3 offset:10240
    ds_read_b64_tr_b16 a[42:43], v4 offset:10240
    v_mfma_f32_16x16x32_bf16 v[48:51], v[72:75], a[16:19], v[48:51]
    v_add_f32_dpp v13, v12, v61 wave_shr:1 row_mask:0xf bank_mask:0xf
    ds_read_b64_tr_b16 a[44:45], v5 offset:11264
    ds_read_b64_tr_b16 a[46:47], v6 offset:11264
    v_mfma_f32_16x16x32_bf16 v[52:55], v[72:75], a[20:23], v[52:55]
    v_add_f32_dpp v17, v13, v60 wave_shr:1 row_mask:0xf bank_mask:0xf
    v_mfma_f32_16x16x32_bf16 v[48:51], v[76:79], a[8:11], v[48:51]
    s_waitcnt lgkmcnt(6)
    v_fmac_f32 v17, s44, v15
    ds_write_b32 v9, v17 offset:1280
    ds_read_u16_d16_hi v14, v7 offset:6144
    v_mfma_f32_16x16x32_bf16 v[52:55], v[76:79], a[12:15], v[52:55]
    v_add_f32_dpp v10, v63, v42 wave_ror:1 row_mask:0xf bank_mask:0xf
    v_add_f32_dpp v11, v12, v41 wave_ror:1 row_mask:0xf bank_mask:0xf
    v_add_f32_dpp v16, v13, v40 wave_ror:1 row_mask:0xf bank_mask:0xf
    s_waitcnt lgkmcnt(6)
    v_mfma_f32_16x16x32_bf16 v[48:51], v[80:83], a[0:3], v[48:51]
    v_add_f32_dpp v10, v43, v42 wave_shr:1 row_mask:0xf bank_mask:0xf
    v_mfma_f32_16x16x32_bf16 v[52:55], v[80:83], a[4:7], v[52:55]
    s_waitcnt lgkmcnt(4)
    v_mfma_f32_16x16x32_bf16 v[56:59], v[64:67], a[40:43], 0
    v_add_f32_dpp v11, v10, v41 wave_shr:1 row_mask:0xf bank_mask:0xf
    s_nop 1
    v_add_f32_dpp v16, v11, v40 wave_shr:1 row_mask:0xf bank_mask:0xf
    s_waitcnt lgkmcnt(0)
    v_fmac_f32 v16, s44, v14
    ds_write_b32 v9, v16 offset:1536
    v_mfma_f32_16x16x32_bf16 v[60:63], v[64:67], a[44:47], 0
    ds_read_u16_d16_hi v15, v8 offset:7168
    v_add_f32_dpp v12, v43, v46 wave_ror:1 row_mask:0xf bank_mask:0xf
    v_add_f32_dpp v13, v10, v45 wave_ror:1 row_mask:0xf bank_mask:0xf
    v_mfma_f32_16x16x32_bf16 v[56:59], v[68:71], a[32:35], v[56:59]
    v_add_f32_dpp v17, v11, v44 wave_ror:1 row_mask:0xf bank_mask:0xf
    v_add_f32_dpp v12, v47, v46 wave_shr:1 row_mask:0xf bank_mask:0xf
    v_mfma_f32_16x16x32_bf16 v[60:63], v[68:71], a[36:39], v[60:63]
    ds_read_b64_tr_b16 v[84:85], v2 offset:1280
    ds_read_b64_tr_b16 v[86:87], v2 offset:1312
    v_mfma_f32_16x16x32_bf16 v[56:59], v[72:75], a[24:27], v[56:59]
    v_add_f32_dpp v13, v12, v45 wave_shr:1 row_mask:0xf bank_mask:0xf
    v_mfma_f32_16x16x32_bf16 v[60:63], v[72:75], a[28:31], v[60:63]
    ds_read_b64_tr_b16 a[48:49], v3 offset:12288
    ds_read_b64_tr_b16 a[50:51], v4 offset:12288
    v_mfma_f32_16x16x32_bf16 v[56:59], v[76:79], a[16:19], v[56:59]
    v_add_f32_dpp v17, v13, v44 wave_shr:1 row_mask:0xf bank_mask:0xf
    ds_read_b64_tr_b16 a[52:53], v5 offset:13312
    ds_read_b64_tr_b16 a[54:55], v6 offset:13312
    v_mfma_f32_16x16x32_bf16 v[60:63], v[76:79], a[20:23], v[60:63]
    s_waitcnt lgkmcnt(6)
    v_fmac_f32 v17, s44, v15
    v_mfma_f32_16x16x32_bf16 v[56:59], v[80:83], a[8:11], v[56:59]
    ds_write_b32 v9, v17 offset:1792
    ds_read_u16_d16_hi v14, v7 offset:8192
    v_add_f32_dpp v10, v47, v50 wave_ror:1 row_mask:0xf bank_mask:0xf
    v_mfma_f32_16x16x32_bf16 v[60:63], v[80:83], a[12:15], v[60:63]
    v_add_f32_dpp v11, v12, v49 wave_ror:1 row_mask:0xf bank_mask:0xf
    v_add_f32_dpp v16, v13, v48 wave_ror:1 row_mask:0xf bank_mask:0xf
    v_add_f32_dpp v10, v51, v50 wave_shr:1 row_mask:0xf bank_mask:0xf
    s_waitcnt lgkmcnt(6)
    v_mfma_f32_16x16x32_bf16 v[56:59], v[84:87], a[0:3], v[56:59]
    v_add_f32_dpp v11, v10, v49 wave_shr:1 row_mask:0xf bank_mask:0xf
    v_mfma_f32_16x16x32_bf16 v[60:63], v[84:87], a[4:7], v[60:63]
    s_waitcnt lgkmcnt(4)
    v_mfma_f32_16x16x32_bf16 v[40:43], v[64:67], a[48:51], 0
    v_add_f32_dpp v16, v11, v48 wave_shr:1 row_mask:0xf bank_mask:0xf
    s_waitcnt lgkmcnt(0)
    v_fmac_f32 v16, s44, v14
    ds_write_b32 v9, v16 offset:2048
    v_mfma_f32_16x16x32_bf16 v[44:47], v[64:67], a[52:55], 0
    ds_read_u16_d16_hi v15, v8 offset:9216
    v_add_f32_dpp v12, v51, v54 wave_ror:1 row_mask:0xf bank_mask:0xf
    v_add_f32_dpp v13, v10, v53 wave_ror:1 row_mask:0xf bank_mask:0xf
    v_mfma_f32_16x16x32_bf16 v[40:43], v[68:71], a[40:43], v[40:43]
    v_add_f32_dpp v17, v11, v52 wave_ror:1 row_mask:0xf bank_mask:0xf
    v_add_f32_dpp v12, v55, v54 wave_shr:1 row_mask:0xf bank_mask:0xf
    v_mfma_f32_16x16x32_bf16 v[44:47], v[68:71], a[44:47], v[44:47]
    v_mfma_f32_16x16x32_bf16 v[40:43], v[72:75], a[32:35], v[40:43]
    v_add_f32_dpp v13, v12, v53 wave_shr:1 row_mask:0xf bank_mask:0xf
    v_mfma_f32_16x16x32_bf16 v[44:47], v[72:75], a[36:39], v[44:47]
    ds_read_b64_tr_b16 v[88:89], v2 offset:1536
    ds_read_b64_tr_b16 v[90:91], v2 offset:1568
    v_mfma_f32_16x16x32_bf16 v[40:43], v[76:79], a[24:27], v[40:43]
    v_add_f32_dpp v17, v13, v52 wave_shr:1 row_mask:0xf bank_mask:0xf
    v_mfma_f32_16x16x32_bf16 v[44:47], v[76:79], a[28:31], v[44:47]
    s_waitcnt lgkmcnt(2)
    v_fmac_f32 v17, s44, v15
    ds_write_b32 v9, v17 offset:2304
    ds_read_u16_d16_hi v14, v7 offset:10240
    ds_read_b64_tr_b16 a[56:57], v3 offset:14336
    ds_read_b64_tr_b16 a[58:59], v4 offset:14336
    v_mfma_f32_16x16x32_bf16 v[40:43], v[80:83], a[16:19], v[40:43]
    v_add_f32_dpp v10, v55, v58 wave_ror:1 row_mask:0xf bank_mask:0xf
    ds_read_b64_tr_b16 a[60:61], v5 offset:15360
    ds_read_b64_tr_b16 a[62:63], v6 offset:15360
    v_mfma_f32_16x16x32_bf16 v[44:47], v[80:83], a[20:23], v[44:47]
    v_add_f32_dpp v11, v12, v57 wave_ror:1 row_mask:0xf bank_mask:0xf
    v_mfma_f32_16x16x32_bf16 v[40:43], v[84:87], a[8:11], v[40:43]
    v_add_f32_dpp v16, v13, v56 wave_ror:1 row_mask:0xf bank_mask:0xf
    v_add_f32_dpp v10, v59, v58 wave_shr:1 row_mask:0xf bank_mask:0xf
    v_mfma_f32_16x16x32_bf16 v[44:47], v[84:87], a[12:15], v[44:47]
    s_waitcnt lgkmcnt(6)
    v_mfma_f32_16x16x32_bf16 v[40:43], v[88:91], a[0:3], v[40:43]
    v_add_f32_dpp v11, v10, v57 wave_shr:1 row_mask:0xf bank_mask:0xf
    v_mfma_f32_16x16x32_bf16 v[44:47], v[88:91], a[4:7], v[44:47]
    s_waitcnt lgkmcnt(2)
    v_mfma_f32_16x16x32_bf16 v[48:51], v[64:67], a[56:59], 0
    v_add_f32_dpp v16, v11, v56 wave_shr:1 row_mask:0xf bank_mask:0xf
    v_fmac_f32 v16, s44, v14
    ds_write_b32 v9, v16 offset:2560
    s_waitcnt lgkmcnt(1)
    v_mfma_f32_16x16x32_bf16 v[52:55], v[64:67], a[60:63], 0
    ds_read_u16_d16_hi v15, v8 offset:11264
    v_add_f32_dpp v12, v59, v62 wave_ror:1 row_mask:0xf bank_mask:0xf
    v_add_f32_dpp v13, v10, v61 wave_ror:1 row_mask:0xf bank_mask:0xf
    v_mfma_f32_16x16x32_bf16 v[48:51], v[68:71], a[48:51], v[48:51]
    v_add_f32_dpp v17, v11, v60 wave_ror:1 row_mask:0xf bank_mask:0xf
    v_add_f32_dpp v12, v63, v62 wave_shr:1 row_mask:0xf bank_mask:0xf
    v_mfma_f32_16x16x32_bf16 v[52:55], v[68:71], a[52:55], v[52:55]
    v_mfma_f32_16x16x32_bf16 v[48:51], v[72:75], a[40:43], v[48:51]
    v_add_f32_dpp v13, v12, v61 wave_shr:1 row_mask:0xf bank_mask:0xf
    v_mfma_f32_16x16x32_bf16 v[52:55], v[72:75], a[44:47], v[52:55]
    v_mfma_f32_16x16x32_bf16 v[48:51], v[76:79], a[32:35], v[48:51]
    v_add_f32_dpp v17, v13, v60 wave_shr:1 row_mask:0xf bank_mask:0xf
    s_waitcnt lgkmcnt(0)
    v_fmac_f32 v17, s44, v15
    ds_write_b32 v9, v17 offset:2816
    v_mfma_f32_16x16x32_bf16 v[52:55], v[76:79], a[36:39], v[52:55]
    ds_read_u16_d16_hi v14, v7 offset:12288
    v_add_f32_dpp v10, v63, v42 wave_ror:1 row_mask:0xf bank_mask:0xf
    v_add_f32_dpp v11, v12, v41 wave_ror:1 row_mask:0xf bank_mask:0xf
    ds_read_b64_tr_b16 v[92:93], v2 offset:1792
    ds_read_b64_tr_b16 v[94:95], v2 offset:1824
    v_mfma_f32_16x16x32_bf16 v[48:51], v[80:83], a[24:27], v[48:51]
    v_add_f32_dpp v16, v13, v40 wave_ror:1 row_mask:0xf bank_mask:0xf
    v_mfma_f32_16x16x32_bf16 v[52:55], v[80:83], a[28:31], v[52:55]
    v_add_f32_dpp v10, v43, v42 wave_shr:1 row_mask:0xf bank_mask:0xf
    ds_read_b64_tr_b16 a[64:65], v3 offset:16384
    ds_read_b64_tr_b16 a[66:67], v4 offset:16384
    v_mfma_f32_16x16x32_bf16 v[48:51], v[84:87], a[16:19], v[48:51]
    v_add_f32_dpp v11, v10, v41 wave_shr:1 row_mask:0xf bank_mask:0xf
    ds_read_b64_tr_b16 a[68:69], v5 offset:17408
    ds_read_b64_tr_b16 a[70:71], v6 offset:17408
    v_mfma_f32_16x16x32_bf16 v[52:55], v[84:87], a[20:23], v[52:55]
    v_add_f32_dpp v16, v11, v40 wave_shr:1 row_mask:0xf bank_mask:0xf
    v_mfma_f32_16x16x32_bf16 v[48:51], v[88:91], a[8:11], v[48:51]
    s_waitcnt lgkmcnt(6)
    v_fmac_f32 v16, s44, v14
    ds_write_b32 v9, v16 offset:3072
    ds_read_u16_d16_hi v15, v8 offset:13312
    v_mfma_f32_16x16x32_bf16 v[52:55], v[88:91], a[12:15], v[52:55]
    v_add_f32_dpp v12, v43, v46 wave_ror:1 row_mask:0xf bank_mask:0xf
    v_add_f32_dpp v13, v10, v45 wave_ror:1 row_mask:0xf bank_mask:0xf
    v_add_f32_dpp v17, v11, v44 wave_ror:1 row_mask:0xf bank_mask:0xf
    s_waitcnt lgkmcnt(6)
    v_mfma_f32_16x16x32_bf16 v[48:51], v[92:95], a[0:3], v[48:51]
    v_add_f32_dpp v12, v47, v46 wave_shr:1 row_mask:0xf bank_mask:0xf
    v_mfma_f32_16x16x32_bf16 v[52:55], v[92:95], a[4:7], v[52:55]
    s_waitcnt lgkmcnt(4)
    v_mfma_f32_16x16x32_bf16 v[56:59], v[64:67], a[64:67], 0
    v_add_f32_dpp v13, v12, v45 wave_shr:1 row_mask:0xf bank_mask:0xf
    s_waitcnt lgkmcnt(2)
    v_mfma_f32_16x16x32_bf16 v[60:63], v[64:67], a[68:71], 0
    v_add_f32_dpp v17, v13, v44 wave_shr:1 row_mask:0xf bank_mask:0xf
    s_waitcnt lgkmcnt(0)
    v_fmac_f32 v17, s44, v15
    ds_write_b32 v9, v17 offset:3328
    v_mfma_f32_16x16x32_bf16 v[56:59], v[68:71], a[56:59], v[56:59]
    ds_read_u16_d16_hi v14, v7 offset:14336
    v_add_f32_dpp v10, v47, v50 wave_ror:1 row_mask:0xf bank_mask:0xf
    v_add_f32_dpp v11, v12, v49 wave_ror:1 row_mask:0xf bank_mask:0xf
    v_mfma_f32_16x16x32_bf16 v[60:63], v[68:71], a[60:63], v[60:63]
    v_add_f32_dpp v16, v13, v48 wave_ror:1 row_mask:0xf bank_mask:0xf
    v_add_f32_dpp v10, v51, v50 wave_shr:1 row_mask:0xf bank_mask:0xf
    v_mfma_f32_16x16x32_bf16 v[56:59], v[72:75], a[48:51], v[56:59]
    v_mfma_f32_16x16x32_bf16 v[60:63], v[72:75], a[52:55], v[60:63]
    v_add_f32_dpp v11, v10, v49 wave_shr:1 row_mask:0xf bank_mask:0xf
    v_mfma_f32_16x16x32_bf16 v[56:59], v[76:79], a[40:43], v[56:59]
    v_mfma_f32_16x16x32_bf16 v[60:63], v[76:79], a[44:47], v[60:63]
    v_add_f32_dpp v16, v11, v48 wave_shr:1 row_mask:0xf bank_mask:0xf
    s_waitcnt lgkmcnt(0)
    v_fmac_f32 v16, s44, v14
    ds_write_b32 v9, v16 offset:3584
    v_mfma_f32_16x16x32_bf16 v[56:59], v[80:83], a[32:35], v[56:59]
    ds_read_u16_d16_hi v15, v8 offset:15360
    v_add_f32_dpp v12, v51, v54 wave_ror:1 row_mask:0xf bank_mask:0xf
    v_add_f32_dpp v13, v10, v53 wave_ror:1 row_mask:0xf bank_mask:0xf
    v_mfma_f32_16x16x32_bf16 v[60:63], v[80:83], a[36:39], v[60:63]
    v_add_f32_dpp v17, v11, v52 wave_ror:1 row_mask:0xf bank_mask:0xf
    v_add_f32_dpp v12, v55, v54 wave_shr:1 row_mask:0xf bank_mask:0xf
    ds_read_b64_tr_b16 v[96:97], v2 offset:2048
    ds_read_b64_tr_b16 v[98:99], v2 offset:2080
    v_mfma_f32_16x16x32_bf16 v[56:59], v[84:87], a[24:27], v[56:59]
    v_add_f32_dpp v13, v12, v53 wave_shr:1 row_mask:0xf bank_mask:0xf
    v_mfma_f32_16x16x32_bf16 v[60:63], v[84:87], a[28:31], v[60:63]
    v_mfma_f32_16x16x32_bf16 v[56:59], v[88:91], a[16:19], v[56:59]
    v_add_f32_dpp v17, v13, v52 wave_shr:1 row_mask:0xf bank_mask:0xf
    s_waitcnt lgkmcnt(2)
    v_fmac_f32 v17, s44, v15
    ds_write_b32 v9, v17 offset:3840
    v_mfma_f32_16x16x32_bf16 v[60:63], v[88:91], a[20:23], v[60:63]
    v_mfma_f32_16x16x32_bf16 v[56:59], v[92:95], a[8:11], v[56:59]
    v_mfma_f32_16x16x32_bf16 v[60:63], v[92:95], a[12:15], v[60:63]
    s_waitcnt lgkmcnt(1)
    v_mfma_f32_16x16x32_bf16 v[56:59], v[96:99], a[0:3], v[56:59]
    ds_read_u16_d16_hi v14, v7 offset:16384
    v_mfma_f32_16x16x32_bf16 v[60:63], v[96:99], a[4:7], v[60:63]
    s_nop 5
    v_add_f32_dpp v10, v55, v58 wave_ror:1 row_mask:0xf bank_mask:0xf
    v_add_f32_dpp v11, v12, v57 wave_ror:1 row_mask:0xf bank_mask:0xf
    v_add_f32_dpp v16, v13, v56 wave_ror:1 row_mask:0xf bank_mask:0xf
    s_nop 1
    v_add_f32_dpp v10, v59, v58 wave_shr:1 row_mask:0xf bank_mask:0xf
    s_nop 1
    v_add_f32_dpp v11, v10, v57 wave_shr:1 row_mask:0xf bank_mask:0xf
    s_nop 1
    v_add_f32_dpp v16, v11, v56 wave_shr:1 row_mask:0xf bank_mask:0xf
    s_waitcnt lgkmcnt(0)
    v_fmac_f32 v16, s44, v14
    ds_write_b32 v9, v16 offset:4096
    ds_read_u16_d16_hi v15, v8 offset:17408
    v_add_f32_dpp v12, v59, v62 wave_ror:1 row_mask:0xf bank_mask:0xf
    v_add_f32_dpp v13, v10, v61 wave_ror:1 row_mask:0xf bank_mask:0xf
    v_add_f32_dpp v17, v11, v60 wave_ror:1 row_mask:0xf bank_mask:0xf
    v_add_f32_dpp v12, v63, v62 wave_shr:1 row_mask:0xf bank_mask:0xf
    s_nop 1
    v_add_f32_dpp v13, v12, v61 wave_shr:1 row_mask:0xf bank_mask:0xf
    s_nop 1
    v_add_f32_dpp v17, v13, v60 wave_shr:1 row_mask:0xf bank_mask:0xf
    s_waitcnt lgkmcnt(0)
    v_fmac_f32 v17, s44, v15
    ds_write_b32 v9, v17 offset:4352
    v_lshlrev_b32 v36, 2, v0
    v_add_u32 v36, 67840, v36
    v_lshlrev_b32 v37, 4, v0
    v_lshlrev_b32 v38, 3, v0
    s_lshl_b32 s45, s30, 15
    s_add_u32 s45, s45, 2768896
    s_waitcnt lgkmcnt(0)
    s_barrier
    ds_read_b32 v40, v36 offset:0
    ds_read_b32 v41, v36 offset:4608
    ds_read_b32 v42, v36 offset:9216
    ds_read_b32 v43, v36 offset:13824
    ds_read_b32 v44, v36 offset:18432
    ds_read_b32 v45, v36 offset:23040
    ds_read_b32 v46, v36 offset:27648
    ds_read_b32 v47, v36 offset:32256
    s_waitcnt vmcnt(2)
    v_lshlrev_b32 v48, 16, v18
    v_and_b32 v49, 0xffff0000, v18
    v_lshlrev_b32 v50, 16, v19
    v_and_b32 v51, 0xffff0000, v19
    v_lshlrev_b32 v52, 16, v20
    v_and_b32 v53, 0xffff0000, v20
    v_lshlrev_b32 v54, 16, v21
    v_and_b32 v55, 0xffff0000, v21
    v_pk_fma_f32 v[56:57], v[48:49], v[22:23], v[22:23] op_sel:[0,0,1] op_sel_hi:[1,0,1]
    v_pk_fma_f32 v[58:59], v[50:51], v[22:23], v[22:23] op_sel:[0,0,1] op_sel_hi:[1,0,1]
    v_pk_fma_f32 v[60:61], v[52:53], v[22:23], v[22:23] op_sel:[0,0,1] op_sel_hi:[1,0,1]
    v_pk_fma_f32 v[62:63], v[54:55], v[22:23], v[22:23] op_sel:[0,0,1] op_sel_hi:[1,0,1]
    s_waitcnt lgkmcnt(0)
    v_pk_fma_f32 v[56:57], v[56:57], v[40:41], v[48:49]
    v_pk_fma_f32 v[58:59], v[58:59], v[42:43], v[50:51]
    v_pk_fma_f32 v[60:61], v[60:61], v[44:45], v[52:53]
    v_pk_fma_f32 v[62:63], v[62:63], v[46:47], v[54:55]
    v_cvt_pk_bf16_f32 v64, v56, v57
    v_cvt_pk_bf16_f32 v65, v58, v59
    v_cvt_pk_bf16_f32 v66, v60, v61
    v_cvt_pk_bf16_f32 v67, v62, v63
    buffer_store_dwordx4 v[64:67], v37, s[24:27], s45 offen
    s_add_u32 s45, s45, 8192
    ds_read_b32 v40, v36 offset:2048
    ds_read_b32 v41, v36 offset:6656
    ds_read_b32 v42, v36 offset:11264
    ds_read_b32 v43, v36 offset:15872
    ds_read_b32 v44, v36 offset:20480
    ds_read_b32 v45, v36 offset:25088
    ds_read_b32 v46, v36 offset:29696
    ds_read_b32 v47, v36 offset:34304
    s_waitcnt vmcnt(2)
    v_lshlrev_b32 v48, 16, v24
    v_and_b32 v49, 0xffff0000, v24
    v_lshlrev_b32 v50, 16, v25
    v_and_b32 v51, 0xffff0000, v25
    v_lshlrev_b32 v52, 16, v26
    v_and_b32 v53, 0xffff0000, v26
    v_lshlrev_b32 v54, 16, v27
    v_and_b32 v55, 0xffff0000, v27
    v_pk_fma_f32 v[56:57], v[48:49], v[28:29], v[28:29] op_sel:[0,0,1] op_sel_hi:[1,0,1]
    v_pk_fma_f32 v[58:59], v[50:51], v[28:29], v[28:29] op_sel:[0,0,1] op_sel_hi:[1,0,1]
    v_pk_fma_f32 v[60:61], v[52:53], v[28:29], v[28:29] op_sel:[0,0,1] op_sel_hi:[1,0,1]
    v_pk_fma_f32 v[62:63], v[54:55], v[28:29], v[28:29] op_sel:[0,0,1] op_sel_hi:[1,0,1]
    s_waitcnt lgkmcnt(0)
    v_pk_fma_f32 v[56:57], v[56:57], v[40:41], v[48:49]
    v_pk_fma_f32 v[58:59], v[58:59], v[42:43], v[50:51]
    v_pk_fma_f32 v[60:61], v[60:61], v[44:45], v[52:53]
    v_pk_fma_f32 v[62:63], v[62:63], v[46:47], v[54:55]
    v_cvt_pk_bf16_f32 v72, v56, v57
    v_cvt_pk_bf16_f32 v73, v58, v59
    v_cvt_pk_bf16_f32 v74, v60, v61
    v_cvt_pk_bf16_f32 v75, v62, v63
    buffer_store_dwordx4 v[72:75], v37, s[24:27], s45 offen
    s_add_u32 s45, s45, 8192
    s_cmp_ge_u32 s32, 2
    s_cbranch_scc1 conv_e0
    ds_read_b32 v40, v36 offset:4096
    ds_read_b32 v41, v36 offset:8704
    ds_read_b32 v42, v36 offset:13312
    ds_read_b32 v43, v36 offset:17920
    ds_read_b32 v44, v36 offset:22528
    ds_read_b32 v45, v36 offset:27136
    ds_read_b32 v46, v36 offset:31744
    ds_read_b32 v47, v36 offset:36352
    s_waitcnt vmcnt(2)
    v_lshlrev_b32 v48, 16, v30
    v_and_b32 v49, 0xffff0000, v30
    v_lshlrev_b32 v50, 16, v31
    v_and_b32 v51, 0xffff0000, v31
    v_lshlrev_b32 v52, 16, v32
    v_and_b32 v53, 0xffff0000, v32
    v_lshlrev_b32 v54, 16, v33
    v_and_b32 v55, 0xffff0000, v33
    v_pk_fma_f32 v[56:57], v[48:49], v[34:35], v[34:35] op_sel:[0,0,1] op_sel_hi:[1,0,1]
    v_pk_fma_f32 v[58:59], v[50:51], v[34:35], v[34:35] op_sel:[0,0,1] op_sel_hi:[1,0,1]
    v_pk_fma_f32 v[60:61], v[52:53], v[34:35], v[34:35] op_sel:[0,0,1] op_sel_hi:[1,0,1]
    v_pk_fma_f32 v[62:63], v[54:55], v[34:35], v[34:35] op_sel:[0,0,1] op_sel_hi:[1,0,1]
    s_waitcnt lgkmcnt(0)
    v_pk_fma_f32 v[56:57], v[56:57], v[40:41], v[48:49]
    v_pk_fma_f32 v[58:59], v[58:59], v[42:43], v[50:51]
    v_pk_fma_f32 v[60:61], v[60:61], v[44:45], v[52:53]
    v_pk_fma_f32 v[62:63], v[62:63], v[46:47], v[54:55]
    v_cvt_pk_bf16_f32 v80, v56, v57
    v_cvt_pk_bf16_f32 v81, v58, v59
    v_cvt_pk_bf16_f32 v82, v60, v61
    v_cvt_pk_bf16_f32 v83, v62, v63
    buffer_store_dwordx4 v[80:83], v37, s[24:27], s45 offen
conv_e0:
    s_endpgm
conv_s1:
    v_add_u32 v36, 1152, v0
    v_mul_u32_u24 v37, 1280, v36
    v_lshlrev_b32 v38, 3, v36
    s_lshl_b32 s45, s30, 4
    s_mov_b32 s46, 2621440
    buffer_load_dwordx2 v[22:23], v38, s[24:27], s46 offen
    s_lshl_b32 s49, s30, 4
    s_mul_i32 s45, s32, 2048
    s_add_u32 s45, s45, 67840
    v_lshlrev_b32 v9, 2, v1
    v_add_u32 v9, s45, v9
    s_waitcnt vmcnt(1)
    s_waitcnt lgkmcnt(0)
    s_barrier
    ds_read_b64_tr_b16 v[64:65], v2 offset:0
    ds_read_b64_tr_b16 v[66:67], v2 offset:32
    ds_read_b64_tr_b16 a[68:69], v5 offset:17408
    ds_read_b64_tr_b16 a[70:71], v6 offset:17408
    ds_read_b64_tr_b16 a[72:73], v3 offset:18432
    ds_read_b64_tr_b16 a[74:75], v4 offset:18432
    ds_read_b64_tr_b16 a[76:77], v5 offset:19456
    ds_read_b64_tr_b16 a[78:79], v6 offset:19456
    ds_read_b64_tr_b16 a[80:81], v3 offset:20480
    ds_read_b64_tr_b16 a[82:83], v4 offset:20480
    ds_read_b64_tr_b16 v[68:69], v2 offset:256
    ds_read_b64_tr_b16 v[70:71], v2 offset:288
    ds_read_b64_tr_b16 a[60:61], v5 offset:15360
    ds_read_b64_tr_b16 a[62:63], v6 offset:15360
    s_waitcnt lgkmcnt(10)
    v_mfma_f32_16x16x32_bf16 v[60:63], v[64:67], a[68:71], 0
    ds_read_b64_tr_b16 a[64:65], v3 offset:16384
    ds_read_b64_tr_b16 a[66:67], v4 offset:16384
    s_waitcnt lgkmcnt(10)
    v_mfma_f32_16x16x32_bf16 v[40:43], v[64:67], a[72:75], 0
    ds_read_b64_tr_b16 v[72:73], v2 offset:512
    ds_read_b64_tr_b16 v[74:75], v2 offset:544
    s_waitcnt lgkmcnt(10)
    v_mfma_f32_16x16x32_bf16 v[44:47], v[64:67], a[76:79], 0
    s_add_u32 s49, s49, 0
    buffer_load_dwordx4 v[18:21], v37, s[4:7], s49 offen
    ds_read_b64_tr_b16 a[52:53], v5 offset:13312
    ds_read_b64_tr_b16 a[54:55], v6 offset:13312
    s_waitcnt lgkmcnt(10)
    v_mfma_f32_16x16x32_bf16 v[48:51], v[64:67], a[80:83], 0
    ds_read_b64_tr_b16 a[56:57], v3 offset:14336
    ds_read_b64_tr_b16 a[58:59], v4 offset:14336
    s_waitcnt lgkmcnt(8)
    v_mfma_f32_16x16x32_bf16 v[60:63], v[68:71], a[60:63], v[60:63]
    s_waitcnt lgkmcnt(6)
    v_mfma_f32_16x16x32_bf16 v[40:43], v[68:71], a[64:67], v[40:43]
    ds_read_b64_tr_b16 v[76:77], v2 offset:768
    ds_read_b64_tr_b16 v[78:79], v2 offset:800
    v_mfma_f32_16x16x32_bf16 v[44:47], v[68:71], a[68:71], v[44:47]
    ds_read_b64_tr_b16 a[44:45], v5 offset:11264
    ds_read_b64_tr_b16 a[46:47], v6 offset:11264
    v_mfma_f32_16x16x32_bf16 v[48:51], v[68:71], a[72:75], v[48:51]
    ds_read_b64_tr_b16 a[48:49], v3 offset:12288
    ds_read_b64_tr_b16 a[50:51], v4 offset:12288
    s_waitcnt lgkmcnt(8)
    v_mfma_f32_16x16x32_bf16 v[60:63], v[72:75], a[52:55], v[60:63]
    s_waitcnt lgkmcnt(6)
    v_mfma_f32_16x16x32_bf16 v[40:43], v[72:75], a[56:59], v[40:43]
    ds_read_b64_tr_b16 v[80:81], v2 offset:1024
    ds_read_b64_tr_b16 v[82:83], v2 offset:1056
    v_mfma_f32_16x16x32_bf16 v[44:47], v[72:75], a[60:63], v[44:47]
    ds_read_b64_tr_b16 a[36:37], v5 offset:9216
    ds_read_b64_tr_b16 a[38:39], v6 offset:9216
    v_mfma_f32_16x16x32_bf16 v[48:51], v[72:75], a[64:67], v[48:51]
    ds_read_b64_tr_b16 a[40:41], v3 offset:10240
    ds_read_b64_tr_b16 a[42:43], v4 offset:10240
    s_waitcnt lgkmcnt(8)
    v_mfma_f32_16x16x32_bf16 v[60:63], v[76:79], a[44:47], v[60:63]
    buffer_load_dword v30, v32, s[12:15], 0 offen
    s_waitcnt lgkmcnt(6)
    v_mfma_f32_16x16x32_bf16 v[40:43], v[76:79], a[48:51], v[40:43]
    ds_read_b64_tr_b16 v[84:85], v2 offset:1280
    ds_read_b64_tr_b16 v[86:87], v2 offset:1312
    v_mfma_f32_16x16x32_bf16 v[44:47], v[76:79], a[52:55], v[44:47]
    ds_read_b64_tr_b16 a[28:29], v5 offset:7168
    ds_read_b64_tr_b16 a[30:31], v6 offset:7168
    v_mfma_f32_16x16x32_bf16 v[48:51], v[76:79], a[56:59], v[48:51]
    ds_read_b64_tr_b16 a[32:33], v3 offset:8192
    ds_read_b64_tr_b16 a[34:35], v4 offset:8192
    s_waitcnt lgkmcnt(8)
    v_mfma_f32_16x16x32_bf16 v[60:63], v[80:83], a[36:39], v[60:63]
    s_waitcnt lgkmcnt(6)
    v_mfma_f32_16x16x32_bf16 v[40:43], v[80:83], a[40:43], v[40:43]
    ds_read_b64_tr_b16 v[88:89], v2 offset:1536
    ds_read_b64_tr_b16 v[90:91], v2 offset:1568
    v_mfma_f32_16x16x32_bf16 v[44:47], v[80:83], a[44:47], v[44:47]
    ds_read_b64_tr_b16 a[20:21], v5 offset:5120
    ds_read_b64_tr_b16 a[22:23], v6 offset:5120
    v_mfma_f32_16x16x32_bf16 v[48:51], v[80:83], a[48:51], v[48:51]
    ds_read_b64_tr_b16 a[24:25], v3 offset:6144
    ds_read_b64_tr_b16 a[26:27], v4 offset:6144
    s_waitcnt lgkmcnt(8)
    v_mfma_f32_16x16x32_bf16 v[60:63], v[84:87], a[28:31], v[60:63]
    s_waitcnt lgkmcnt(6)
    v_mfma_f32_16x16x32_bf16 v[40:43], v[84:87], a[32:35], v[40:43]
    ds_read_b64_tr_b16 v[92:93], v2 offset:1792
    ds_read_b64_tr_b16 v[94:95], v2 offset:1824
    v_mfma_f32_16x16x32_bf16 v[44:47], v[84:87], a[36:39], v[44:47]
    ds_read_b64_tr_b16 a[12:13], v5 offset:3072
    ds_read_b64_tr_b16 a[14:15], v6 offset:3072
    v_mfma_f32_16x16x32_bf16 v[48:51], v[84:87], a[40:43], v[48:51]
    ds_read_b64_tr_b16 a[16:17], v3 offset:4096
    ds_read_b64_tr_b16 a[18:19], v4 offset:4096
    s_waitcnt lgkmcnt(8)
    v_mfma_f32_16x16x32_bf16 v[60:63], v[88:91], a[20:23], v[60:63]
    s_waitcnt lgkmcnt(6)
    v_mfma_f32_16x16x32_bf16 v[40:43], v[88:91], a[24:27], v[40:43]
    ds_read_b64_tr_b16 v[96:97], v2 offset:2048
    ds_read_b64_tr_b16 v[98:99], v2 offset:2080
    v_mfma_f32_16x16x32_bf16 v[44:47], v[88:91], a[28:31], v[44:47]
    ds_read_b64_tr_b16 a[4:5], v5 offset:1024
    ds_read_b64_tr_b16 a[6:7], v6 offset:1024
    v_mfma_f32_16x16x32_bf16 v[48:51], v[88:91], a[32:35], v[48:51]
    ds_read_b64_tr_b16 a[8:9], v3 offset:2048
    ds_read_b64_tr_b16 a[10:11], v4 offset:2048
    s_waitcnt lgkmcnt(8)
    v_mfma_f32_16x16x32_bf16 v[60:63], v[92:95], a[12:15], v[60:63]
    s_waitcnt lgkmcnt(6)
    v_mfma_f32_16x16x32_bf16 v[40:43], v[92:95], a[16:19], v[40:43]
    ds_read_b64_tr_b16 v[100:101], v2 offset:2304
    ds_read_b64_tr_b16 v[102:103], v2 offset:2336
    v_mfma_f32_16x16x32_bf16 v[44:47], v[92:95], a[20:23], v[44:47]
    ds_read_b64_tr_b16 a[0:1], v3 offset:0
    ds_read_b64_tr_b16 a[2:3], v4 offset:0
    v_mfma_f32_16x16x32_bf16 v[48:51], v[92:95], a[24:27], v[48:51]
    s_waitcnt lgkmcnt(6)
    v_mfma_f32_16x16x32_bf16 v[60:63], v[96:99], a[4:7], v[60:63]
    ds_read_b64_tr_b16 v[104:105], v2 offset:2560
    ds_read_b64_tr_b16 v[106:107], v2 offset:2592
    s_waitcnt lgkmcnt(6)
    v_mfma_f32_16x16x32_bf16 v[40:43], v[96:99], a[8:11], v[40:43]
    ds_read_b64_tr_b16 a[84:85], v5 offset:21504
    ds_read_b64_tr_b16 a[86:87], v6 offset:21504
    v_mfma_f32_16x16x32_bf16 v[44:47], v[96:99], a[12:15], v[44:47]
    ds_read_b64_tr_b16 a[88:89], v3 offset:22528
    ds_read_b64_tr_b16 a[90:91], v4 offset:22528
    v_mfma_f32_16x16x32_bf16 v[48:51], v[96:99], a[16:19], v[48:51]
    s_waitcnt lgkmcnt(6)
    v_mfma_f32_16x16x32_bf16 v[40:43], v[100:103], a[0:3], v[40:43]
    v_add_f32_dpp v12, v63, v62 wave_shr:1 row_mask:0xf bank_mask:0xf
    v_mfma_f32_16x16x32_bf16 v[44:47], v[100:103], a[4:7], v[44:47]
    v_mfma_f32_16x16x32_bf16 v[48:51], v[100:103], a[8:11], v[48:51]
    v_add_f32_dpp v13, v12, v61 wave_shr:1 row_mask:0xf bank_mask:0xf
    ds_read_u16_d16_hi v14, v7 offset:18432
    s_waitcnt lgkmcnt(5)
    v_mfma_f32_16x16x32_bf16 v[48:51], v[104:107], a[0:3], v[48:51]
    s_waitcnt lgkmcnt(3)
    v_mfma_f32_16x16x32_bf16 v[52:55], v[64:67], a[84:87], 0
    v_add_f32_dpp v10, v63, v42 wave_ror:1 row_mask:0xf bank_mask:0xf
    v_add_f32_dpp v11, v12, v41 wave_ror:1 row_mask:0xf bank_mask:0xf
    s_waitcnt lgkmcnt(1)
    v_mfma_f32_16x16x32_bf16 v[56:59], v[64:67], a[88:91], 0
    v_add_f32_dpp v16, v13, v40 wave_ror:1 row_mask:0xf bank_mask:0xf
    v_add_f32_dpp v10, v43, v42 wave_shr:1 row_mask:0xf bank_mask:0xf
    v_mfma_f32_16x16x32_bf16 v[52:55], v[68:71], a[76:79], v[52:55]
    v_mfma_f32_16x16x32_bf16 v[56:59], v[68:71], a[80:83], v[56:59]
    v_add_f32_dpp v11, v10, v41 wave_shr:1 row_mask:0xf bank_mask:0xf
    v_mfma_f32_16x16x32_bf16 v[52:55], v[72:75], a[68:71], v[52:55]
    v_mfma_f32_16x16x32_bf16 v[56:59], v[72:75], a[72:75], v[56:59]
    v_add_f32_dpp v16, v11, v40 wave_shr:1 row_mask:0xf bank_mask:0xf
    s_waitcnt lgkmcnt(0)
    v_fmac_f32 v16, s44, v14
    v_mfma_f32_16x16x32_bf16 v[52:55], v[76:79], a[60:63], v[52:55]
    ds_write_b32 v9, v16 offset:0
    ds_read_u16_d16_hi v15, v8 offset:19456
    v_mfma_f32_16x16x32_bf16 v[56:59], v[76:79], a[64:67], v[56:59]
    v_add_f32_dpp v12, v43, v46 wave_ror:1 row_mask:0xf bank_mask:0xf
    v_add_f32_dpp v13, v10, v45 wave_ror:1 row_mask:0xf bank_mask:0xf
    v_mfma_f32_16x16x32_bf16 v[52:55], v[80:83], a[52:55], v[52:55]
    v_add_f32_dpp v17, v11, v44 wave_ror:1 row_mask:0xf bank_mask:0xf
    v_add_f32_dpp v12, v47, v46 wave_shr:1 row_mask:0xf bank_mask:0xf
    v_mfma_f32_16x16x32_bf16 v[56:59], v[80:83], a[56:59], v[56:59]
    v_mfma_f32_16x16x32_bf16 v[52:55], v[84:87], a[44:47], v[52:55]
    v_add_f32_dpp v13, v12, v45 wave_shr:1 row_mask:0xf bank_mask:0xf
    v_mfma_f32_16x16x32_bf16 v[56:59], v[84:87], a[48:51], v[56:59]
    v_mfma_f32_16x16x32_bf16 v[52:55], v[88:91], a[36:39], v[52:55]
    v_add_f32_dpp v17, v13, v44 wave_shr:1 row_mask:0xf bank_mask:0xf
    s_waitcnt lgkmcnt(0)
    v_fmac_f32 v17, s44, v15
    v_mfma_f32_16x16x32_bf16 v[56:59], v[88:91], a[40:43], v[56:59]
    ds_write_b32 v9, v17 offset:256
    ds_read_u16_d16_hi v14, v7 offset:20480
    v_mfma_f32_16x16x32_bf16 v[52:55], v[92:95], a[28:31], v[52:55]
    v_add_f32_dpp v10, v47, v50 wave_ror:1 row_mask:0xf bank_mask:0xf
    v_add_f32_dpp v11, v12, v49 wave_ror:1 row_mask:0xf bank_mask:0xf
    v_mfma_f32_16x16x32_bf16 v[56:59], v[92:95], a[32:35], v[56:59]
    v_add_f32_dpp v16, v13, v48 wave_ror:1 row_mask:0xf bank_mask:0xf
    v_add_f32_dpp v10, v51, v50 wave_shr:1 row_mask:0xf bank_mask:0xf
    ds_read_b64_tr_b16 v[108:109], v2 offset:2816
    ds_read_b64_tr_b16 v[110:111], v2 offset:2848
    v_mfma_f32_16x16x32_bf16 v[52:55], v[96:99], a[20:23], v[52:55]
    ds_read_b64_tr_b16 a[92:93], v5 offset:23552
    ds_read_b64_tr_b16 a[94:95], v6 offset:23552
    v_mfma_f32_16x16x32_bf16 v[56:59], v[96:99], a[24:27], v[56:59]
    ds_read_b64_tr_b16 a[96:97], v3 offset:24576
    ds_read_b64_tr_b16 a[98:99], v4 offset:24576
    v_mfma_f32_16x16x32_bf16 v[52:55], v[100:103], a[12:15], v[52:55]
    ds_read_b64_tr_b16 a[100:101], v5 offset:25600
    ds_read_b64_tr_b16 a[102:103], v6 offset:25600
    v_mfma_f32_16x16x32_bf16 v[56:59], v[100:103], a[16:19], v[56:59]
    v_mfma_f32_16x16x32_bf16 v[52:55], v[104:107], a[4:7], v[52:55]
    v_add_f32_dpp v11, v10, v49 wave_shr:1 row_mask:0xf bank_mask:0xf
    v_mfma_f32_16x16x32_bf16 v[56:59], v[104:107], a[8:11], v[56:59]
    s_waitcnt lgkmcnt(6)
    v_mfma_f32_16x16x32_bf16 v[56:59], v[108:111], a[0:3], v[56:59]
    v_add_f32_dpp v16, v11, v48 wave_shr:1 row_mask:0xf bank_mask:0xf
    v_fmac_f32 v16, s44, v14
    s_waitcnt lgkmcnt(4)
    v_mfma_f32_16x16x32_bf16 v[60:63], v[64:67], a[92:95], 0
    ds_write_b32 v9, v16 offset:512
    ds_read_u16_d16_hi v15, v8 offset:21504
    s_waitcnt lgkmcnt(4)
    v_mfma_f32_16x16x32_bf16 v[40:43], v[64:67], a[96:99], 0
    v_add_f32_dpp v12, v51, v54 wave_ror:1 row_mask:0xf bank_mask:0xf
    v_add_f32_dpp v13, v10, v53 wave_ror:1 row_mask:0xf bank_mask:0xf
    s_waitcnt lgkmcnt(2)
    v_mfma_f32_16x16x32_bf16 v[44:47], v[64:67], a[100:103], 0
    v_add_f32_dpp v17, v11, v52 wave_ror:1 row_mask:0xf bank_mask:0xf
    v_add_f32_dpp v12, v55, v54 wave_shr:1 row_mask:0xf bank_mask:0xf
    v_mfma_f32_16x16x32_bf16 v[60:63], v[68:71], a[84:87], v[60:63]
    v_mfma_f32_16x16x32_bf16 v[40:43], v[68:71], a[88:91], v[40:43]
    v_add_f32_dpp v13, v12, v53 wave_shr:1 row_mask:0xf bank_mask:0xf
    v_mfma_f32_16x16x32_bf16 v[44:47], v[68:71], a[92:95], v[44:47]
    v_mfma_f32_16x16x32_bf16 v[60:63], v[72:75], a[76:79], v[60:63]
    v_add_f32_dpp v17, v13, v52 wave_shr:1 row_mask:0xf bank_mask:0xf
    s_waitcnt lgkmcnt(0)
    v_fmac_f32 v17, s44, v15
    v_mfma_f32_16x16x32_bf16 v[40:43], v[72:75], a[80:83], v[40:43]
    ds_write_b32 v9, v17 offset:768
    ds_read_u16_d16_hi v14, v7 offset:22528
    v_mfma_f32_16x16x32_bf16 v[44:47], v[72:75], a[84:87], v[44:47]
    v_add_f32_dpp v10, v55, v58 wave_ror:1 row_mask:0xf bank_mask:0xf
    v_add_f32_dpp v11, v12, v57 wave_ror:1 row_mask:0xf bank_mask:0xf
    v_mfma_f32_16x16x32_bf16 v[60:63], v[76:79], a[68:71], v[60:63]
    v_add_f32_dpp v16, v13, v56 wave_ror:1 row_mask:0xf bank_mask:0xf
    v_add_f32_dpp v10, v59, v58 wave_shr:1 row_mask:0xf bank_mask:0xf
    v_mfma_f32_16x16x32_bf16 v[40:43], v[76:79], a[72:75], v[40:43]
    v_mfma_f32_16x16x32_bf16 v[44:47], v[76:79], a[76:79], v[44:47]
    v_add_f32_dpp v11, v10, v57 wave_shr:1 row_mask:0xf bank_mask:0xf
    v_mfma_f32_16x16x32_bf16 v[60:63], v[80:83], a[60:63], v[60:63]
    v_mfma_f32_16x16x32_bf16 v[40:43], v[80:83], a[64:67], v[40:43]
    v_add_f32_dpp v16, v11, v56 wave_shr:1 row_mask:0xf bank_mask:0xf
    s_waitcnt lgkmcnt(0)
    v_fmac_f32 v16, s44, v14
    v_mfma_f32_16x16x32_bf16 v[44:47], v[80:83], a[68:71], v[44:47]
    ds_write_b32 v9, v16 offset:1024
    v_mfma_f32_16x16x32_bf16 v[60:63], v[84:87], a[52:55], v[60:63]
    v_mfma_f32_16x16x32_bf16 v[40:43], v[84:87], a[56:59], v[40:43]
    v_mfma_f32_16x16x32_bf16 v[44:47], v[84:87], a[60:63], v[44:47]
    v_mfma_f32_16x16x32_bf16 v[60:63], v[88:91], a[44:47], v[60:63]
    v_mfma_f32_16x16x32_bf16 v[40:43], v[88:91], a[48:51], v[40:43]
    v_mfma_f32_16x16x32_bf16 v[44:47], v[88:91], a[52:55], v[44:47]
    v_mfma_f32_16x16x32_bf16 v[60:63], v[92:95], a[36:39], v[60:63]
    v_mfma_f32_16x16x32_bf16 v[40:43], v[92:95], a[40:43], v[40:43]
    v_mfma_f32_16x16x32_bf16 v[44:47], v[92:95], a[44:47], v[44:47]
    v_mfma_f32_16x16x32_bf16 v[60:63], v[96:99], a[28:31], v[60:63]
    v_mfma_f32_16x16x32_bf16 v[40:43], v[96:99], a[32:35], v[40:43]
    v_mfma_f32_16x16x32_bf16 v[44:47], v[96:99], a[36:39], v[44:47]
    v_mfma_f32_16x16x32_bf16 v[60:63], v[100:103], a[20:23], v[60:63]
    v_mfma_f32_16x16x32_bf16 v[40:43], v[100:103], a[24:27], v[40:43]
    v_mfma_f32_16x16x32_bf16 v[44:47], v[100:103], a[28:31], v[44:47]
    ds_read_b64_tr_b16 v[112:113], v2 offset:3072
    ds_read_b64_tr_b16 v[114:115], v2 offset:3104
    v_mfma_f32_16x16x32_bf16 v[60:63], v[104:107], a[12:15], v[60:63]
    v_mfma_f32_16x16x32_bf16 v[40:43], v[104:107], a[16:19], v[40:43]
    v_mfma_f32_16x16x32_bf16 v[44:47], v[104:107], a[20:23], v[44:47]
    v_mfma_f32_16x16x32_bf16 v[60:63], v[108:111], a[4:7], v[60:63]
    ds_read_u16_d16_hi v15, v8 offset:23552
    v_mfma_f32_16x16x32_bf16 v[40:43], v[108:111], a[8:11], v[40:43]
    v_mfma_f32_16x16x32_bf16 v[44:47], v[108:111], a[12:15], v[44:47]
    s_waitcnt lgkmcnt(1)
    v_mfma_f32_16x16x32_bf16 v[40:43], v[112:115], a[0:3], v[40:43]
    v_mfma_f32_16x16x32_bf16 v[44:47], v[112:115], a[4:7], v[44:47]
    s_nop 1
    v_add_f32_dpp v12, v59, v62 wave_ror:1 row_mask:0xf bank_mask:0xf
    v_add_f32_dpp v13, v10, v61 wave_ror:1 row_mask:0xf bank_mask:0xf
    v_add_f32_dpp v17, v11, v60 wave_ror:1 row_mask:0xf bank_mask:0xf
    v_add_f32_dpp v12, v63, v62 wave_shr:1 row_mask:0xf bank_mask:0xf
    s_nop 1
    v_add_f32_dpp v13, v12, v61 wave_shr:1 row_mask:0xf bank_mask:0xf
    s_nop 1
    v_add_f32_dpp v17, v13, v60 wave_shr:1 row_mask:0xf bank_mask:0xf
    s_waitcnt lgkmcnt(0)
    v_fmac_f32 v17, s44, v15
    ds_write_b32 v9, v17 offset:1280
    ds_read_u16_d16_hi v14, v7 offset:24576
    v_add_f32_dpp v10, v63, v42 wave_ror:1 row_mask:0xf bank_mask:0xf
    v_add_f32_dpp v11, v12, v41 wave_ror:1 row_mask:0xf bank_mask:0xf
    v_add_f32_dpp v16, v13, v40 wave_ror:1 row_mask:0xf bank_mask:0xf
    v_add_f32_dpp v10, v43, v42 wave_shr:1 row_mask:0xf bank_mask:0xf
    s_nop 1
    v_add_f32_dpp v11, v10, v41 wave_shr:1 row_mask:0xf bank_mask:0xf
    s_nop 1
    v_add_f32_dpp v16, v11, v40 wave_shr:1 row_mask:0xf bank_mask:0xf
    s_waitcnt lgkmcnt(0)
    v_fmac_f32 v16, s44, v14
    ds_write_b32 v9, v16 offset:1536
    ds_read_u16_d16_hi v15, v8 offset:25600
    v_add_f32_dpp v12, v43, v46 wave_ror:1 row_mask:0xf bank_mask:0xf
    v_add_f32_dpp v13, v10, v45 wave_ror:1 row_mask:0xf bank_mask:0xf
    v_add_f32_dpp v17, v11, v44 wave_ror:1 row_mask:0xf bank_mask:0xf
    v_add_f32_dpp v12, v47, v46 wave_shr:1 row_mask:0xf bank_mask:0xf
    s_nop 1
    v_add_f32_dpp v13, v12, v45 wave_shr:1 row_mask:0xf bank_mask:0xf
    s_nop 1
    v_add_f32_dpp v17, v13, v44 wave_shr:1 row_mask:0xf bank_mask:0xf
    s_waitcnt lgkmcnt(0)
    v_fmac_f32 v17, s44, v15
    ds_write_b32 v9, v17 offset:1792
    v_lshlrev_b32 v36, 2, v0
    v_add_u32 v36, 67840, v36
    v_lshlrev_b32 v37, 4, v0
    v_lshlrev_b32 v38, 3, v0
    s_lshl_b32 s45, s30, 15
    s_add_u32 s45, s45, 2787328
    s_waitcnt lgkmcnt(0)
    s_barrier
    ds_read_b32 v40, v36 offset:0
    ds_read_b32 v41, v36 offset:2048
    ds_read_b32 v42, v36 offset:4096
    ds_read_b32 v43, v36 offset:6144
    ds_read_b32 v44, v36 offset:8192
    ds_read_b32 v45, v36 offset:10240
    ds_read_b32 v46, v36 offset:12288
    ds_read_b32 v47, v36 offset:14336
    s_waitcnt vmcnt(1)
    v_lshlrev_b32 v48, 16, v18
    v_and_b32 v49, 0xffff0000, v18
    v_lshlrev_b32 v50, 16, v19
    v_and_b32 v51, 0xffff0000, v19
    v_lshlrev_b32 v52, 16, v20
    v_and_b32 v53, 0xffff0000, v20
    v_lshlrev_b32 v54, 16, v21
    v_and_b32 v55, 0xffff0000, v21
    v_pk_fma_f32 v[56:57], v[48:49], v[22:23], v[22:23] op_sel:[0,0,1] op_sel_hi:[1,0,1]
    v_pk_fma_f32 v[58:59], v[50:51], v[22:23], v[22:23] op_sel:[0,0,1] op_sel_hi:[1,0,1]
    v_pk_fma_f32 v[60:61], v[52:53], v[22:23], v[22:23] op_sel:[0,0,1] op_sel_hi:[1,0,1]
    v_pk_fma_f32 v[62:63], v[54:55], v[22:23], v[22:23] op_sel:[0,0,1] op_sel_hi:[1,0,1]
    s_waitcnt lgkmcnt(0)
    v_pk_fma_f32 v[56:57], v[56:57], v[40:41], v[48:49]
    v_pk_fma_f32 v[58:59], v[58:59], v[42:43], v[50:51]
    v_pk_fma_f32 v[60:61], v[60:61], v[44:45], v[52:53]
    v_pk_fma_f32 v[62:63], v[62:63], v[46:47], v[54:55]
    v_cvt_pk_bf16_f32 v64, v56, v57
    v_cvt_pk_bf16_f32 v65, v58, v59
    v_cvt_pk_bf16_f32 v66, v60, v61
    v_cvt_pk_bf16_f32 v67, v62, v63
    buffer_store_dwordx4 v[64:67], v37, s[24:27], s45 offen
conv_e1:
    s_endpgm
conv_s2:
    v_add_u32 v36, 1664, v0
    v_mul_u32_u24 v37, 1280, v36
    v_lshlrev_b32 v38, 3, v36
    s_lshl_b32 s45, s30, 4
    s_mov_b32 s46, 2621440
    buffer_load_dwordx2 v[22:23], v38, s[24:27], s46 offen
    s_lshl_b32 s49, s30, 4
    s_mul_i32 s45, s32, 1536
    s_add_u32 s45, s45, 67840
    v_lshlrev_b32 v9, 2, v1
    v_add_u32 v9, s45, v9
    s_waitcnt vmcnt(1)
    s_waitcnt lgkmcnt(0)
    s_barrier
    ds_read_b64_tr_b16 v[64:65], v2 offset:0
    ds_read_b64_tr_b16 v[66:67], v2 offset:32
    ds_read_b64_tr_b16 a[100:101], v5 offset:25600
    ds_read_b64_tr_b16 a[102:103], v6 offset:25600
    ds_read_b64_tr_b16 a[104:105], v3 offset:26624
    ds_read_b64_tr_b16 a[106:107], v4 offset:26624
    ds_read_b64_tr_b16 a[108:109], v5 offset:27648
    ds_read_b64_tr_b16 a[110:111], v6 offset:27648
    ds_read_b64_tr_b16 a[112:113], v3 offset:28672
    ds_read_b64_tr_b16 a[114:115], v4 offset:28672
    ds_read_b64_tr_b16 v[68:69], v2 offset:256
    ds_read_b64_tr_b16 v[70:71], v2 offset:288
    ds_read_b64_tr_b16 a[92:93], v5 offset:23552
    ds_read_b64_tr_b16 a[94:95], v6 offset:23552
    s_waitcnt lgkmcnt(10)
    v_mfma_f32_16x16x32_bf16 v[44:47], v[64:67], a[100:103], 0
    ds_read_b64_tr_b16 a[96:97], v3 offset:24576
    ds_read_b64_tr_b16 a[98:99], v4 offset:24576
    s_waitcnt lgkmcnt(10)
    v_mfma_f32_16x16x32_bf16 v[48:51], v[64:67], a[104:107], 0
    ds_read_b64_tr_b16 v[72:73], v2 offset:512
    ds_read_b64_tr_b16 v[74:75], v2 offset:544
    s_waitcnt lgkmcnt(10)
    v_mfma_f32_16x16x32_bf16 v[52:55], v[64:67], a[108:111], 0
    s_add_u32 s49, s49, 0
    buffer_load_dwordx4 v[18:21], v37, s[4:7], s49 offen
    ds_read_b64_tr_b16 a[84:85], v5 offset:21504
    ds_read_b64_tr_b16 a[86:87], v6 offset:21504
    s_waitcnt lgkmcnt(10)
    v_mfma_f32_16x16x32_bf16 v[56:59], v[64:67], a[112:115], 0
    ds_read_b64_tr_b16 a[88:89], v3 offset:22528
    ds_read_b64_tr_b16 a[90:91], v4 offset:22528
    s_waitcnt lgkmcnt(8)
    v_mfma_f32_16x16x32_bf16 v[44:47], v[68:71], a[92:95], v[44:47]
    s_waitcnt lgkmcnt(6)
    v_mfma_f32_16x16x32_bf16 v[48:51], v[68:71], a[96:99], v[48:51]
    ds_read_b64_tr_b16 v[76:77], v2 offset:768
    ds_read_b64_tr_b16 v[78:79], v2 offset:800
    v_mfma_f32_16x16x32_bf16 v[52:55], v[68:71], a[100:103], v[52:55]
    ds_read_b64_tr_b16 a[76:77], v5 offset:19456
    ds_read_b64_tr_b16 a[78:79], v6 offset:19456
    v_mfma_f32_16x16x32_bf16 v[56:59], v[68:71], a[104:107], v[56:59]
    ds_read_b64_tr_b16 a[80:81], v3 offset:20480
    ds_read_b64_tr_b16 a[82:83], v4 offset:20480
    s_waitcnt lgkmcnt(8)
    v_mfma_f32_16x16x32_bf16 v[44:47], v[72:75], a[84:87], v[44:47]
    s_waitcnt lgkmcnt(6)
    v_mfma_f32_16x16x32_bf16 v[48:51], v[72:75], a[88:91], v[48:51]
    ds_read_b64_tr_b16 v[80:81], v2 offset:1024
    ds_read_b64_tr_b16 v[82:83], v2 offset:1056
    v_mfma_f32_16x16x32_bf16 v[52:55], v[72:75], a[92:95], v[52:55]
    ds_read_b64_tr_b16 a[68:69], v5 offset:17408
    ds_read_b64_tr_b16 a[70:71], v6 offset:17408
    v_mfma_f32_16x16x32_bf16 v[56:59], v[72:75], a[96:99], v[56:59]
    ds_read_b64_tr_b16 a[72:73], v3 offset:18432
    ds_read_b64_tr_b16 a[74:75], v4 offset:18432
    s_waitcnt lgkmcnt(8)
    v_mfma_f32_16x16x32_bf16 v[44:47], v[76:79], a[76:79], v[44:47]
    buffer_load_dword v30, v32, s[16:19], 0 offen
    s_waitcnt lgkmcnt(6)
    v_mfma_f32_16x16x32_bf16 v[48:51], v[76:79], a[80:83], v[48:51]
    ds_read_b64_tr_b16 v[84:85], v2 offset:1280
    ds_read_b64_tr_b16 v[86:87], v2 offset:1312
    v_mfma_f32_16x16x32_bf16 v[52:55], v[76:79], a[84:87], v[52:55]
    ds_read_b64_tr_b16 a[60:61], v5 offset:15360
    ds_read_b64_tr_b16 a[62:63], v6 offset:15360
    v_mfma_f32_16x16x32_bf16 v[56:59], v[76:79], a[88:91], v[56:59]
    ds_read_b64_tr_b16 a[64:65], v3 offset:16384
    ds_read_b64_tr_b16 a[66:67], v4 offset:16384
    s_waitcnt lgkmcnt(8)
    v_mfma_f32_16x16x32_bf16 v[44:47], v[80:83], a[68:71], v[44:47]
    s_waitcnt lgkmcnt(6)
    v_mfma_f32_16x16x32_bf16 v[48:51], v[80:83], a[72:75], v[48:51]
    ds_read_b64_tr_b16 v[88:89], v2 offset:1536
    ds_read_b64_tr_b16 v[90:91], v2 offset:1568
    v_mfma_f32_16x16x32_bf16 v[52:55], v[80:83], a[76:79], v[52:55]
    ds_read_b64_tr_b16 a[52:53], v5 offset:13312
    ds_read_b64_tr_b16 a[54:55], v6 offset:13312
    v_mfma_f32_16x16x32_bf16 v[56:59], v[80:83], a[80:83], v[56:59]
    ds_read_b64_tr_b16 a[56:57], v3 offset:14336
    ds_read_b64_tr_b16 a[58:59], v4 offset:14336
    s_waitcnt lgkmcnt(8)
    v_mfma_f32_16x16x32_bf16 v[44:47], v[84:87], a[60:63], v[44:47]
    s_waitcnt lgkmcnt(6)
    v_mfma_f32_16x16x32_bf16 v[48:51], v[84:87], a[64:67], v[48:51]
    ds_read_b64_tr_b16 v[92:93], v2 offset:1792
    ds_read_b64_tr_b16 v[94:95], v2 offset:1824
    v_mfma_f32_16x16x32_bf16 v[52:55], v[84:87], a[68:71], v[52:55]
    ds_read_b64_tr_b16 a[44:45], v5 offset:11264
    ds_read_b64_tr_b16 a[46:47], v6 offset:11264
    v_mfma_f32_16x16x32_bf16 v[56:59], v[84:87], a[72:75], v[56:59]
    ds_read_b64_tr_b16 a[48:49], v3 offset:12288
    ds_read_b64_tr_b16 a[50:51], v4 offset:12288
    s_waitcnt lgkmcnt(8)
    v_mfma_f32_16x16x32_bf16 v[44:47], v[88:91], a[52:55], v[44:47]
    s_waitcnt lgkmcnt(6)
    v_mfma_f32_16x16x32_bf16 v[48:51], v[88:91], a[56:59], v[48:51]
    ds_read_b64_tr_b16 v[96:97], v2 offset:2048
    ds_read_b64_tr_b16 v[98:99], v2 offset:2080
    v_mfma_f32_16x16x32_bf16 v[52:55], v[88:91], a[60:63], v[52:55]
    ds_read_b64_tr_b16 a[36:37], v5 offset:9216
    ds_read_b64_tr_b16 a[38:39], v6 offset:9216
    v_mfma_f32_16x16x32_bf16 v[56:59], v[88:91], a[64:67], v[56:59]
    ds_read_b64_tr_b16 a[40:41], v3 offset:10240
    ds_read_b64_tr_b16 a[42:43], v4 offset:10240
    s_waitcnt lgkmcnt(8)
    v_mfma_f32_16x16x32_bf16 v[44:47], v[92:95], a[44:47], v[44:47]
    s_waitcnt lgkmcnt(6)
    v_mfma_f32_16x16x32_bf16 v[48:51], v[92:95], a[48:51], v[48:51]
    ds_read_b64_tr_b16 v[100:101], v2 offset:2304
    ds_read_b64_tr_b16 v[102:103], v2 offset:2336
    v_mfma_f32_16x16x32_bf16 v[52:55], v[92:95], a[52:55], v[52:55]
    ds_read_b64_tr_b16 a[28:29], v5 offset:7168
    ds_read_b64_tr_b16 a[30:31], v6 offset:7168
    v_mfma_f32_16x16x32_bf16 v[56:59], v[92:95], a[56:59], v[56:59]
    ds_read_b64_tr_b16 a[32:33], v3 offset:8192
    ds_read_b64_tr_b16 a[34:35], v4 offset:8192
    s_waitcnt lgkmcnt(8)
    v_mfma_f32_16x16x32_bf16 v[44:47], v[96:99], a[36:39], v[44:47]
    s_waitcnt lgkmcnt(6)
    v_mfma_f32_16x16x32_bf16 v[48:51], v[96:99], a[40:43], v[48:51]
    ds_read_b64_tr_b16 v[104:105], v2 offset:2560
    ds_read_b64_tr_b16 v[106:107], v2 offset:2592
    v_mfma_f32_16x16x32_bf16 v[52:55], v[96:99], a[44:47], v[52:55]
    ds_read_b64_tr_b16 a[20:21], v5 offset:5120
    ds_read_b64_tr_b16 a[22:23], v6 offset:5120
    v_mfma_f32_16x16x32_bf16 v[56:59], v[96:99], a[48:51], v[56:59]
    ds_read_b64_tr_b16 a[24:25], v3 offset:6144
    ds_read_b64_tr_b16 a[26:27], v4 offset:6144
    s_waitcnt lgkmcnt(8)
    v_mfma_f32_16x16x32_bf16 v[44:47], v[100:103], a[28:31], v[44:47]
    s_waitcnt lgkmcnt(6)
    v_mfma_f32_16x16x32_bf16 v[48:51], v[100:103], a[32:35], v[48:51]
    ds_read_b64_tr_b16 v[108:109], v2 offset:2816
    ds_read_b64_tr_b16 v[110:111], v2 offset:2848
    v_mfma_f32_16x16x32_bf16 v[52:55], v[100:103], a[36:39], v[52:55]
    ds_read_b64_tr_b16 a[12:13], v5 offset:3072
    ds_read_b64_tr_b16 a[14:15], v6 offset:3072
    v_mfma_f32_16x16x32_bf16 v[56:59], v[100:103], a[40:43], v[56:59]
    ds_read_b64_tr_b16 a[16:17], v3 offset:4096
    ds_read_b64_tr_b16 a[18:19], v4 offset:4096
    s_waitcnt lgkmcnt(8)
    v_mfma_f32_16x16x32_bf16 v[44:47], v[104:107], a[20:23], v[44:47]
    s_waitcnt lgkmcnt(6)
    v_mfma_f32_16x16x32_bf16 v[48:51], v[104:107], a[24:27], v[48:51]
    ds_read_b64_tr_b16 v[112:113], v2 offset:3072
    ds_read_b64_tr_b16 v[114:115], v2 offset:3104
    v_mfma_f32_16x16x32_bf16 v[52:55], v[104:107], a[28:31], v[52:55]
    ds_read_b64_tr_b16 a[4:5], v5 offset:1024
    ds_read_b64_tr_b16 a[6:7], v6 offset:1024
    v_mfma_f32_16x16x32_bf16 v[56:59], v[104:107], a[32:35], v[56:59]
    ds_read_b64_tr_b16 a[8:9], v3 offset:2048
    ds_read_b64_tr_b16 a[10:11], v4 offset:2048
    s_waitcnt lgkmcnt(8)
    v_mfma_f32_16x16x32_bf16 v[44:47], v[108:111], a[12:15], v[44:47]
    s_waitcnt lgkmcnt(6)
    v_mfma_f32_16x16x32_bf16 v[48:51], v[108:111], a[16:19], v[48:51]
    ds_read_b64_tr_b16 v[116:117], v2 offset:3328
    ds_read_b64_tr_b16 v[118:119], v2 offset:3360
    v_mfma_f32_16x16x32_bf16 v[52:55], v[108:111], a[20:23], v[52:55]
    ds_read_b64_tr_b16 a[0:1], v3 offset:0
    ds_read_b64_tr_b16 a[2:3], v4 offset:0
    v_mfma_f32_16x16x32_bf16 v[56:59], v[108:111], a[24:27], v[56:59]
    s_waitcnt lgkmcnt(6)
    v_mfma_f32_16x16x32_bf16 v[44:47], v[112:115], a[4:7], v[44:47]
    ds_read_b64_tr_b16 v[120:121], v2 offset:3584
    ds_read_b64_tr_b16 v[122:123], v2 offset:3616
    s_waitcnt lgkmcnt(6)
    v_mfma_f32_16x16x32_bf16 v[48:51], v[112:115], a[8:11], v[48:51]
    ds_read_b64_tr_b16 a[116:117], v5 offset:29696
    ds_read_b64_tr_b16 a[118:119], v6 offset:29696
    v_mfma_f32_16x16x32_bf16 v[52:55], v[112:115], a[12:15], v[52:55]
    ds_read_b64_tr_b16 a[120:121], v3 offset:30720
    ds_read_b64_tr_b16 a[122:123], v4 offset:30720
    v_mfma_f32_16x16x32_bf16 v[56:59], v[112:115], a[16:19], v[56:59]
    ds_read_b64_tr_b16 a[124:125], v5 offset:31744
    ds_read_b64_tr_b16 a[126:127], v6 offset:31744
    s_waitcnt lgkmcnt(8)
    v_mfma_f32_16x16x32_bf16 v[48:51], v[116:119], a[0:3], v[48:51]
    v_mfma_f32_16x16x32_bf16 v[52:55], v[116:119], a[4:7], v[52:55]
    v_add_f32_dpp v12, v47, v46 wave_shr:1 row_mask:0xf bank_mask:0xf
    v_mfma_f32_16x16x32_bf16 v[56:59], v[116:119], a[8:11], v[56:59]
    s_waitcnt lgkmcnt(6)
    v_mfma_f32_16x16x32_bf16 v[56:59], v[120:123], a[0:3], v[56:59]
    v_add_f32_dpp v13, v12, v45 wave_shr:1 row_mask:0xf bank_mask:0xf
    ds_read_u16_d16_hi v14, v7 offset:26624
    s_waitcnt lgkmcnt(5)
    v_mfma_f32_16x16x32_bf16 v[60:63], v[64:67], a[116:119], 0
    v_add_f32_dpp v10, v47, v50 wave_ror:1 row_mask:0xf bank_mask:0xf
    v_add_f32_dpp v11, v12, v49 wave_ror:1 row_mask:0xf bank_mask:0xf
    s_waitcnt lgkmcnt(3)
    v_mfma_f32_16x16x32_bf16 v[40:43], v[64:67], a[120:123], 0
    v_add_f32_dpp v16, v13, v48 wave_ror:1 row_mask:0xf bank_mask:0xf
    v_add_f32_dpp v10, v51, v50 wave_shr:1 row_mask:0xf bank_mask:0xf
    s_nop 1
    v_add_f32_dpp v11, v10, v49 wave_shr:1 row_mask:0xf bank_mask:0xf
    s_nop 1
    v_add_f32_dpp v16, v11, v48 wave_shr:1 row_mask:0xf bank_mask:0xf
    s_waitcnt lgkmcnt(0)
    v_fmac_f32 v16, s44, v14
    ds_write_b32 v9, v16 offset:0
    v_mfma_f32_16x16x32_bf16 v[44:47], v[64:67], a[124:127], 0
    ds_read_u16_d16_hi v15, v8 offset:27648
    v_add_f32_dpp v12, v51, v54 wave_ror:1 row_mask:0xf bank_mask:0xf
    v_mfma_f32_16x16x32_bf16 v[60:63], v[68:71], a[108:111], v[60:63]
    v_add_f32_dpp v13, v10, v53 wave_ror:1 row_mask:0xf bank_mask:0xf
    v_add_f32_dpp v17, v11, v52 wave_ror:1 row_mask:0xf bank_mask:0xf
    v_mfma_f32_16x16x32_bf16 v[40:43], v[68:71], a[112:115], v[40:43]
    v_add_f32_dpp v12, v55, v54 wave_shr:1 row_mask:0xf bank_mask:0xf
    v_mfma_f32_16x16x32_bf16 v[44:47], v[68:71], a[116:119], v[44:47]
    v_mfma_f32_16x16x32_bf16 v[60:63], v[72:75], a[100:103], v[60:63]
    v_add_f32_dpp v13, v12, v53 wave_shr:1 row_mask:0xf bank_mask:0xf
    v_mfma_f32_16x16x32_bf16 v[40:43], v[72:75], a[104:107], v[40:43]
    v_mfma_f32_16x16x32_bf16 v[44:47], v[72:75], a[108:111], v[44:47]
    v_add_f32_dpp v17, v13, v52 wave_shr:1 row_mask:0xf bank_mask:0xf
    s_waitcnt lgkmcnt(0)
    v_fmac_f32 v17, s44, v15
    v_mfma_f32_16x16x32_bf16 v[60:63], v[76:79], a[92:95], v[60:63]
    ds_write_b32 v9, v17 offset:256
    ds_read_u16_d16_hi v14, v7 offset:28672
    v_mfma_f32_16x16x32_bf16 v[40:43], v[76:79], a[96:99], v[40:43]
    v_add_f32_dpp v10, v55, v58 wave_ror:1 row_mask:0xf bank_mask:0xf
    v_add_f32_dpp v11, v12, v57 wave_ror:1 row_mask:0xf bank_mask:0xf
    v_mfma_f32_16x16x32_bf16 v[44:47], v[76:79], a[100:103], v[44:47]
    v_add_f32_dpp v16, v13, v56 wave_ror:1 row_mask:0xf bank_mask:0xf
    v_add_f32_dpp v10, v59, v58 wave_shr:1 row_mask:0xf bank_mask:0xf
    v_mfma_f32_16x16x32_bf16 v[60:63], v[80:83], a[84:87], v[60:63]
    v_mfma_f32_16x16x32_bf16 v[40:43], v[80:83], a[88:91], v[40:43]
    v_add_f32_dpp v11, v10, v57 wave_shr:1 row_mask:0xf bank_mask:0xf
    v_mfma_f32_16x16x32_bf16 v[44:47], v[80:83], a[92:95], v[44:47]
    v_mfma_f32_16x16x32_bf16 v[60:63], v[84:87], a[76:79], v[60:63]
    v_add_f32_dpp v16, v11, v56 wave_shr:1 row_mask:0xf bank_mask:0xf
    s_waitcnt lgkmcnt(0)
    v_fmac_f32 v16, s44, v14
    v_mfma_f32_16x16x32_bf16 v[40:43], v[84:87], a[80:83], v[40:43]
    ds_write_b32 v9, v16 offset:512
    v_mfma_f32_16x16x32_bf16 v[44:47], v[84:87], a[84:87], v[44:47]
    v_mfma_f32_16x16x32_bf16 v[60:63], v[88:91], a[68:71], v[60:63]
    v_mfma_f32_16x16x32_bf16 v[40:43], v[88:91], a[72:75], v[40:43]
    v_mfma_f32_16x16x32_bf16 v[44:47], v[88:91], a[76:79], v[44:47]
    v_mfma_f32_16x16x32_bf16 v[60:63], v[92:95], a[60:63], v[60:63]
    v_mfma_f32_16x16x32_bf16 v[40:43], v[92:95], a[64:67], v[40:43]
    v_mfma_f32_16x16x32_bf16 v[44:47], v[92:95], a[68:71], v[44:47]
    v_mfma_f32_16x16x32_bf16 v[60:63], v[96:99], a[52:55], v[60:63]
    v_mfma_f32_16x16x32_bf16 v[40:43], v[96:99], a[56:59], v[40:43]
    v_mfma_f32_16x16x32_bf16 v[44:47], v[96:99], a[60:63], v[44:47]
    v_mfma_f32_16x16x32_bf16 v[60:63], v[100:103], a[44:47], v[60:63]
    v_mfma_f32_16x16x32_bf16 v[40:43], v[100:103], a[48:51], v[40:43]
    v_mfma_f32_16x16x32_bf16 v[44:47], v[100:103], a[52:55], v[44:47]
    v_mfma_f32_16x16x32_bf16 v[60:63], v[104:107], a[36:39], v[60:63]
    v_mfma_f32_16x16x32_bf16 v[40:43], v[104:107], a[40:43], v[40:43]
    v_mfma_f32_16x16x32_bf16 v[44:47], v[104:107], a[44:47], v[44:47]
    v_mfma_f32_16x16x32_bf16 v[60:63], v[108:111], a[28:31], v[60:63]
    v_mfma_f32_16x16x32_bf16 v[40:43], v[108:111], a[32:35], v[40:43]
    v_mfma_f32_16x16x32_bf16 v[44:47], v[108:111], a[36:39], v[44:47]
    v_mfma_f32_16x16x32_bf16 v[60:63], v[112:115], a[20:23], v[60:63]
    v_mfma_f32_16x16x32_bf16 v[40:43], v[112:115], a[24:27], v[40:43]
    v_mfma_f32_16x16x32_bf16 v[44:47], v[112:115], a[28:31], v[44:47]
    ds_read_b64_tr_b16 v[124:125], v2 offset:3840
    ds_read_b64_tr_b16 v[126:127], v2 offset:3872
    v_mfma_f32_16x16x32_bf16 v[60:63], v[116:119], a[12:15], v[60:63]
    v_mfma_f32_16x16x32_bf16 v[40:43], v[116:119], a[16:19], v[40:43]
    v_mfma_f32_16x16x32_bf16 v[44:47], v[116:119], a[20:23], v[44:47]
    v_mfma_f32_16x16x32_bf16 v[60:63], v[120:123], a[4:7], v[60:63]
    ds_read_u16_d16_hi v15, v8 offset:29696
    v_mfma_f32_16x16x32_bf16 v[40:43], v[120:123], a[8:11], v[40:43]
    v_mfma_f32_16x16x32_bf16 v[44:47], v[120:123], a[12:15], v[44:47]
    s_waitcnt lgkmcnt(1)
    v_mfma_f32_16x16x32_bf16 v[40:43], v[124:127], a[0:3], v[40:43]
    v_mfma_f32_16x16x32_bf16 v[44:47], v[124:127], a[4:7], v[44:47]
    s_nop 1
    v_add_f32_dpp v12, v59, v62 wave_ror:1 row_mask:0xf bank_mask:0xf
    v_add_f32_dpp v13, v10, v61 wave_ror:1 row_mask:0xf bank_mask:0xf
    v_add_f32_dpp v17, v11, v60 wave_ror:1 row_mask:0xf bank_mask:0xf
    v_add_f32_dpp v12, v63, v62 wave_shr:1 row_mask:0xf bank_mask:0xf
    s_nop 1
    v_add_f32_dpp v13, v12, v61 wave_shr:1 row_mask:0xf bank_mask:0xf
    s_nop 1
    v_add_f32_dpp v17, v13, v60 wave_shr:1 row_mask:0xf bank_mask:0xf
    s_waitcnt lgkmcnt(0)
    v_fmac_f32 v17, s44, v15
    ds_write_b32 v9, v17 offset:768
    ds_read_u16_d16_hi v14, v7 offset:30720
    v_add_f32_dpp v10, v63, v42 wave_ror:1 row_mask:0xf bank_mask:0xf
    v_add_f32_dpp v11, v12, v41 wave_ror:1 row_mask:0xf bank_mask:0xf
    v_add_f32_dpp v16, v13, v40 wave_ror:1 row_mask:0xf bank_mask:0xf
    v_add_f32_dpp v10, v43, v42 wave_shr:1 row_mask:0xf bank_mask:0xf
    s_nop 1
    v_add_f32_dpp v11, v10, v41 wave_shr:1 row_mask:0xf bank_mask:0xf
    s_nop 1
    v_add_f32_dpp v16, v11, v40 wave_shr:1 row_mask:0xf bank_mask:0xf
    s_waitcnt lgkmcnt(0)
    v_fmac_f32 v16, s44, v14
    ds_write_b32 v9, v16 offset:1024
    ds_read_u16_d16_hi v15, v8 offset:31744
    v_add_f32_dpp v12, v43, v46 wave_ror:1 row_mask:0xf bank_mask:0xf
    v_add_f32_dpp v13, v10, v45 wave_ror:1 row_mask:0xf bank_mask:0xf
    v_add_f32_dpp v17, v11, v44 wave_ror:1 row_mask:0xf bank_mask:0xf
    v_add_f32_dpp v12, v47, v46 wave_shr:1 row_mask:0xf bank_mask:0xf
    s_nop 1
    v_add_f32_dpp v13, v12, v45 wave_shr:1 row_mask:0xf bank_mask:0xf
    s_nop 1
    v_add_f32_dpp v17, v13, v44 wave_shr:1 row_mask:0xf bank_mask:0xf
    s_waitcnt lgkmcnt(0)
    v_fmac_f32 v17, s44, v15
    ds_write_b32 v9, v17 offset:1280
    v_lshlrev_b32 v36, 2, v0
    v_add_u32 v36, 67840, v36
    v_lshlrev_b32 v37, 4, v0
    v_lshlrev_b32 v38, 3, v0
    s_lshl_b32 s45, s30, 15
    s_add_u32 s45, s45, 2795520
    s_waitcnt lgkmcnt(0)
    s_barrier
    s_cmp_ge_u32 s32, 6
    s_cbranch_scc1 conv_e2
    ds_read_b32 v40, v36 offset:0
    ds_read_b32 v41, v36 offset:1536
    ds_read_b32 v42, v36 offset:3072
    ds_read_b32 v43, v36 offset:4608
    ds_read_b32 v44, v36 offset:6144
    ds_read_b32 v45, v36 offset:7680
    ds_read_b32 v46, v36 offset:9216
    ds_read_b32 v47, v36 offset:10752
    s_waitcnt vmcnt(1)
    v_lshlrev_b32 v48, 16, v18
    v_and_b32 v49, 0xffff0000, v18
    v_lshlrev_b32 v50, 16, v19
    v_and_b32 v51, 0xffff0000, v19
    v_lshlrev_b32 v52, 16, v20
    v_and_b32 v53, 0xffff0000, v20
    v_lshlrev_b32 v54, 16, v21
    v_and_b32 v55, 0xffff0000, v21
    v_pk_fma_f32 v[56:57], v[48:49], v[22:23], v[22:23] op_sel:[0,0,1] op_sel_hi:[1,0,1]
    v_pk_fma_f32 v[58:59], v[50:51], v[22:23], v[22:23] op_sel:[0,0,1] op_sel_hi:[1,0,1]
    v_pk_fma_f32 v[60:61], v[52:53], v[22:23], v[22:23] op_sel:[0,0,1] op_sel_hi:[1,0,1]
    v_pk_fma_f32 v[62:63], v[54:55], v[22:23], v[22:23] op_sel:[0,0,1] op_sel_hi:[1,0,1]
    s_waitcnt lgkmcnt(0)
    v_pk_fma_f32 v[56:57], v[56:57], v[40:41], v[48:49]
    v_pk_fma_f32 v[58:59], v[58:59], v[42:43], v[50:51]
    v_pk_fma_f32 v[60:61], v[60:61], v[44:45], v[52:53]
    v_pk_fma_f32 v[62:63], v[62:63], v[46:47], v[54:55]
    v_cvt_pk_bf16_f32 v64, v56, v57
    v_cvt_pk_bf16_f32 v65, v58, v59
    v_cvt_pk_bf16_f32 v66, v60, v61
    v_cvt_pk_bf16_f32 v67, v62, v63
    buffer_store_dwordx4 v[64:67], v37, s[24:27], s45 offen
conv_e2:
    s_endpgm
conv_end:
    s_endpgm
.globl g12_kernel
.p2align 8
.type g12_kernel,@function
g12_kernel:
    s_cmp_ge_u32 s2, 256
    s_cbranch_scc1 g_end
    s_load_dwordx2 s[8:9], s[0:1], 56
    s_load_dwordx2 s[12:13], s[0:1], 64
    s_load_dwordx2 s[24:25], s[0:1], 96
    s_load_dwordx2 s[16:17], s[0:1], 72
    s_load_dwordx2 s[20:21], s[0:1], 80
    v_lshrrev_b32 v1, 6, v0
    s_and_b32 s28, s2, 7
    v_readfirstlane_b32 s32, v1
    v_and_b32 v1, 63, v0
    s_mov_b32 s10, 2211840
    s_mov_b32 s11, 0x00020000
    s_mov_b32 s14, 2211840
    s_mov_b32 s15, 0x00020000
    s_mov_b32 s18, 2211840
    s_mov_b32 s19, 0x00020000
    s_mov_b32 s22, 2621440
    s_mov_b32 s23, 0x00020000
    s_mov_b32 s26, 12468224
    s_mov_b32 s27, 0x00020000
    s_cmp_lt_u32 s2, 32
    s_cbranch_scc1 g_help
    s_lshr_b32 s29, s2, 3
    s_sub_u32 s29, s29, 4
    s_lshr_b32 s30, s28, 1
    s_mul_i32 s30, s30, 7
    s_lshr_b32 s31, s29, 2
    s_add_u32 s30, s30, s31
    s_cmp_ge_u32 s30, 27
    s_cbranch_scc1 g_only2
    s_and_b32 s33, s28, 1
    s_lshl_b32 s33, s33, 2
    s_and_b32 s31, s29, 3
    s_add_u32 s31, s31, s33
    v_lshrrev_b32 v4, 3, v0
    v_mul_u32_u24 v3, 3456, v4
    v_bfe_u32 v5, v4, 1, 1
    v_bfe_u32 v6, v4, 3, 1
    v_lshl_or_b32 v5, v6, 1, v5
    v_lshlrev_b32 v5, 1, v5
    v_and_b32 v6, 7, v0
    v_xor_b32 v5, v5, v6
    v_lshl_add_u32 v3, v5, 4, v3
    s_lshl_b32 s33, s30, 7
    v_add_u32 v3, s33, v3
    s_lshl_b32 s33, s31, 8
    s_lshl_b32 s34, s32, 6
    s_add_u32 s33, s33, s34
    v_and_b32 v5, 15, v1
    v_add_u32 v5, s33, v5
    v_lshlrev_b32 v5, 4, v5
    v_lshrrev_b32 v6, 4, v1
    v_lshl_add_u32 v2, v6, 15, v5
    s_lshl_b32 s40, s32, 10
    s_waitcnt lgkmcnt(0)
    s_add_u32 m0, s40, 0
    s_mov_b32 s41, 0
    buffer_load_dwordx4 v3, s[8:11], s41 offen lds
    s_add_u32 m0, s40, 4096
    s_mov_b32 s41, 0
    buffer_load_dwordx4 v3, s[12:15], s41 offen lds
    s_mov_b32 s42, 2768896
    buffer_load_dwordx4 a[0:3], v2, s[24:27], s42 offen offset:0
    buffer_load_dwordx4 a[4:7], v2, s[24:27], s42 offen offset:256
    buffer_load_dwordx4 a[8:11], v2, s[24:27], s42 offen offset:512
    buffer_load_dwordx4 a[12:15], v2, s[24:27], s42 offen offset:768
    s_add_u32 m0, s40, 8192
    s_mov_b32 s41, 110592
    buffer_load_dwordx4 v3, s[8:11], s41 offen lds
    s_add_u32 m0, s40, 12288
    s_mov_b32 s41, 110592
    buffer_load_dwordx4 v3, s[12:15], s41 offen lds
    s_mov_b32 s42, 2899968
    buffer_load_dwordx4 a[16:19], v2, s[24:27], s42 offen offset:0
    buffer_load_dwordx4 a[20:23], v2, s[24:27], s42 offen offset:256
    buffer_load_dwordx4 a[24:27], v2, s[24:27], s42 offen offset:512
    buffer_load_dwordx4 a[28:31], v2, s[24:27], s42 offen offset:768
    s_add_u32 m0, s40, 16384
    s_mov_b32 s41, 221184
    buffer_load_dwordx4 v3, s[8:11], s41 offen lds
    s_add_u32 m0, s40, 20480
    s_mov_b32 s41, 221184
    buffer_load_dwordx4 v3, s[12:15], s41 offen lds
    s_mov_b32 s42, 3031040
    buffer_load_dwordx4 a[32:35], v2, s[24:27], s42 offen offset:0
    buffer_load_dwordx4 a[36:39], v2, s[24:27], s42 offen offset:256
    buffer_load_dwordx4 a[40:43], v2, s[24:27], s42 offen offset:512
    buffer_load_dwordx4 a[44:47], v2, s[24:27], s42 offen offset:768
    s_add_u32 m0, s40, 24576
    s_mov_b32 s41, 331776
    buffer_load_dwordx4 v3, s[8:11], s41 offen lds
    s_add_u32 m0, s40, 28672
    s_mov_b32 s41, 331776
    buffer_load_dwordx4 v3, s[12:15], s41 offen lds
    s_mov_b32 s42, 3162112
    buffer_load_dwordx4 a[48:51], v2, s[24:27], s42 offen offset:0
    buffer_load_dwordx4 a[52:55], v2, s[24:27], s42 offen offset:256
    buffer_load_dwordx4 a[56:59], v2, s[24:27], s42 offen offset:512
    buffer_load_dwordx4 a[60:63], v2, s[24:27], s42 offen offset:768
    v_lshrrev_b32 v20, 4, v1
    v_bfe_u32 v21, v1, 2, 2
    v_lshl_add_u32 v22, v20, 3, v21
    v_lshlrev_b32 v22, 7, v22
    v_and_b32 v23, 3, v1
    v_lshl_add_u32 v22, v23, 3, v22
    v_lshrrev_b32 v21, 1, v21
    v_and_b32 v23, 1, v20
    v_lshl_or_b32 v21, v23, 1, v21
    v_xor_b32 v23, 0, v21
    v_lshl_add_u32 v4, v23, 5, v22
    v_add_u32 v8, 0x10000, v4
    v_add_u32 v12, 0x20000, v4
    v_xor_b32 v23, 1, v21
    v_lshl_add_u32 v5, v23, 5, v22
    v_add_u32 v9, 0x10000, v5
    v_add_u32 v13, 0x20000, v5
    v_xor_b32 v23, 2, v21
    v_lshl_add_u32 v6, v23, 5, v22
    v_add_u32 v10, 0x10000, v6
    v_add_u32 v14, 0x20000, v6
    v_xor_b32 v23, 3, v21
    v_lshl_add_u32 v7, v23, 5, v22
    v_add_u32 v11, 0x10000, v7
    v_add_u32 v15, 0x20000, v7
    s_lshl_b32 s44, s30, 18
    s_add_u32 s44, s44, 5390336
    s_add_u32 s45, s44, 0x20000
    s_mov_b32 s43, 2637824
    s_lshl_b32 s46, s30, 8
    s_add_u32 s46, s46, 2654208
    s_add_u32 s47, s46, 6912
    s_lshl_b32 s48, s31, 11
    s_mul_i32 s49, s30, 4
    s_add_u32 s48, s48, s49
    s_add_u32 s48, s48, 2670592
    v_add_u32 v52, s33, v1
    v_lshlrev_b32 v52, 3, v52
    v_and_b32 v53, 15, v1
    v_lshlrev_b32 v53, 2, v53
    v_and_b32 v26, 48, v1
    s_lshr_b32 s54, s28, 1
    s_mul_i32 s54, s54, 28
    s_add_u32 s54, s54, s29
    s_mul_i32 s51, s54, 205
    s_lshr_b32 s51, s51, 10
    s_mul_i32 s50, s51, 5
    s_sub_u32 s50, s54, s50
    s_and_b32 s54, s28, 1
    s_mul_i32 s54, s54, 5
    s_add_u32 s50, s50, s54
    s_and_b32 s52, s32, 1
    s_lshr_b32 s53, s32, 1
    v_lshrrev_b32 v24, 3, v1
    v_mul_u32_u24 v16, 1280, v24
    v_and_b32 v24, 6, v24
    v_and_b32 v25, 7, v1
    v_xor_b32 v24, v24, v25
    v_lshl_add_u32 v16, v24, 4, v16
    s_lshl_b32 s54, s50, 7
    s_mul_i32 s55, s52, 20480
    s_add_u32 s54, s54, s55
    s_mul_i32 s55, s53, 1105920
    s_add_u32 s54, s54, s55
    v_add_u32 v16, s54, v16
    s_lshl_b32 s56, s53, 12
    s_lshl_b32 s55, s52, 11
    s_add_u32 s56, s56, s55
    s_mul_i32 s59, s53, 40960
    s_lshl_b32 s61, s53, 17
    s_xor_b32 s55, s53, 1
    s_mul_i32 s60, s55, 1064960
    s_mul_i32 s62, s55, 3407872
    s_mul_i32 s58, s51, 96
    s_mul_i32 s55, s52, 48
    s_add_u32 s54, s58, s55
    s_min_u32 s54, s54, 2000
    v_and_b32 v24, 15, v1
    v_add_u32 v24, s54, v24
    v_lshlrev_b32 v25, 4, v24
    v_lshrrev_b32 v27, 4, v1
    v_lshl_add_u32 v17, v27, 15, v25
    s_mul_i32 s55, s53, 3538944
    v_add_u32 v17, s55, v17
    v_and_b32 v28, 1, v27
    v_lshrrev_b32 v29, 1, v27
    v_lshl_add_u32 v28, v28, 1, v29
    s_lshl_b32 s54, s53, 2
    s_lshl_b32 s55, s50, 3
    s_add_u32 s54, s54, s55
    v_add_u32 v28, s54, v28
    v_lshl_add_u32 v18, v28, 15, v25
    v_mul_u32_u24 v19, 1280, v24
    v_lshl_add_u32 v19, v28, 4, v19
    s_mul_i32 s54, s32, 6144
    s_add_u32 s54, s54, 65536
    v_lshlrev_b32 v27, 4, v1
    v_add_u32 v54, s54, v27
    s_xor_b32 s54, s32, 2
    s_mul_i32 s54, s54, 6144
    s_add_u32 s54, s54, 65536
    v_add_u32 v55, s54, v27
    v_bfe_u32 v27, v1, 2, 4
    v_lshlrev_b32 v28, 7, v27
    v_and_b32 v29, 3, v1
    v_lshl_add_u32 v28, v29, 3, v28
    s_lshl_b32 s54, s53, 12
    v_add_u32 v28, s54, v28
    v_bfe_u32 v27, v27, 1, 2
    s_lshl_b32 s54, s53, 1
    v_xor_b32 v27, s54, v27
    v_xor_b32 v29, 0, v27
    v_lshl_add_u32 v120, v29, 5, v28
    v_add_u32 v124, 0x10000, v120
    v_xor_b32 v29, 1, v27
    v_lshl_add_u32 v121, v29, 5, v28
    v_add_u32 v125, 0x10000, v121
    v_xor_b32 v29, 2, v27
    v_lshl_add_u32 v122, v29, 5, v28
    v_add_u32 v126, 0x10000, v122
    v_xor_b32 v29, 3, v27
    v_lshl_add_u32 v123, v29, 5, v28
    v_add_u32 v127, 0x10000, v123
    v_lshrrev_b32 v27, 5, v1
    v_mul_u32_u24 v27, 95, v27
    v_add_u32 v27, s58, v27
    v_lshrrev_b32 v27, 8, v27
    v_min_u32 v27, 7, v27
    v_and_b32 v28, 31, v1
    v_min_u32 v28, 26, v28
    v_mul_u32_u24 v28, 4, v28
    v_lshl_add_u32 v31, v27, 11, v28
    v_mov_b32 v24, 1
    v_mov_b32 v25, 0
    s_mov_b32 s49, 2670592
    s_cmp_eq_u32 s32, 0
    s_cselect_b32 s36, 1, 0
    s_mov_b32 s37, 0
    s_waitcnt vmcnt(22)
    s_barrier
    ds_read_b64_tr_b16 a[160:161], v4 offset:0
    ds_read_b64_tr_b16 a[162:163], v4 offset:512
    ds_read_b64_tr_b16 a[164:165], v4 offset:4096
    ds_read_b64_tr_b16 a[166:167], v4 offset:4608
    ds_read_b64_tr_b16 a[168:169], v5 offset:0
    ds_read_b64_tr_b16 a[170:171], v5 offset:512
    ds_read_b64_tr_b16 a[172:173], v5 offset:4096
    ds_read_b64_tr_b16 a[174:175], v5 offset:4608
    ds_read_b64_tr_b16 a[176:177], v6 offset:0
    ds_read_b64_tr_b16 a[178:179], v6 offset:512
    ds_read_b64_tr_b16 a[180:181], v6 offset:4096
    ds_read_b64_tr_b16 a[182:183], v6 offset:4608
    ds_read_b64_tr_b16 a[184:185], v7 offset:0
    ds_read_b64_tr_b16 a[186:187], v7 offset:512
    ds_read_b64_tr_b16 a[188:189], v7 offset:4096
    ds_read_b64_tr_b16 a[190:191], v7 offset:4608
    s_waitcnt vmcnt(16)
    s_waitcnt lgkmcnt(0)
    s_barrier
    v_mfma_f32_16x16x32_bf16 v[128:131], a[160:163], a[0:3], 0
    ds_read_b64_tr_b16 a[192:193], v4 offset:8192
    v_mfma_f32_16x16x32_bf16 v[132:135], a[160:163], a[4:7], 0
    ds_read_b64_tr_b16 a[194:195], v4 offset:8704
    v_mfma_f32_16x16x32_bf16 v[136:139], a[160:163], a[8:11], 0
    s_add_u32 m0, s40, 32768
    s_mov_b32 s41, 442368
    buffer_load_dwordx4 v3, s[8:11], s41 offen lds
    v_mfma_f32_16x16x32_bf16 v[140:143], a[160:163], a[12:15], 0
    ds_read_b64_tr_b16 a[196:197], v4 offset:12288
    v_mfma_f32_16x16x32_bf16 v[192:195], a[164:167], a[0:3], 0
    ds_read_b64_tr_b16 a[198:199], v4 offset:12800
    v_mfma_f32_16x16x32_bf16 v[196:199], a[164:167], a[4:7], 0
    ds_read_b64_tr_b16 a[200:201], v5 offset:8192
    v_mfma_f32_16x16x32_bf16 v[200:203], a[164:167], a[8:11], 0
    s_add_u32 m0, s40, 36864
    s_mov_b32 s41, 442368
    buffer_load_dwordx4 v3, s[12:15], s41 offen lds
    v_mfma_f32_16x16x32_bf16 v[204:207], a[164:167], a[12:15], 0
    ds_read_b64_tr_b16 a[202:203], v5 offset:8704
    v_mfma_f32_16x16x32_bf16 v[144:147], a[168:171], a[0:3], 0
    ds_read_b64_tr_b16 a[204:205], v5 offset:12288
    v_mfma_f32_16x16x32_bf16 v[148:151], a[168:171], a[4:7], 0
    ds_read_b64_tr_b16 a[206:207], v5 offset:12800
    v_mfma_f32_16x16x32_bf16 v[152:155], a[168:171], a[8:11], 0
    s_add_u32 m0, s40, 40960
    s_mov_b32 s41, 552960
    buffer_load_dwordx4 v3, s[8:11], s41 offen lds
    v_mfma_f32_16x16x32_bf16 v[156:159], a[168:171], a[12:15], 0
    ds_read_b64_tr_b16 a[208:209], v6 offset:8192
    v_mfma_f32_16x16x32_bf16 v[208:211], a[172:175], a[0:3], 0
    ds_read_b64_tr_b16 a[210:211], v6 offset:8704
    v_mfma_f32_16x16x32_bf16 v[212:215], a[172:175], a[4:7], 0
    ds_read_b64_tr_b16 a[212:213], v6 offset:12288
    v_mfma_f32_16x16x32_bf16 v[216:219], a[172:175], a[8:11], 0
    s_add_u32 m0, s40, 45056
    s_mov_b32 s41, 552960
    buffer_load_dwordx4 v3, s[12:15], s41 offen lds
    v_mfma_f32_16x16x32_bf16 v[220:223], a[172:175], a[12:15], 0
    ds_read_b64_tr_b16 a[214:215], v6 offset:12800
    v_mfma_f32_16x16x32_bf16 v[160:163], a[176:179], a[0:3], 0
    ds_read_b64_tr_b16 a[216:217], v7 offset:8192
    v_mfma_f32_16x16x32_bf16 v[164:167], a[176:179], a[4:7], 0
    ds_read_b64_tr_b16 a[218:219], v7 offset:8704
    v_mfma_f32_16x16x32_bf16 v[168:171], a[176:179], a[8:11], 0
    s_add_u32 m0, s40, 49152
    s_mov_b32 s41, 663552
    buffer_load_dwordx4 v3, s[8:11], s41 offen lds
    v_mfma_f32_16x16x32_bf16 v[172:175], a[176:179], a[12:15], 0
    ds_read_b64_tr_b16 a[220:221], v7 offset:12288
    v_mfma_f32_16x16x32_bf16 v[224:227], a[180:183], a[0:3], 0
    ds_read_b64_tr_b16 a[222:223], v7 offset:12800
    v_mfma_f32_16x16x32_bf16 v[228:231], a[180:183], a[4:7], 0
    v_mfma_f32_16x16x32_bf16 v[232:235], a[180:183], a[8:11], 0
    s_add_u32 m0, s40, 53248
    s_mov_b32 s41, 663552
    buffer_load_dwordx4 v3, s[12:15], s41 offen lds
    v_mfma_f32_16x16x32_bf16 v[236:239], a[180:183], a[12:15], 0
    v_mfma_f32_16x16x32_bf16 v[176:179], a[184:187], a[0:3], 0
    v_mfma_f32_16x16x32_bf16 v[180:183], a[184:187], a[4:7], 0
    v_mfma_f32_16x16x32_bf16 v[184:187], a[184:187], a[8:11], 0
    s_mov_b32 s42, 3293184
    buffer_load_dwordx4 a[64:67], v2, s[24:27], s42 offen offset:0
    v_mfma_f32_16x16x32_bf16 v[188:191], a[184:187], a[12:15], 0
    v_mfma_f32_16x16x32_bf16 v[240:243], a[188:191], a[0:3], 0
    v_mfma_f32_16x16x32_bf16 v[244:247], a[188:191], a[4:7], 0
    v_mfma_f32_16x16x32_bf16 v[248:251], a[188:191], a[8:11], 0
    buffer_load_dwordx4 a[68:71], v2, s[24:27], s42 offen offset:256
    v_mfma_f32_16x16x32_bf16 v[252:255], a[188:191], a[12:15], 0
    s_waitcnt vmcnt(12)
    s_waitcnt lgkmcnt(0)
    s_barrier
    v_mfma_f32_16x16x32_bf16 v[128:131], a[192:195], a[16:19], v[128:131]
    ds_read_b64_tr_b16 a[160:161], v4 offset:16384
    v_mfma_f32_16x16x32_bf16 v[132:135], a[192:195], a[20:23], v[132:135]
    ds_read_b64_tr_b16 a[162:163], v4 offset:16896
    v_mfma_f32_16x16x32_bf16 v[136:139], a[192:195], a[24:27], v[136:139]
    buffer_load_dwordx4 a[72:75], v2, s[24:27], s42 offen offset:512
    v_mfma_f32_16x16x32_bf16 v[140:143], a[192:195], a[28:31], v[140:143]
    ds_read_b64_tr_b16 a[164:165], v4 offset:20480
    v_mfma_f32_16x16x32_bf16 v[192:195], a[196:199], a[16:19], v[192:195]
    ds_read_b64_tr_b16 a[166:167], v4 offset:20992
    v_mfma_f32_16x16x32_bf16 v[196:199], a[196:199], a[20:23], v[196:199]
    ds_read_b64_tr_b16 a[168:169], v5 offset:16384
    v_mfma_f32_16x16x32_bf16 v[200:203], a[196:199], a[24:27], v[200:203]
    ds_read_b64_tr_b16 a[170:171], v5 offset:16896
    v_mfma_f32_16x16x32_bf16 v[204:207], a[196:199], a[28:31], v[204:207]
    buffer_load_dwordx4 a[76:79], v2, s[24:27], s42 offen offset:768
    v_mfma_f32_16x16x32_bf16 v[144:147], a[200:203], a[16:19], v[144:147]
    ds_read_b64_tr_b16 a[172:173], v5 offset:20480
    v_mfma_f32_16x16x32_bf16 v[148:151], a[200:203], a[20:23], v[148:151]
    ds_read_b64_tr_b16 a[174:175], v5 offset:20992
    v_mfma_f32_16x16x32_bf16 v[152:155], a[200:203], a[24:27], v[152:155]
    ds_read_b64_tr_b16 a[176:177], v6 offset:16384
    v_mfma_f32_16x16x32_bf16 v[156:159], a[200:203], a[28:31], v[156:159]
    s_mov_b32 s42, 3424256
    buffer_load_dwordx4 a[80:83], v2, s[24:27], s42 offen offset:0
    v_mfma_f32_16x16x32_bf16 v[208:211], a[204:207], a[16:19], v[208:211]
    ds_read_b64_tr_b16 a[178:179], v6 offset:16896
    v_mfma_f32_16x16x32_bf16 v[212:215], a[204:207], a[20:23], v[212:215]
    ds_read_b64_tr_b16 a[180:181], v6 offset:20480
    v_mfma_f32_16x16x32_bf16 v[216:219], a[204:207], a[24:27], v[216:219]
    ds_read_b64_tr_b16 a[182:183], v6 offset:20992
    v_mfma_f32_16x16x32_bf16 v[220:223], a[204:207], a[28:31], v[220:223]
    ds_read_b64_tr_b16 a[184:185], v7 offset:16384
    v_mfma_f32_16x16x32_bf16 v[160:163], a[208:211], a[16:19], v[160:163]
    buffer_load_dwordx4 a[84:87], v2, s[24:27], s42 offen offset:256
    v_mfma_f32_16x16x32_bf16 v[164:167], a[208:211], a[20:23], v[164:167]
    ds_read_b64_tr_b16 a[186:187], v7 offset:16896
    v_mfma_f32_16x16x32_bf16 v[168:171], a[208:211], a[24:27], v[168:171]
    ds_read_b64_tr_b16 a[188:189], v7 offset:20480
    v_mfma_f32_16x16x32_bf16 v[172:175], a[208:211], a[28:31], v[172:175]
    ds_read_b64_tr_b16 a[190:191], v7 offset:20992
    v_mfma_f32_16x16x32_bf16 v[224:227], a[212:215], a[16:19], v[224:227]
    v_mfma_f32_16x16x32_bf16 v[228:231], a[212:215], a[20:23], v[228:231]
    buffer_load_dwordx4 a[88:91], v2, s[24:27], s42 offen offset:512
    v_mfma_f32_16x16x32_bf16 v[232:235], a[212:215], a[24:27], v[232:235]
    v_mfma_f32_16x16x32_bf16 v[236:239], a[212:215], a[28:31], v[236:239]
    v_mfma_f32_16x16x32_bf16 v[176:179], a[216:219], a[16:19], v[176:179]
    v_mfma_f32_16x16x32_bf16 v[180:183], a[216:219], a[20:23], v[180:183]
    buffer_load_dwordx4 a[92:95], v2, s[24:27], s42 offen offset:768
    v_mfma_f32_16x16x32_bf16 v[184:187], a[216:219], a[24:27], v[184:187]
    v_mfma_f32_16x16x32_bf16 v[188:191], a[216:219], a[28:31], v[188:191]
    v_mfma_f32_16x16x32_bf16 v[240:243], a[220:223], a[16:19], v[240:243]
    v_mfma_f32_16x16x32_bf16 v[244:247], a[220:223], a[20:23], v[244:247]
    v_mfma_f32_16x16x32_bf16 v[248:251], a[220:223], a[24:27], v[248:251]
    s_mov_b32 s42, 3555328
    buffer_load_dwordx4 a[96:99], v2, s[24:27], s42 offen offset:0
    v_mfma_f32_16x16x32_bf16 v[252:255], a[220:223], a[28:31], v[252:255]
    s_waitcnt lgkmcnt(0)
    v_mfma_f32_16x16x32_bf16 v[128:131], a[160:163], a[32:35], v[128:131]
    ds_read_b64_tr_b16 a[192:193], v4 offset:24576
    v_mfma_f32_16x16x32_bf16 v[132:135], a[160:163], a[36:39], v[132:135]
    ds_read_b64_tr_b16 a[194:195], v4 offset:25088
    v_mfma_f32_16x16x32_bf16 v[136:139], a[160:163], a[40:43], v[136:139]
    buffer_load_dwordx4 a[100:103], v2, s[24:27], s42 offen offset:256
    v_mfma_f32_16x16x32_bf16 v[140:143], a[160:163], a[44:47], v[140:143]
    ds_read_b64_tr_b16 a[196:197], v4 offset:28672
    v_mfma_f32_16x16x32_bf16 v[192:195], a[164:167], a[32:35], v[192:195]
    ds_read_b64_tr_b16 a[198:199], v4 offset:29184
    v_mfma_f32_16x16x32_bf16 v[196:199], a[164:167], a[36:39], v[196:199]
    ds_read_b64_tr_b16 a[200:201], v5 offset:24576
    v_mfma_f32_16x16x32_bf16 v[200:203], a[164:167], a[40:43], v[200:203]
    ds_read_b64_tr_b16 a[202:203], v5 offset:25088
    v_mfma_f32_16x16x32_bf16 v[204:207], a[164:167], a[44:47], v[204:207]
    buffer_load_dwordx4 a[104:107], v2, s[24:27], s42 offen offset:512
    v_mfma_f32_16x16x32_bf16 v[144:147], a[168:171], a[32:35], v[144:147]
    ds_read_b64_tr_b16 a[204:205], v5 offset:28672
    v_mfma_f32_16x16x32_bf16 v[148:151], a[168:171], a[36:39], v[148:151]
    ds_read_b64_tr_b16 a[206:207], v5 offset:29184
    v_mfma_f32_16x16x32_bf16 v[152:155], a[168:171], a[40:43], v[152:155]
    ds_read_b64_tr_b16 a[208:209], v6 offset:24576
    v_mfma_f32_16x16x32_bf16 v[156:159], a[168:171], a[44:47], v[156:159]
    buffer_load_dwordx4 a[108:111], v2, s[24:27], s42 offen offset:768
    v_mfma_f32_16x16x32_bf16 v[208:211], a[172:175], a[32:35], v[208:211]
    ds_read_b64_tr_b16 a[210:211], v6 offset:25088
    v_mfma_f32_16x16x32_bf16 v[212:215], a[172:175], a[36:39], v[212:215]
    ds_read_b64_tr_b16 a[212:213], v6 offset:28672
    v_mfma_f32_16x16x32_bf16 v[216:219], a[172:175], a[40:43], v[216:219]
    ds_read_b64_tr_b16 a[214:215], v6 offset:29184
    v_mfma_f32_16x16x32_bf16 v[220:223], a[172:175], a[44:47], v[220:223]
    ds_read_b64_tr_b16 a[216:217], v7 offset:24576
    v_mfma_f32_16x16x32_bf16 v[160:163], a[176:179], a[32:35], v[160:163]
    s_add_u32 m0, s40, 57344
    s_mov_b32 s41, 774144
    buffer_load_dwordx4 v3, s[8:11], s41 offen lds
    v_mfma_f32_16x16x32_bf16 v[164:167], a[176:179], a[36:39], v[164:167]
    ds_read_b64_tr_b16 a[218:219], v7 offset:25088
    v_mfma_f32_16x16x32_bf16 v[168:171], a[176:179], a[40:43], v[168:171]
    ds_read_b64_tr_b16 a[220:221], v7 offset:28672
    v_mfma_f32_16x16x32_bf16 v[172:175], a[176:179], a[44:47], v[172:175]
    ds_read_b64_tr_b16 a[222:223], v7 offset:29184
    v_mfma_f32_16x16x32_bf16 v[224:227], a[180:183], a[32:35], v[224:227]
    v_mfma_f32_16x16x32_bf16 v[228:231], a[180:183], a[36:39], v[228:231]
    s_add_u32 m0, s40, 61440
    s_mov_b32 s41, 774144
    buffer_load_dwordx4 v3, s[12:15], s41 offen lds
    v_mfma_f32_16x16x32_bf16 v[232:235], a[180:183], a[40:43], v[232:235]
    v_mfma_f32_16x16x32_bf16 v[236:239], a[180:183], a[44:47], v[236:239]
    v_mfma_f32_16x16x32_bf16 v[176:179], a[184:187], a[32:35], v[176:179]
    v_mfma_f32_16x16x32_bf16 v[180:183], a[184:187], a[36:39], v[180:183]
    s_add_u32 m0, s40, 65536
    s_mov_b32 s41, 884736
    buffer_load_dwordx4 v3, s[8:11], s41 offen lds
    v_mfma_f32_16x16x32_bf16 v[184:187], a[184:187], a[40:43], v[184:187]
    v_mfma_f32_16x16x32_bf16 v[188:191], a[184:187], a[44:47], v[188:191]
    v_mfma_f32_16x16x32_bf16 v[240:243], a[188:191], a[32:35], v[240:243]
    v_mfma_f32_16x16x32_bf16 v[244:247], a[188:191], a[36:39], v[244:247]
    v_mfma_f32_16x16x32_bf16 v[248:251], a[188:191], a[40:43], v[248:251]
    s_add_u32 m0, s40, 69632
    s_mov_b32 s41, 884736
    buffer_load_dwordx4 v3, s[12:15], s41 offen lds
    v_mfma_f32_16x16x32_bf16 v[252:255], a[188:191], a[44:47], v[252:255]
    s_waitcnt vmcnt(16)
    s_waitcnt lgkmcnt(0)
    s_barrier
    v_mfma_f32_16x16x32_bf16 v[128:131], a[192:195], a[48:51], v[128:131]
    ds_read_b64_tr_b16 a[160:161], v4 offset:32768
    v_mfma_f32_16x16x32_bf16 v[132:135], a[192:195], a[52:55], v[132:135]
    ds_read_b64_tr_b16 a[162:163], v4 offset:33280
    v_mfma_f32_16x16x32_bf16 v[136:139], a[192:195], a[56:59], v[136:139]
    s_add_u32 m0, s40, 73728
    s_mov_b32 s41, 995328
    buffer_load_dwordx4 v3, s[8:11], s41 offen lds
    v_mfma_f32_16x16x32_bf16 v[140:143], a[192:195], a[60:63], v[140:143]
    ds_read_b64_tr_b16 a[164:165], v4 offset:36864
    v_mfma_f32_16x16x32_bf16 v[192:195], a[196:199], a[48:51], v[192:195]
    ds_read_b64_tr_b16 a[166:167], v4 offset:37376
    v_mfma_f32_16x16x32_bf16 v[196:199], a[196:199], a[52:55], v[196:199]
    ds_read_b64_tr_b16 a[168:169], v5 offset:32768
    v_mfma_f32_16x16x32_bf16 v[200:203], a[196:199], a[56:59], v[200:203]
    ds_read_b64_tr_b16 a[170:171], v5 offset:33280
    v_mfma_f32_16x16x32_bf16 v[204:207], a[196:199], a[60:63], v[204:207]
    s_add_u32 m0, s40, 77824
    s_mov_b32 s41, 995328
    buffer_load_dwordx4 v3, s[12:15], s41 offen lds
    v_mfma_f32_16x16x32_bf16 v[144:147], a[200:203], a[48:51], v[144:147]
    ds_read_b64_tr_b16 a[172:173], v5 offset:36864
    v_mfma_f32_16x16x32_bf16 v[148:151], a[200:203], a[52:55], v[148:151]
    ds_read_b64_tr_b16 a[174:175], v5 offset:37376
    v_mfma_f32_16x16x32_bf16 v[152:155], a[200:203], a[56:59], v[152:155]
    ds_read_b64_tr_b16 a[176:177], v6 offset:32768
    v_mfma_f32_16x16x32_bf16 v[156:159], a[200:203], a[60:63], v[156:159]
    s_mov_b32 s42, 3686400
    buffer_load_dwordx4 a[112:115], v2, s[24:27], s42 offen offset:0
    v_mfma_f32_16x16x32_bf16 v[208:211], a[204:207], a[48:51], v[208:211]
    ds_read_b64_tr_b16 a[178:179], v6 offset:33280
    v_mfma_f32_16x16x32_bf16 v[212:215], a[204:207], a[52:55], v[212:215]
    ds_read_b64_tr_b16 a[180:181], v6 offset:36864
    v_mfma_f32_16x16x32_bf16 v[216:219], a[204:207], a[56:59], v[216:219]
    ds_read_b64_tr_b16 a[182:183], v6 offset:37376
    v_mfma_f32_16x16x32_bf16 v[220:223], a[204:207], a[60:63], v[220:223]
    ds_read_b64_tr_b16 a[184:185], v7 offset:32768
    v_mfma_f32_16x16x32_bf16 v[160:163], a[208:211], a[48:51], v[160:163]
    buffer_load_dwordx4 a[116:119], v2, s[24:27], s42 offen offset:256
    v_mfma_f32_16x16x32_bf16 v[164:167], a[208:211], a[52:55], v[164:167]
    ds_read_b64_tr_b16 a[186:187], v7 offset:33280
    v_mfma_f32_16x16x32_bf16 v[168:171], a[208:211], a[56:59], v[168:171]
    ds_read_b64_tr_b16 a[188:189], v7 offset:36864
    v_mfma_f32_16x16x32_bf16 v[172:175], a[208:211], a[60:63], v[172:175]
    ds_read_b64_tr_b16 a[190:191], v7 offset:37376
    v_mfma_f32_16x16x32_bf16 v[224:227], a[212:215], a[48:51], v[224:227]
    v_mfma_f32_16x16x32_bf16 v[228:231], a[212:215], a[52:55], v[228:231]
    buffer_load_dwordx4 a[120:123], v2, s[24:27], s42 offen offset:512
    v_mfma_f32_16x16x32_bf16 v[232:235], a[212:215], a[56:59], v[232:235]
    v_mfma_f32_16x16x32_bf16 v[236:239], a[212:215], a[60:63], v[236:239]
    v_mfma_f32_16x16x32_bf16 v[176:179], a[216:219], a[48:51], v[176:179]
    v_mfma_f32_16x16x32_bf16 v[180:183], a[216:219], a[52:55], v[180:183]
    buffer_load_dwordx4 a[124:127], v2, s[24:27], s42 offen offset:768
    v_mfma_f32_16x16x32_bf16 v[184:187], a[216:219], a[56:59], v[184:187]
    v_mfma_f32_16x16x32_bf16 v[188:191], a[216:219], a[60:63], v[188:191]
    v_mfma_f32_16x16x32_bf16 v[240:243], a[220:223], a[48:51], v[240:243]
    v_mfma_f32_16x16x32_bf16 v[244:247], a[220:223], a[52:55], v[244:247]
    v_mfma_f32_16x16x32_bf16 v[248:251], a[220:223], a[56:59], v[248:251]
    s_mov_b32 s42, 3817472
    buffer_load_dwordx4 a[128:131], v2, s[24:27], s42 offen offset:0
    v_mfma_f32_16x16x32_bf16 v[252:255], a[220:223], a[60:63], v[252:255]
    s_waitcnt vmcnt(19)
    s_waitcnt lgkmcnt(0)
    v_mfma_f32_16x16x32_bf16 v[128:131], a[160:163], a[64:67], v[128:131]
    ds_read_b64_tr_b16 a[192:193], v4 offset:40960
    v_mfma_f32_16x16x32_bf16 v[132:135], a[160:163], a[68:71], v[132:135]
    ds_read_b64_tr_b16 a[194:195], v4 offset:41472
    v_mfma_f32_16x16x32_bf16 v[136:139], a[160:163], a[72:75], v[136:139]
    buffer_load_dwordx4 a[132:135], v2, s[24:27], s42 offen offset:256
    v_mfma_f32_16x16x32_bf16 v[140:143], a[160:163], a[76:79], v[140:143]
    ds_read_b64_tr_b16 a[196:197], v4 offset:45056
    v_mfma_f32_16x16x32_bf16 v[192:195], a[164:167], a[64:67], v[192:195]
    ds_read_b64_tr_b16 a[198:199], v4 offset:45568
    v_mfma_f32_16x16x32_bf16 v[196:199], a[164:167], a[68:71], v[196:199]
    ds_read_b64_tr_b16 a[200:201], v5 offset:40960
    v_mfma_f32_16x16x32_bf16 v[200:203], a[164:167], a[72:75], v[200:203]
    buffer_load_dwordx4 a[136:139], v2, s[24:27], s42 offen offset:512
    v_mfma_f32_16x16x32_bf16 v[204:207], a[164:167], a[76:79], v[204:207]
    ds_read_b64_tr_b16 a[202:203], v5 offset:41472
    v_mfma_f32_16x16x32_bf16 v[144:147], a[168:171], a[64:67], v[144:147]
    ds_read_b64_tr_b16 a[204:205], v5 offset:45056
    v_mfma_f32_16x16x32_bf16 v[148:151], a[168:171], a[68:71], v[148:151]
    ds_read_b64_tr_b16 a[206:207], v5 offset:45568
    v_mfma_f32_16x16x32_bf16 v[152:155], a[168:171], a[72:75], v[152:155]
    buffer_load_dwordx4 a[140:143], v2, s[24:27], s42 offen offset:768
    v_mfma_f32_16x16x32_bf16 v[156:159], a[168:171], a[76:79], v[156:159]
    ds_read_b64_tr_b16 a[208:209], v6 offset:40960
    v_mfma_f32_16x16x32_bf16 v[208:211], a[172:175], a[64:67], v[208:211]
    ds_read_b64_tr_b16 a[210:211], v6 offset:41472
    v_mfma_f32_16x16x32_bf16 v[212:215], a[172:175], a[68:71], v[212:215]
    ds_read_b64_tr_b16 a[212:213], v6 offset:45056
    v_mfma_f32_16x16x32_bf16 v[216:219], a[172:175], a[72:75], v[216:219]
    s_mov_b32 s42, 3948544
    buffer_load_dwordx4 a[144:147], v2, s[24:27], s42 offen offset:0
    v_mfma_f32_16x16x32_bf16 v[220:223], a[172:175], a[76:79], v[220:223]
    ds_read_b64_tr_b16 a[214:215], v6 offset:45568
    v_mfma_f32_16x16x32_bf16 v[160:163], a[176:179], a[64:67], v[160:163]
    ds_read_b64_tr_b16 a[216:217], v7 offset:40960
    v_mfma_f32_16x16x32_bf16 v[164:167], a[176:179], a[68:71], v[164:167]
    ds_read_b64_tr_b16 a[218:219], v7 offset:41472
    v_mfma_f32_16x16x32_bf16 v[168:171], a[176:179], a[72:75], v[168:171]
    buffer_load_dwordx4 a[148:151], v2, s[24:27], s42 offen offset:256
    v_mfma_f32_16x16x32_bf16 v[172:175], a[176:179], a[76:79], v[172:175]
    ds_read_b64_tr_b16 a[220:221], v7 offset:45056
    v_mfma_f32_16x16x32_bf16 v[224:227], a[180:183], a[64:67], v[224:227]
    ds_read_b64_tr_b16 a[222:223], v7 offset:45568
    v_mfma_f32_16x16x32_bf16 v[228:231], a[180:183], a[68:71], v[228:231]
    v_mfma_f32_16x16x32_bf16 v[232:235], a[180:183], a[72:75], v[232:235]
    buffer_load_dwordx4 a[152:155], v2, s[24:27], s42 offen offset:512
    v_mfma_f32_16x16x32_bf16 v[236:239], a[180:183], a[76:79], v[236:239]
    v_mfma_f32_16x16x32_bf16 v[176:179], a[184:187], a[64:67], v[176:179]
    v_mfma_f32_16x16x32_bf16 v[180:183], a[184:187], a[68:71], v[180:183]
    v_mfma_f32_16x16x32_bf16 v[184:187], a[184:187], a[72:75], v[184:187]
    buffer_load_dwordx4 a[156:159], v2, s[24:27], s42 offen offset:768
    v_mfma_f32_16x16x32_bf16 v[188:191], a[184:187], a[76:79], v[188:191]
    v_mfma_f32_16x16x32_bf16 v[240:243], a[188:191], a[64:67], v[240:243]
    v_mfma_f32_16x16x32_bf16 v[244:247], a[188:191], a[68:71], v[244:247]
    v_mfma_f32_16x16x32_bf16 v[248:251], a[188:191], a[72:75], v[248:251]
    s_add_u32 m0, s40, 81920
    s_mov_b32 s41, 1105920
    buffer_load_dwordx4 v3, s[8:11], s41 offen lds
    v_mfma_f32_16x16x32_bf16 v[252:255], a[188:191], a[76:79], v[252:255]
    s_waitcnt vmcnt(23)
    s_waitcnt lgkmcnt(0)
    v_mfma_f32_16x16x32_bf16 v[128:131], a[192:195], a[80:83], v[128:131]
    ds_read_b64_tr_b16 a[160:161], v4 offset:49152
    v_mfma_f32_16x16x32_bf16 v[132:135], a[192:195], a[84:87], v[132:135]
    ds_read_b64_tr_b16 a[162:163], v4 offset:49664
    v_mfma_f32_16x16x32_bf16 v[136:139], a[192:195], a[88:91], v[136:139]
    s_add_u32 m0, s40, 86016
    s_mov_b32 s41, 1105920
    buffer_load_dwordx4 v3, s[12:15], s41 offen lds
    v_mfma_f32_16x16x32_bf16 v[140:143], a[192:195], a[92:95], v[140:143]
    ds_read_b64_tr_b16 a[164:165], v4 offset:53248
    v_mfma_f32_16x16x32_bf16 v[192:195], a[196:199], a[80:83], v[192:195]
    ds_read_b64_tr_b16 a[166:167], v4 offset:53760
    v_mfma_f32_16x16x32_bf16 v[196:199], a[196:199], a[84:87], v[196:199]
    ds_read_b64_tr_b16 a[168:169], v5 offset:49152
    v_mfma_f32_16x16x32_bf16 v[200:203], a[196:199], a[88:91], v[200:203]
    ds_read_b64_tr_b16 a[170:171], v5 offset:49664
    v_mfma_f32_16x16x32_bf16 v[204:207], a[196:199], a[92:95], v[204:207]
    s_add_u32 m0, s40, 90112
    s_mov_b32 s41, 1216512
    buffer_load_dwordx4 v3, s[8:11], s41 offen lds
    v_mfma_f32_16x16x32_bf16 v[144:147], a[200:203], a[80:83], v[144:147]
    ds_read_b64_tr_b16 a[172:173], v5 offset:53248
    v_mfma_f32_16x16x32_bf16 v[148:151], a[200:203], a[84:87], v[148:151]
    ds_read_b64_tr_b16 a[174:175], v5 offset:53760
    v_mfma_f32_16x16x32_bf16 v[152:155], a[200:203], a[88:91], v[152:155]
    ds_read_b64_tr_b16 a[176:177], v6 offset:49152
    v_mfma_f32_16x16x32_bf16 v[156:159], a[200:203], a[92:95], v[156:159]
    s_add_u32 m0, s40, 94208
    s_mov_b32 s41, 1216512
    buffer_load_dwordx4 v3, s[12:15], s41 offen lds
    v_mfma_f32_16x16x32_bf16 v[208:211], a[204:207], a[80:83], v[208:211]
    ds_read_b64_tr_b16 a[178:179], v6 offset:49664
    v_mfma_f32_16x16x32_bf16 v[212:215], a[204:207], a[84:87], v[212:215]
    ds_read_b64_tr_b16 a[180:181], v6 offset:53248
    v_mfma_f32_16x16x32_bf16 v[216:219], a[204:207], a[88:91], v[216:219]
    ds_read_b64_tr_b16 a[182:183], v6 offset:53760
    v_mfma_f32_16x16x32_bf16 v[220:223], a[204:207], a[92:95], v[220:223]
    ds_read_b64_tr_b16 a[184:185], v7 offset:49152
    v_mfma_f32_16x16x32_bf16 v[160:163], a[208:211], a[80:83], v[160:163]
    s_add_u32 m0, s40, 98304
    s_mov_b32 s41, 1327104
    buffer_load_dwordx4 v3, s[8:11], s41 offen lds
    v_mfma_f32_16x16x32_bf16 v[164:167], a[208:211], a[84:87], v[164:167]
    ds_read_b64_tr_b16 a[186:187], v7 offset:49664
    v_mfma_f32_16x16x32_bf16 v[168:171], a[208:211], a[88:91], v[168:171]
    ds_read_b64_tr_b16 a[188:189], v7 offset:53248
    v_mfma_f32_16x16x32_bf16 v[172:175], a[208:211], a[92:95], v[172:175]
    ds_read_b64_tr_b16 a[190:191], v7 offset:53760
    v_mfma_f32_16x16x32_bf16 v[224:227], a[212:215], a[80:83], v[224:227]
    v_mfma_f32_16x16x32_bf16 v[228:231], a[212:215], a[84:87], v[228:231]
    s_add_u32 m0, s40, 102400
    s_mov_b32 s41, 1327104
    buffer_load_dwordx4 v3, s[12:15], s41 offen lds
    v_mfma_f32_16x16x32_bf16 v[232:235], a[212:215], a[88:91], v[232:235]
    v_mfma_f32_16x16x32_bf16 v[236:239], a[212:215], a[92:95], v[236:239]
    v_mfma_f32_16x16x32_bf16 v[176:179], a[216:219], a[80:83], v[176:179]
    v_mfma_f32_16x16x32_bf16 v[180:183], a[216:219], a[84:87], v[180:183]
    s_add_u32 m0, s40, 106496
    s_mov_b32 s41, 1437696
    buffer_load_dwordx4 v3, s[8:11], s41 offen lds
    v_mfma_f32_16x16x32_bf16 v[184:187], a[216:219], a[88:91], v[184:187]
    v_mfma_f32_16x16x32_bf16 v[188:191], a[216:219], a[92:95], v[188:191]
    v_mfma_f32_16x16x32_bf16 v[240:243], a[220:223], a[80:83], v[240:243]
    v_mfma_f32_16x16x32_bf16 v[244:247], a[220:223], a[84:87], v[244:247]
    v_mfma_f32_16x16x32_bf16 v[248:251], a[220:223], a[88:91], v[248:251]
    s_add_u32 m0, s40, 110592
    s_mov_b32 s41, 1437696
    buffer_load_dwordx4 v3, s[12:15], s41 offen lds
    v_mfma_f32_16x16x32_bf16 v[252:255], a[220:223], a[92:95], v[252:255]
    s_waitcnt vmcnt(20)
    s_waitcnt lgkmcnt(0)
    s_barrier
    v_mfma_f32_16x16x32_bf16 v[128:131], a[160:163], a[96:99], v[128:131]
    ds_read_b64_tr_b16 a[192:193], v4 offset:57344
    v_mfma_f32_16x16x32_bf16 v[132:135], a[160:163], a[100:103], v[132:135]
    ds_read_b64_tr_b16 a[194:195], v4 offset:57856
    v_mfma_f32_16x16x32_bf16 v[136:139], a[160:163], a[104:107], v[136:139]
    s_mov_b32 s42, 4079616
    buffer_load_dwordx4 a[0:3], v2, s[24:27], s42 offen offset:0
    v_mfma_f32_16x16x32_bf16 v[140:143], a[160:163], a[108:111], v[140:143]
    ds_read_b64_tr_b16 a[196:197], v4 offset:61440
    v_mfma_f32_16x16x32_bf16 v[192:195], a[164:167], a[96:99], v[192:195]
    ds_read_b64_tr_b16 a[198:199], v4 offset:61952
    v_mfma_f32_16x16x32_bf16 v[196:199], a[164:167], a[100:103], v[196:199]
    ds_read_b64_tr_b16 a[200:201], v5 offset:57344
    v_mfma_f32_16x16x32_bf16 v[200:203], a[164:167], a[104:107], v[200:203]
    ds_read_b64_tr_b16 a[202:203], v5 offset:57856
    v_mfma_f32_16x16x32_bf16 v[204:207], a[164:167], a[108:111], v[204:207]
    buffer_load_dwordx4 a[4:7], v2, s[24:27], s42 offen offset:256
    v_mfma_f32_16x16x32_bf16 v[144:147], a[168:171], a[96:99], v[144:147]
    ds_read_b64_tr_b16 a[204:205], v5 offset:61440
    v_mfma_f32_16x16x32_bf16 v[148:151], a[168:171], a[100:103], v[148:151]
    ds_read_b64_tr_b16 a[206:207], v5 offset:61952
    v_mfma_f32_16x16x32_bf16 v[152:155], a[168:171], a[104:107], v[152:155]
    ds_read_b64_tr_b16 a[208:209], v6 offset:57344
    v_mfma_f32_16x16x32_bf16 v[156:159], a[168:171], a[108:111], v[156:159]
    buffer_load_dwordx4 a[8:11], v2, s[24:27], s42 offen offset:512
    v_mfma_f32_16x16x32_bf16 v[208:211], a[172:175], a[96:99], v[208:211]
    ds_read_b64_tr_b16 a[210:211], v6 offset:57856
    v_mfma_f32_16x16x32_bf16 v[212:215], a[172:175], a[100:103], v[212:215]
    ds_read_b64_tr_b16 a[212:213], v6 offset:61440
    v_mfma_f32_16x16x32_bf16 v[216:219], a[172:175], a[104:107], v[216:219]
    ds_read_b64_tr_b16 a[214:215], v6 offset:61952
    v_mfma_f32_16x16x32_bf16 v[220:223], a[172:175], a[108:111], v[220:223]
    ds_read_b64_tr_b16 a[216:217], v7 offset:57344
    v_mfma_f32_16x16x32_bf16 v[160:163], a[176:179], a[96:99], v[160:163]
    buffer_load_dwordx4 a[12:15], v2, s[24:27], s42 offen offset:768
    v_mfma_f32_16x16x32_bf16 v[164:167], a[176:179], a[100:103], v[164:167]
    ds_read_b64_tr_b16 a[218:219], v7 offset:57856
    v_mfma_f32_16x16x32_bf16 v[168:171], a[176:179], a[104:107], v[168:171]
    ds_read_b64_tr_b16 a[220:221], v7 offset:61440
    v_mfma_f32_16x16x32_bf16 v[172:175], a[176:179], a[108:111], v[172:175]
    ds_read_b64_tr_b16 a[222:223], v7 offset:61952
    v_mfma_f32_16x16x32_bf16 v[224:227], a[180:183], a[96:99], v[224:227]
    v_mfma_f32_16x16x32_bf16 v[228:231], a[180:183], a[100:103], v[228:231]
    s_mov_b32 s42, 4210688
    buffer_load_dwordx4 a[16:19], v2, s[24:27], s42 offen offset:0
    v_mfma_f32_16x16x32_bf16 v[232:235], a[180:183], a[104:107], v[232:235]
    v_mfma_f32_16x16x32_bf16 v[236:239], a[180:183], a[108:111], v[236:239]
    v_mfma_f32_16x16x32_bf16 v[176:179], a[184:187], a[96:99], v[176:179]
    v_mfma_f32_16x16x32_bf16 v[180:183], a[184:187], a[100:103], v[180:183]
    buffer_load_dwordx4 a[20:23], v2, s[24:27], s42 offen offset:256
    v_mfma_f32_16x16x32_bf16 v[184:187], a[184:187], a[104:107], v[184:187]
    v_mfma_f32_16x16x32_bf16 v[188:191], a[184:187], a[108:111], v[188:191]
    v_mfma_f32_16x16x32_bf16 v[240:243], a[188:191], a[96:99], v[240:243]
    v_mfma_f32_16x16x32_bf16 v[244:247], a[188:191], a[100:103], v[244:247]
    v_mfma_f32_16x16x32_bf16 v[248:251], a[188:191], a[104:107], v[248:251]
    buffer_load_dwordx4 a[24:27], v2, s[24:27], s42 offen offset:512
    v_mfma_f32_16x16x32_bf16 v[252:255], a[188:191], a[108:111], v[252:255]
    s_waitcnt vmcnt(23)
    s_waitcnt lgkmcnt(0)
    v_mfma_f32_16x16x32_bf16 v[128:131], a[192:195], a[112:115], v[128:131]
    ds_read_b64_tr_b16 a[160:161], v8 offset:0
    v_mfma_f32_16x16x32_bf16 v[132:135], a[192:195], a[116:119], v[132:135]
    ds_read_b64_tr_b16 a[162:163], v8 offset:512
    v_mfma_f32_16x16x32_bf16 v[136:139], a[192:195], a[120:123], v[136:139]
    buffer_load_dwordx4 a[28:31], v2, s[24:27], s42 offen offset:768
    v_mfma_f32_16x16x32_bf16 v[140:143], a[192:195], a[124:127], v[140:143]
    ds_read_b64_tr_b16 a[164:165], v8 offset:4096
    v_mfma_f32_16x16x32_bf16 v[192:195], a[196:199], a[112:115], v[192:195]
    ds_read_b64_tr_b16 a[166:167], v8 offset:4608
    v_mfma_f32_16x16x32_bf16 v[196:199], a[196:199], a[116:119], v[196:199]
    ds_read_b64_tr_b16 a[168:169], v9 offset:0
    v_mfma_f32_16x16x32_bf16 v[200:203], a[196:199], a[120:123], v[200:203]
    ds_read_b64_tr_b16 a[170:171], v9 offset:512
    v_mfma_f32_16x16x32_bf16 v[204:207], a[196:199], a[124:127], v[204:207]
    s_mov_b32 s42, 4341760
    buffer_load_dwordx4 a[32:35], v2, s[24:27], s42 offen offset:0
    v_mfma_f32_16x16x32_bf16 v[144:147], a[200:203], a[112:115], v[144:147]
    ds_read_b64_tr_b16 a[172:173], v9 offset:4096
    v_mfma_f32_16x16x32_bf16 v[148:151], a[200:203], a[116:119], v[148:151]
    ds_read_b64_tr_b16 a[174:175], v9 offset:4608
    v_mfma_f32_16x16x32_bf16 v[152:155], a[200:203], a[120:123], v[152:155]
    ds_read_b64_tr_b16 a[176:177], v10 offset:0
    v_mfma_f32_16x16x32_bf16 v[156:159], a[200:203], a[124:127], v[156:159]
    buffer_load_dwordx4 a[36:39], v2, s[24:27], s42 offen offset:256
    v_mfma_f32_16x16x32_bf16 v[208:211], a[204:207], a[112:115], v[208:211]
    ds_read_b64_tr_b16 a[178:179], v10 offset:512
    v_mfma_f32_16x16x32_bf16 v[212:215], a[204:207], a[116:119], v[212:215]
    ds_read_b64_tr_b16 a[180:181], v10 offset:4096
    v_mfma_f32_16x16x32_bf16 v[216:219], a[204:207], a[120:123], v[216:219]
    ds_read_b64_tr_b16 a[182:183], v10 offset:4608
    v_mfma_f32_16x16x32_bf16 v[220:223], a[204:207], a[124:127], v[220:223]
    ds_read_b64_tr_b16 a[184:185], v11 offset:0
    v_mfma_f32_16x16x32_bf16 v[160:163], a[208:211], a[112:115], v[160:163]
    buffer_load_dwordx4 a[40:43], v2, s[24:27], s42 offen offset:512
    v_mfma_f32_16x16x32_bf16 v[164:167], a[208:211], a[116:119], v[164:167]
    ds_read_b64_tr_b16 a[186:187], v11 offset:512
    v_mfma_f32_16x16x32_bf16 v[168:171], a[208:211], a[120:123], v[168:171]
    ds_read_b64_tr_b16 a[188:189], v11 offset:4096
    v_mfma_f32_16x16x32_bf16 v[172:175], a[208:211], a[124:127], v[172:175]
    ds_read_b64_tr_b16 a[190:191], v11 offset:4608
    v_mfma_f32_16x16x32_bf16 v[224:227], a[212:215], a[112:115], v[224:227]
    v_mfma_f32_16x16x32_bf16 v[228:231], a[212:215], a[116:119], v[228:231]
    buffer_load_dwordx4 a[44:47], v2, s[24:27], s42 offen offset:768
    v_mfma_f32_16x16x32_bf16 v[232:235], a[212:215], a[120:123], v[232:235]
    v_mfma_f32_16x16x32_bf16 v[236:239], a[212:215], a[124:127], v[236:239]
    v_mfma_f32_16x16x32_bf16 v[176:179], a[216:219], a[112:115], v[176:179]
    v_mfma_f32_16x16x32_bf16 v[180:183], a[216:219], a[116:119], v[180:183]
    s_mov_b32 s42, 4472832
    buffer_load_dwordx4 a[48:51], v2, s[24:27], s42 offen offset:0
    v_mfma_f32_16x16x32_bf16 v[184:187], a[216:219], a[120:123], v[184:187]
    v_mfma_f32_16x16x32_bf16 v[188:191], a[216:219], a[124:127], v[188:191]
    v_mfma_f32_16x16x32_bf16 v[240:243], a[220:223], a[112:115], v[240:243]
    v_mfma_f32_16x16x32_bf16 v[244:247], a[220:223], a[116:119], v[244:247]
    v_mfma_f32_16x16x32_bf16 v[248:251], a[220:223], a[120:123], v[248:251]
    buffer_load_dwordx4 a[52:55], v2, s[24:27], s42 offen offset:256
    v_mfma_f32_16x16x32_bf16 v[252:255], a[220:223], a[124:127], v[252:255]
    s_waitcnt vmcnt(26)
    s_waitcnt lgkmcnt(0)
    v_mfma_f32_16x16x32_bf16 v[128:131], a[160:163], a[128:131], v[128:131]
    ds_read_b64_tr_b16 a[192:193], v8 offset:8192
    v_mfma_f32_16x16x32_bf16 v[132:135], a[160:163], a[132:135], v[132:135]
    ds_read_b64_tr_b16 a[194:195], v8 offset:8704
    v_mfma_f32_16x16x32_bf16 v[136:139], a[160:163], a[136:139], v[136:139]
    buffer_load_dwordx4 a[56:59], v2, s[24:27], s42 offen offset:512
    v_mfma_f32_16x16x32_bf16 v[140:143], a[160:163], a[140:143], v[140:143]
    ds_read_b64_tr_b16 a[196:197], v8 offset:12288
    v_mfma_f32_16x16x32_bf16 v[192:195], a[164:167], a[128:131], v[192:195]
    ds_read_b64_tr_b16 a[198:199], v8 offset:12800
    v_mfma_f32_16x16x32_bf16 v[196:199], a[164:167], a[132:135], v[196:199]
    ds_read_b64_tr_b16 a[200:201], v9 offset:8192
    v_mfma_f32_16x16x32_bf16 v[200:203], a[164:167], a[136:139], v[200:203]
    buffer_load_dwordx4 a[60:63], v2, s[24:27], s42 offen offset:768
    v_mfma_f32_16x16x32_bf16 v[204:207], a[164:167], a[140:143], v[204:207]
    ds_read_b64_tr_b16 a[202:203], v9 offset:8704
    v_mfma_f32_16x16x32_bf16 v[144:147], a[168:171], a[128:131], v[144:147]
    ds_read_b64_tr_b16 a[204:205], v9 offset:12288
    v_mfma_f32_16x16x32_bf16 v[148:151], a[168:171], a[132:135], v[148:151]
    ds_read_b64_tr_b16 a[206:207], v9 offset:12800
    v_mfma_f32_16x16x32_bf16 v[152:155], a[168:171], a[136:139], v[152:155]
    s_add_u32 m0, s40, 114688
    s_mov_b32 s41, 1548288
    buffer_load_dwordx4 v3, s[8:11], s41 offen lds
    v_mfma_f32_16x16x32_bf16 v[156:159], a[168:171], a[140:143], v[156:159]
    ds_read_b64_tr_b16 a[208:209], v10 offset:8192
    v_mfma_f32_16x16x32_bf16 v[208:211], a[172:175], a[128:131], v[208:211]
    ds_read_b64_tr_b16 a[210:211], v10 offset:8704
    v_mfma_f32_16x16x32_bf16 v[212:215], a[172:175], a[132:135], v[212:215]
    ds_read_b64_tr_b16 a[212:213], v10 offset:12288
    v_mfma_f32_16x16x32_bf16 v[216:219], a[172:175], a[136:139], v[216:219]
    s_add_u32 m0, s40, 118784
    s_mov_b32 s41, 1548288
    buffer_load_dwordx4 v3, s[12:15], s41 offen lds
    v_mfma_f32_16x16x32_bf16 v[220:223], a[172:175], a[140:143], v[220:223]
    ds_read_b64_tr_b16 a[214:215], v10 offset:12800
    v_mfma_f32_16x16x32_bf16 v[160:163], a[176:179], a[128:131], v[160:163]
    ds_read_b64_tr_b16 a[216:217], v11 offset:8192
    v_mfma_f32_16x16x32_bf16 v[164:167], a[176:179], a[132:135], v[164:167]
    ds_read_b64_tr_b16 a[218:219], v11 offset:8704
    v_mfma_f32_16x16x32_bf16 v[168:171], a[176:179], a[136:139], v[168:171]
    s_add_u32 m0, s40, 122880
    s_mov_b32 s41, 1658880
    buffer_load_dwordx4 v3, s[8:11], s41 offen lds
    v_mfma_f32_16x16x32_bf16 v[172:175], a[176:179], a[140:143], v[172:175]
    ds_read_b64_tr_b16 a[220:221], v11 offset:12288
    v_mfma_f32_16x16x32_bf16 v[224:227], a[180:183], a[128:131], v[224:227]
    ds_read_b64_tr_b16 a[222:223], v11 offset:12800
    v_mfma_f32_16x16x32_bf16 v[228:231], a[180:183], a[132:135], v[228:231]
    v_mfma_f32_16x16x32_bf16 v[232:235], a[180:183], a[136:139], v[232:235]
    s_add_u32 m0, s40, 126976
    s_mov_b32 s41, 1658880
    buffer_load_dwordx4 v3, s[12:15], s41 offen lds
    v_mfma_f32_16x16x32_bf16 v[236:239], a[180:183], a[140:143], v[236:239]
    v_mfma_f32_16x16x32_bf16 v[176:179], a[184:187], a[128:131], v[176:179]
    v_mfma_f32_16x16x32_bf16 v[180:183], a[184:187], a[132:135], v[180:183]
    v_mfma_f32_16x16x32_bf16 v[184:187], a[184:187], a[136:139], v[184:187]
    s_add_u32 m0, s40, 131072
    s_mov_b32 s41, 1769472
    buffer_load_dwordx4 v3, s[8:11], s41 offen lds
    v_mfma_f32_16x16x32_bf16 v[188:191], a[184:187], a[140:143], v[188:191]
    v_mfma_f32_16x16x32_bf16 v[240:243], a[188:191], a[128:131], v[240:243]
    v_mfma_f32_16x16x32_bf16 v[244:247], a[188:191], a[132:135], v[244:247]
    v_mfma_f32_16x16x32_bf16 v[248:251], a[188:191], a[136:139], v[248:251]
    s_add_u32 m0, s40, 135168
    s_mov_b32 s41, 1769472
    buffer_load_dwordx4 v3, s[12:15], s41 offen lds
    v_mfma_f32_16x16x32_bf16 v[252:255], a[188:191], a[140:143], v[252:255]
    s_waitcnt vmcnt(22)
    s_waitcnt lgkmcnt(0)
    s_barrier
    v_mfma_f32_16x16x32_bf16 v[128:131], a[192:195], a[144:147], v[128:131]
    ds_read_b64_tr_b16 a[160:161], v8 offset:16384
    v_mfma_f32_16x16x32_bf16 v[132:135], a[192:195], a[148:151], v[132:135]
    ds_read_b64_tr_b16 a[162:163], v8 offset:16896
    v_mfma_f32_16x16x32_bf16 v[136:139], a[192:195], a[152:155], v[136:139]
    s_add_u32 m0, s40, 139264
    s_mov_b32 s41, 1880064
    buffer_load_dwordx4 v3, s[8:11], s41 offen lds
    v_mfma_f32_16x16x32_bf16 v[140:143], a[192:195], a[156:159], v[140:143]
    ds_read_b64_tr_b16 a[164:165], v8 offset:20480
    v_mfma_f32_16x16x32_bf16 v[192:195], a[196:199], a[144:147], v[192:195]
    ds_read_b64_tr_b16 a[166:167], v8 offset:20992
    v_mfma_f32_16x16x32_bf16 v[196:199], a[196:199], a[148:151], v[196:199]
    ds_read_b64_tr_b16 a[168:169], v9 offset:16384
    v_mfma_f32_16x16x32_bf16 v[200:203], a[196:199], a[152:155], v[200:203]
    ds_read_b64_tr_b16 a[170:171], v9 offset:16896
    v_mfma_f32_16x16x32_bf16 v[204:207], a[196:199], a[156:159], v[204:207]
    s_add_u32 m0, s40, 143360
    s_mov_b32 s41, 1880064
    buffer_load_dwordx4 v3, s[12:15], s41 offen lds
    v_mfma_f32_16x16x32_bf16 v[144:147], a[200:203], a[144:147], v[144:147]
    ds_read_b64_tr_b16 a[172:173], v9 offset:20480
    v_mfma_f32_16x16x32_bf16 v[148:151], a[200:203], a[148:151], v[148:151]
    ds_read_b64_tr_b16 a[174:175], v9 offset:20992
    v_mfma_f32_16x16x32_bf16 v[152:155], a[200:203], a[152:155], v[152:155]
    ds_read_b64_tr_b16 a[176:177], v10 offset:16384
    v_mfma_f32_16x16x32_bf16 v[156:159], a[200:203], a[156:159], v[156:159]
    s_add_u32 m0, s40, 147456
    s_mov_b32 s41, 1990656
    buffer_load_dwordx4 v3, s[8:11], s41 offen lds
    v_mfma_f32_16x16x32_bf16 v[208:211], a[204:207], a[144:147], v[208:211]
    ds_read_b64_tr_b16 a[178:179], v10 offset:16896
    v_mfma_f32_16x16x32_bf16 v[212:215], a[204:207], a[148:151], v[212:215]
    ds_read_b64_tr_b16 a[180:181], v10 offset:20480
    v_mfma_f32_16x16x32_bf16 v[216:219], a[204:207], a[152:155], v[216:219]
    ds_read_b64_tr_b16 a[182:183], v10 offset:20992
    v_mfma_f32_16x16x32_bf16 v[220:223], a[204:207], a[156:159], v[220:223]
    ds_read_b64_tr_b16 a[184:185], v11 offset:16384
    v_mfma_f32_16x16x32_bf16 v[160:163], a[208:211], a[144:147], v[160:163]
    s_add_u32 m0, s40, 151552
    s_mov_b32 s41, 1990656
    buffer_load_dwordx4 v3, s[12:15], s41 offen lds
    v_mfma_f32_16x16x32_bf16 v[164:167], a[208:211], a[148:151], v[164:167]
    ds_read_b64_tr_b16 a[186:187], v11 offset:16896
    v_mfma_f32_16x16x32_bf16 v[168:171], a[208:211], a[152:155], v[168:171]
    ds_read_b64_tr_b16 a[188:189], v11 offset:20480
    v_mfma_f32_16x16x32_bf16 v[172:175], a[208:211], a[156:159], v[172:175]
    ds_read_b64_tr_b16 a[190:191], v11 offset:20992
    v_mfma_f32_16x16x32_bf16 v[224:227], a[212:215], a[144:147], v[224:227]
    v_mfma_f32_16x16x32_bf16 v[228:231], a[212:215], a[148:151], v[228:231]
    s_add_u32 m0, s40, 155648
    s_mov_b32 s41, 2101248
    buffer_load_dwordx4 v3, s[8:11], s41 offen lds
    v_mfma_f32_16x16x32_bf16 v[232:235], a[212:215], a[152:155], v[232:235]
    v_mfma_f32_16x16x32_bf16 v[236:239], a[212:215], a[156:159], v[236:239]
    v_mfma_f32_16x16x32_bf16 v[176:179], a[216:219], a[144:147], v[176:179]
    v_mfma_f32_16x16x32_bf16 v[180:183], a[216:219], a[148:151], v[180:183]
    s_add_u32 m0, s40, 159744
    s_mov_b32 s41, 2101248
    buffer_load_dwordx4 v3, s[12:15], s41 offen lds
    v_mfma_f32_16x16x32_bf16 v[184:187], a[216:219], a[152:155], v[184:187]
    v_mfma_f32_16x16x32_bf16 v[188:191], a[216:219], a[156:159], v[188:191]
    v_mfma_f32_16x16x32_bf16 v[240:243], a[220:223], a[144:147], v[240:243]
    v_mfma_f32_16x16x32_bf16 v[244:247], a[220:223], a[148:151], v[244:247]
    v_mfma_f32_16x16x32_bf16 v[248:251], a[220:223], a[152:155], v[248:251]
    s_mov_b32 s42, 4603904
    buffer_load_dwordx4 a[64:67], v2, s[24:27], s42 offen offset:0
    v_mfma_f32_16x16x32_bf16 v[252:255], a[220:223], a[156:159], v[252:255]
    s_waitcnt vmcnt(25)
    s_waitcnt lgkmcnt(0)
    v_mfma_f32_16x16x32_bf16 v[128:131], a[160:163], a[0:3], v[128:131]
    ds_read_b64_tr_b16 a[192:193], v8 offset:24576
    v_mfma_f32_16x16x32_bf16 v[132:135], a[160:163], a[4:7], v[132:135]
    ds_read_b64_tr_b16 a[194:195], v8 offset:25088
    v_mfma_f32_16x16x32_bf16 v[136:139], a[160:163], a[8:11], v[136:139]
    buffer_load_dwordx4 a[68:71], v2, s[24:27], s42 offen offset:256
    v_mfma_f32_16x16x32_bf16 v[140:143], a[160:163], a[12:15], v[140:143]
    ds_read_b64_tr_b16 a[196:197], v8 offset:28672
    v_mfma_f32_16x16x32_bf16 v[192:195], a[164:167], a[0:3], v[192:195]
    ds_read_b64_tr_b16 a[198:199], v8 offset:29184
    v_mfma_f32_16x16x32_bf16 v[196:199], a[164:167], a[4:7], v[196:199]
    ds_read_b64_tr_b16 a[200:201], v9 offset:24576
    v_mfma_f32_16x16x32_bf16 v[200:203], a[164:167], a[8:11], v[200:203]
    ds_read_b64_tr_b16 a[202:203], v9 offset:25088
    v_mfma_f32_16x16x32_bf16 v[204:207], a[164:167], a[12:15], v[204:207]
    buffer_load_dwordx4 a[72:75], v2, s[24:27], s42 offen offset:512
    v_mfma_f32_16x16x32_bf16 v[144:147], a[168:171], a[0:3], v[144:147]
    ds_read_b64_tr_b16 a[204:205], v9 offset:28672
    v_mfma_f32_16x16x32_bf16 v[148:151], a[168:171], a[4:7], v[148:151]
    ds_read_b64_tr_b16 a[206:207], v9 offset:29184
    v_mfma_f32_16x16x32_bf16 v[152:155], a[168:171], a[8:11], v[152:155]
    ds_read_b64_tr_b16 a[208:209], v10 offset:24576
    v_mfma_f32_16x16x32_bf16 v[156:159], a[168:171], a[12:15], v[156:159]
    buffer_load_dwordx4 a[76:79], v2, s[24:27], s42 offen offset:768
    v_mfma_f32_16x16x32_bf16 v[208:211], a[172:175], a[0:3], v[208:211]
    ds_read_b64_tr_b16 a[210:211], v10 offset:25088
    v_mfma_f32_16x16x32_bf16 v[212:215], a[172:175], a[4:7], v[212:215]
    ds_read_b64_tr_b16 a[212:213], v10 offset:28672
    v_mfma_f32_16x16x32_bf16 v[216:219], a[172:175], a[8:11], v[216:219]
    ds_read_b64_tr_b16 a[214:215], v10 offset:29184
    v_mfma_f32_16x16x32_bf16 v[220:223], a[172:175], a[12:15], v[220:223]
    ds_read_b64_tr_b16 a[216:217], v11 offset:24576
    v_mfma_f32_16x16x32_bf16 v[160:163], a[176:179], a[0:3], v[160:163]
    s_mov_b32 s42, 4734976
    buffer_load_dwordx4 a[80:83], v2, s[24:27], s42 offen offset:0
    v_mfma_f32_16x16x32_bf16 v[164:167], a[176:179], a[4:7], v[164:167]
    ds_read_b64_tr_b16 a[218:219], v11 offset:25088
    v_mfma_f32_16x16x32_bf16 v[168:171], a[176:179], a[8:11], v[168:171]
    ds_read_b64_tr_b16 a[220:221], v11 offset:28672
    v_mfma_f32_16x16x32_bf16 v[172:175], a[176:179], a[12:15], v[172:175]
    ds_read_b64_tr_b16 a[222:223], v11 offset:29184
    v_mfma_f32_16x16x32_bf16 v[224:227], a[180:183], a[0:3], v[224:227]
    v_mfma_f32_16x16x32_bf16 v[228:231], a[180:183], a[4:7], v[228:231]
    buffer_load_dwordx4 a[84:87], v2, s[24:27], s42 offen offset:256
    v_mfma_f32_16x16x32_bf16 v[232:235], a[180:183], a[8:11], v[232:235]
    v_mfma_f32_16x16x32_bf16 v[236:239], a[180:183], a[12:15], v[236:239]
    v_mfma_f32_16x16x32_bf16 v[176:179], a[184:187], a[0:3], v[176:179]
    v_mfma_f32_16x16x32_bf16 v[180:183], a[184:187], a[4:7], v[180:183]
    buffer_load_dwordx4 a[88:91], v2, s[24:27], s42 offen offset:512
    v_mfma_f32_16x16x32_bf16 v[184:187], a[184:187], a[8:11], v[184:187]
    v_mfma_f32_16x16x32_bf16 v[188:191], a[184:187], a[12:15], v[188:191]
    v_mfma_f32_16x16x32_bf16 v[240:243], a[188:191], a[0:3], v[240:243]
    v_mfma_f32_16x16x32_bf16 v[244:247], a[188:191], a[4:7], v[244:247]
    v_mfma_f32_16x16x32_bf16 v[248:251], a[188:191], a[8:11], v[248:251]
    buffer_load_dwordx4 a[92:95], v2, s[24:27], s42 offen offset:768
    v_mfma_f32_16x16x32_bf16 v[252:255], a[188:191], a[12:15], v[252:255]
    s_waitcnt vmcnt(28)
    s_waitcnt lgkmcnt(0)
    v_mfma_f32_16x16x32_bf16 v[128:131], a[192:195], a[16:19], v[128:131]
    ds_read_b64_tr_b16 a[160:161], v8 offset:32768
    v_mfma_f32_16x16x32_bf16 v[132:135], a[192:195], a[20:23], v[132:135]
    ds_read_b64_tr_b16 a[162:163], v8 offset:33280
    v_mfma_f32_16x16x32_bf16 v[136:139], a[192:195], a[24:27], v[136:139]
    s_mov_b32 s42, 4866048
    buffer_load_dwordx4 a[96:99], v2, s[24:27], s42 offen offset:0
    v_mfma_f32_16x16x32_bf16 v[140:143], a[192:195], a[28:31], v[140:143]
    ds_read_b64_tr_b16 a[164:165], v8 offset:36864
    v_mfma_f32_16x16x32_bf16 v[192:195], a[196:199], a[16:19], v[192:195]
    ds_read_b64_tr_b16 a[166:167], v8 offset:37376
    v_mfma_f32_16x16x32_bf16 v[196:199], a[196:199], a[20:23], v[196:199]
    ds_read_b64_tr_b16 a[168:169], v9 offset:32768
    v_mfma_f32_16x16x32_bf16 v[200:203], a[196:199], a[24:27], v[200:203]
    ds_read_b64_tr_b16 a[170:171], v9 offset:33280
    v_mfma_f32_16x16x32_bf16 v[204:207], a[196:199], a[28:31], v[204:207]
    buffer_load_dwordx4 a[100:103], v2, s[24:27], s42 offen offset:256
    v_mfma_f32_16x16x32_bf16 v[144:147], a[200:203], a[16:19], v[144:147]
    ds_read_b64_tr_b16 a[172:173], v9 offset:36864
    v_mfma_f32_16x16x32_bf16 v[148:151], a[200:203], a[20:23], v[148:151]
    ds_read_b64_tr_b16 a[174:175], v9 offset:37376
    v_mfma_f32_16x16x32_bf16 v[152:155], a[200:203], a[24:27], v[152:155]
    ds_read_b64_tr_b16 a[176:177], v8 offset:40960
    v_mfma_f32_16x16x32_bf16 v[156:159], a[200:203], a[28:31], v[156:159]
    buffer_load_dwordx4 a[104:107], v2, s[24:27], s42 offen offset:512
    v_mfma_f32_16x16x32_bf16 v[208:211], a[204:207], a[16:19], v[208:211]
    ds_read_b64_tr_b16 a[178:179], v8 offset:41472
    v_mfma_f32_16x16x32_bf16 v[212:215], a[204:207], a[20:23], v[212:215]
    ds_read_b64_tr_b16 a[180:181], v8 offset:45056
    v_mfma_f32_16x16x32_bf16 v[216:219], a[204:207], a[24:27], v[216:219]
    ds_read_b64_tr_b16 a[182:183], v8 offset:45568
    v_mfma_f32_16x16x32_bf16 v[220:223], a[204:207], a[28:31], v[220:223]
    ds_read_b64_tr_b16 a[184:185], v9 offset:40960
    v_mfma_f32_16x16x32_bf16 v[160:163], a[208:211], a[16:19], v[160:163]
    buffer_load_dwordx4 a[108:111], v2, s[24:27], s42 offen offset:768
    v_mfma_f32_16x16x32_bf16 v[164:167], a[208:211], a[20:23], v[164:167]
    ds_read_b64_tr_b16 a[186:187], v9 offset:41472
    v_mfma_f32_16x16x32_bf16 v[168:171], a[208:211], a[24:27], v[168:171]
    ds_read_b64_tr_b16 a[188:189], v9 offset:45056
    v_mfma_f32_16x16x32_bf16 v[172:175], a[208:211], a[28:31], v[172:175]
    ds_read_b64_tr_b16 a[190:191], v9 offset:45568
    v_mfma_f32_16x16x32_bf16 v[224:227], a[212:215], a[16:19], v[224:227]
    v_mfma_f32_16x16x32_bf16 v[228:231], a[212:215], a[20:23], v[228:231]
    s_mov_b32 s42, 4997120
    buffer_load_dwordx4 a[112:115], v2, s[24:27], s42 offen offset:0
    v_mfma_f32_16x16x32_bf16 v[232:235], a[212:215], a[24:27], v[232:235]
    v_mfma_f32_16x16x32_bf16 v[236:239], a[212:215], a[28:31], v[236:239]
    v_mfma_f32_16x16x32_bf16 v[176:179], a[216:219], a[16:19], v[176:179]
    v_mfma_f32_16x16x32_bf16 v[180:183], a[216:219], a[20:23], v[180:183]
    buffer_load_dwordx4 a[116:119], v2, s[24:27], s42 offen offset:256
    v_mfma_f32_16x16x32_bf16 v[184:187], a[216:219], a[24:27], v[184:187]
    v_mfma_f32_16x16x32_bf16 v[188:191], a[216:219], a[28:31], v[188:191]
    v_mfma_f32_16x16x32_bf16 v[240:243], a[220:223], a[16:19], v[240:243]
    v_mfma_f32_16x16x32_bf16 v[244:247], a[220:223], a[20:23], v[244:247]
    v_mfma_f32_16x16x32_bf16 v[248:251], a[220:223], a[24:27], v[248:251]
    buffer_load_dwordx4 a[120:123], v2, s[24:27], s42 offen offset:512
    v_mfma_f32_16x16x32_bf16 v[252:255], a[220:223], a[28:31], v[252:255]
    s_waitcnt vmcnt(15)
    s_waitcnt lgkmcnt(0)
    s_barrier
    v_mfma_f32_16x16x32_bf16 v[128:131], a[160:163], a[32:35], v[128:131]
    ds_read_b64_tr_b16 a[192:193], v8 offset:49152
    v_mfma_f32_16x16x32_bf16 v[132:135], a[160:163], a[36:39], v[132:135]
    buffer_load_dwordx4 a[124:127], v2, s[24:27], s42 offen offset:768
    v_mfma_f32_16x16x32_bf16 v[136:139], a[160:163], a[40:43], v[136:139]
    ds_read_b64_tr_b16 a[194:195], v8 offset:49664
    s_mov_b32 s42, 5128192
    v_mfma_f32_16x16x32_bf16 v[140:143], a[160:163], a[44:47], v[140:143]
    buffer_load_dwordx4 a[128:131], v2, s[24:27], s42 offen offset:0
    v_mfma_f32_16x16x32_bf16 v[192:195], a[164:167], a[32:35], v[192:195]
    ds_read_b64_tr_b16 a[196:197], v8 offset:53248
    v_mfma_f32_16x16x32_bf16 v[196:199], a[164:167], a[36:39], v[196:199]
    buffer_load_dwordx4 a[132:135], v2, s[24:27], s42 offen offset:256
    v_mfma_f32_16x16x32_bf16 v[200:203], a[164:167], a[40:43], v[200:203]
    ds_read_b64_tr_b16 a[198:199], v8 offset:53760
    v_mfma_f32_16x16x32_bf16 v[204:207], a[164:167], a[44:47], v[204:207]
    buffer_load_dwordx4 a[136:139], v2, s[24:27], s42 offen offset:512
    ds_read_b64_tr_b16 a[200:201], v9 offset:49152
    v_mfma_f32_16x16x32_bf16 v[144:147], a[168:171], a[32:35], v[144:147]
    buffer_load_dwordx4 a[140:143], v2, s[24:27], s42 offen offset:768
    v_mfma_f32_16x16x32_bf16 v[148:151], a[168:171], a[36:39], v[148:151]
    ds_read_b64_tr_b16 a[202:203], v9 offset:49664
    v_mfma_f32_16x16x32_bf16 v[152:155], a[168:171], a[40:43], v[152:155]
    s_mov_b32 s42, 5259264
    buffer_load_dwordx4 a[144:147], v2, s[24:27], s42 offen offset:0
    v_mfma_f32_16x16x32_bf16 v[156:159], a[168:171], a[44:47], v[156:159]
    ds_read_b64_tr_b16 a[204:205], v9 offset:53248
    v_mfma_f32_16x16x32_bf16 v[208:211], a[172:175], a[32:35], v[208:211]
    buffer_load_dwordx4 a[148:151], v2, s[24:27], s42 offen offset:256
    v_mfma_f32_16x16x32_bf16 v[212:215], a[172:175], a[36:39], v[212:215]
    ds_read_b64_tr_b16 a[206:207], v9 offset:53760
    v_mfma_f32_16x16x32_bf16 v[216:219], a[172:175], a[40:43], v[216:219]
    buffer_load_dwordx4 a[152:155], v2, s[24:27], s42 offen offset:512
    v_mfma_f32_16x16x32_bf16 v[220:223], a[172:175], a[44:47], v[220:223]
    ds_read_b64_tr_b16 a[208:209], v8 offset:57344
    v_mfma_f32_16x16x32_bf16 v[128:131], a[176:179], a[48:51], v[128:131]
    buffer_load_dwordx2 v[20:21], v52, s[24:27], s43 offen sc1
    v_mfma_f32_16x16x32_bf16 v[132:135], a[176:179], a[52:55], v[132:135]
    buffer_load_dwordx4 v[56:59], v26, s[24:27], s46 offen offset:0 sc1
    v_mfma_f32_16x16x32_bf16 v[136:139], a[176:179], a[56:59], v[136:139]
    ds_read_b64_tr_b16 a[210:211], v8 offset:57856
    v_mfma_f32_16x16x32_bf16 v[140:143], a[176:179], a[60:63], v[140:143]
    buffer_load_dwordx4 v[60:63], v26, s[24:27], s46 offen offset:64 sc1
    v_mfma_f32_16x16x32_bf16 v[192:195], a[180:183], a[48:51], v[192:195]
    ds_read_b64_tr_b16 a[212:213], v8 offset:61440
    v_mfma_f32_16x16x32_bf16 v[196:199], a[180:183], a[52:55], v[196:199]
    buffer_load_dwordx4 v[64:67], v26, s[24:27], s46 offen offset:128 sc1
    v_mfma_f32_16x16x32_bf16 v[200:203], a[180:183], a[56:59], v[200:203]
    ds_read_b64_tr_b16 a[214:215], v8 offset:61952
    v_mfma_f32_16x16x32_bf16 v[204:207], a[180:183], a[60:63], v[204:207]
    buffer_load_dwordx4 v[68:71], v26, s[24:27], s46 offen offset:192 sc1
    ds_read_b64_tr_b16 a[216:217], v9 offset:57344
    v_mfma_f32_16x16x32_bf16 v[144:147], a[184:187], a[48:51], v[144:147]
    buffer_load_dwordx4 v[72:75], v26, s[24:27], s47 offen offset:0 sc1
    v_mfma_f32_16x16x32_bf16 v[148:151], a[184:187], a[52:55], v[148:151]
    ds_read_b64_tr_b16 a[218:219], v9 offset:57856
    v_mfma_f32_16x16x32_bf16 v[152:155], a[184:187], a[56:59], v[152:155]
    buffer_load_dwordx4 v[76:79], v26, s[24:27], s47 offen offset:64 sc1
    v_mfma_f32_16x16x32_bf16 v[156:159], a[184:187], a[60:63], v[156:159]
    ds_read_b64_tr_b16 a[220:221], v9 offset:61440
    v_mfma_f32_16x16x32_bf16 v[208:211], a[188:191], a[48:51], v[208:211]
    buffer_load_dwordx4 v[80:83], v26, s[24:27], s47 offen offset:128 sc1
    v_mfma_f32_16x16x32_bf16 v[212:215], a[188:191], a[52:55], v[212:215]
    ds_read_b64_tr_b16 a[222:223], v9 offset:61952
    v_mfma_f32_16x16x32_bf16 v[216:219], a[188:191], a[56:59], v[216:219]
    buffer_load_dwordx4 v[84:87], v26, s[24:27], s47 offen offset:192 sc1
    v_mfma_f32_16x16x32_bf16 v[220:223], a[188:191], a[60:63], v[220:223]
    s_waitcnt vmcnt(24)
    s_waitcnt lgkmcnt(0)
    v_mfma_f32_16x16x32_bf16 v[128:131], a[192:195], a[64:67], v[128:131]
    ds_read_b64_tr_b16 a[160:161], v12 offset:0
    v_mfma_f32_16x16x32_bf16 v[132:135], a[192:195], a[68:71], v[132:135]
    v_mfma_f32_16x16x32_bf16 v[136:139], a[192:195], a[72:75], v[136:139]
    ds_read_b64_tr_b16 a[162:163], v12 offset:512
    v_mfma_f32_16x16x32_bf16 v[140:143], a[192:195], a[76:79], v[140:143]
    v_mfma_f32_16x16x32_bf16 v[192:195], a[196:199], a[64:67], v[192:195]
    ds_read_b64_tr_b16 a[164:165], v12 offset:4096
    v_mfma_f32_16x16x32_bf16 v[196:199], a[196:199], a[68:71], v[196:199]
    v_mfma_f32_16x16x32_bf16 v[200:203], a[196:199], a[72:75], v[200:203]
    ds_read_b64_tr_b16 a[166:167], v12 offset:4608
    v_mfma_f32_16x16x32_bf16 v[204:207], a[196:199], a[76:79], v[204:207]
    v_mfma_f32_16x16x32_bf16 v[144:147], a[200:203], a[64:67], v[144:147]
    ds_read_b64_tr_b16 a[168:169], v13 offset:0
    v_mfma_f32_16x16x32_bf16 v[148:151], a[200:203], a[68:71], v[148:151]
    v_mfma_f32_16x16x32_bf16 v[152:155], a[200:203], a[72:75], v[152:155]
    ds_read_b64_tr_b16 a[170:171], v13 offset:512
    v_mfma_f32_16x16x32_bf16 v[156:159], a[200:203], a[76:79], v[156:159]
    ds_read_b64_tr_b16 a[172:173], v13 offset:4096
    v_mfma_f32_16x16x32_bf16 v[208:211], a[204:207], a[64:67], v[208:211]
    v_mfma_f32_16x16x32_bf16 v[212:215], a[204:207], a[68:71], v[212:215]
    ds_read_b64_tr_b16 a[174:175], v13 offset:4608
    v_mfma_f32_16x16x32_bf16 v[216:219], a[204:207], a[72:75], v[216:219]
    v_mfma_f32_16x16x32_bf16 v[220:223], a[204:207], a[76:79], v[220:223]
    ds_read_b64_tr_b16 a[176:177], v12 offset:8192
    v_mfma_f32_16x16x32_bf16 v[128:131], a[208:211], a[80:83], v[128:131]
    v_mfma_f32_16x16x32_bf16 v[132:135], a[208:211], a[84:87], v[132:135]
    buffer_load_dwordx4 a[156:159], v2, s[24:27], s42 offen offset:768
    v_mfma_f32_16x16x32_bf16 v[136:139], a[208:211], a[88:91], v[136:139]
    v_mfma_f32_16x16x32_bf16 v[140:143], a[208:211], a[92:95], v[140:143]
    ds_read_b64_tr_b16 a[178:179], v12 offset:8704
    v_mfma_f32_16x16x32_bf16 v[192:195], a[212:215], a[80:83], v[192:195]
    ds_read_b64_tr_b16 a[180:181], v12 offset:12288
    v_mfma_f32_16x16x32_bf16 v[196:199], a[212:215], a[84:87], v[196:199]
    v_mfma_f32_16x16x32_bf16 v[200:203], a[212:215], a[88:91], v[200:203]
    ds_read_b64_tr_b16 a[182:183], v12 offset:12800
    v_mfma_f32_16x16x32_bf16 v[204:207], a[212:215], a[92:95], v[204:207]
    v_mfma_f32_16x16x32_bf16 v[144:147], a[216:219], a[80:83], v[144:147]
    ds_read_b64_tr_b16 a[184:185], v13 offset:8192
    v_mfma_f32_16x16x32_bf16 v[148:151], a[216:219], a[84:87], v[148:151]
    v_mfma_f32_16x16x32_bf16 v[152:155], a[216:219], a[88:91], v[152:155]
    ds_read_b64_tr_b16 a[186:187], v13 offset:8704
    v_mfma_f32_16x16x32_bf16 v[156:159], a[216:219], a[92:95], v[156:159]
    v_mfma_f32_16x16x32_bf16 v[208:211], a[220:223], a[80:83], v[208:211]
    ds_read_b64_tr_b16 a[188:189], v13 offset:12288
    v_mfma_f32_16x16x32_bf16 v[212:215], a[220:223], a[84:87], v[212:215]
    v_mfma_f32_16x16x32_bf16 v[216:219], a[220:223], a[88:91], v[216:219]
    ds_read_b64_tr_b16 a[190:191], v13 offset:12800
    v_mfma_f32_16x16x32_bf16 v[220:223], a[220:223], a[92:95], v[220:223]
    s_waitcnt vmcnt(17)
    s_waitcnt lgkmcnt(0)
    v_mfma_f32_16x16x32_bf16 v[128:131], a[160:163], a[96:99], v[128:131]
    ds_read_b64_tr_b16 a[192:193], v12 offset:16384
    v_mfma_f32_16x16x32_bf16 v[132:135], a[160:163], a[100:103], v[132:135]
    v_mfma_f32_16x16x32_bf16 v[136:139], a[160:163], a[104:107], v[136:139]
    ds_read_b64_tr_b16 a[194:195], v12 offset:16896
    v_mfma_f32_16x16x32_bf16 v[140:143], a[160:163], a[108:111], v[140:143]
    v_mfma_f32_16x16x32_bf16 v[192:195], a[164:167], a[96:99], v[192:195]
    ds_read_b64_tr_b16 a[196:197], v12 offset:20480
    v_mfma_f32_16x16x32_bf16 v[196:199], a[164:167], a[100:103], v[196:199]
    v_mfma_f32_16x16x32_bf16 v[200:203], a[164:167], a[104:107], v[200:203]
    ds_read_b64_tr_b16 a[198:199], v12 offset:20992
    v_mfma_f32_16x16x32_bf16 v[204:207], a[164:167], a[108:111], v[204:207]
    ds_read_b64_tr_b16 a[200:201], v13 offset:16384
    v_mfma_f32_16x16x32_bf16 v[144:147], a[168:171], a[96:99], v[144:147]
    s_add_u32 m0, s56, 0
    s_add_u32 s57, s59, 0
    v_mfma_f32_16x16x32_bf16 v[148:151], a[168:171], a[100:103], v[148:151]
    buffer_load_dwordx4 v16, s[16:19], s57 offen lds
    v_mfma_f32_16x16x32_bf16 v[152:155], a[168:171], a[104:107], v[152:155]
    v_mfma_f32_16x16x32_bf16 v[156:159], a[168:171], a[108:111], v[156:159]
    ds_read_b64_tr_b16 a[202:203], v13 offset:16896
    v_mfma_f32_16x16x32_bf16 v[208:211], a[172:175], a[96:99], v[208:211]
    ds_read_b64_tr_b16 a[204:205], v13 offset:20480
    v_mfma_f32_16x16x32_bf16 v[212:215], a[172:175], a[100:103], v[212:215]
    v_mfma_f32_16x16x32_bf16 v[216:219], a[172:175], a[104:107], v[216:219]
    ds_read_b64_tr_b16 a[206:207], v13 offset:20992
    v_mfma_f32_16x16x32_bf16 v[220:223], a[172:175], a[108:111], v[220:223]
    v_mfma_f32_16x16x32_bf16 v[128:131], a[176:179], a[112:115], v[128:131]
    ds_read_b64_tr_b16 a[208:209], v12 offset:24576
    v_mfma_f32_16x16x32_bf16 v[132:135], a[176:179], a[116:119], v[132:135]
    v_mfma_f32_16x16x32_bf16 v[136:139], a[176:179], a[120:123], v[136:139]
    ds_read_b64_tr_b16 a[210:211], v12 offset:25088
    v_mfma_f32_16x16x32_bf16 v[140:143], a[176:179], a[124:127], v[140:143]
    ds_read_b64_tr_b16 a[212:213], v12 offset:28672
    v_mfma_f32_16x16x32_bf16 v[192:195], a[180:183], a[112:115], v[192:195]
    v_mfma_f32_16x16x32_bf16 v[196:199], a[180:183], a[116:119], v[196:199]
    ds_read_b64_tr_b16 a[214:215], v12 offset:29184
    v_mfma_f32_16x16x32_bf16 v[200:203], a[180:183], a[120:123], v[200:203]
    v_mfma_f32_16x16x32_bf16 v[204:207], a[180:183], a[124:127], v[204:207]
    ds_read_b64_tr_b16 a[216:217], v13 offset:24576
    v_mfma_f32_16x16x32_bf16 v[144:147], a[184:187], a[112:115], v[144:147]
    s_add_u32 m0, s56, 1024
    s_add_u32 s57, s59, 10240
    buffer_load_dwordx4 v16, s[16:19], s57 offen lds
    v_mfma_f32_16x16x32_bf16 v[148:151], a[184:187], a[116:119], v[148:151]
    v_mfma_f32_16x16x32_bf16 v[152:155], a[184:187], a[120:123], v[152:155]
    ds_read_b64_tr_b16 a[218:219], v13 offset:25088
    v_mfma_f32_16x16x32_bf16 v[156:159], a[184:187], a[124:127], v[156:159]
    v_mfma_f32_16x16x32_bf16 v[208:211], a[188:191], a[112:115], v[208:211]
    ds_read_b64_tr_b16 a[220:221], v13 offset:28672
    v_mfma_f32_16x16x32_bf16 v[212:215], a[188:191], a[116:119], v[212:215]
    v_mfma_f32_16x16x32_bf16 v[216:219], a[188:191], a[120:123], v[216:219]
    ds_read_b64_tr_b16 a[222:223], v13 offset:29184
    v_mfma_f32_16x16x32_bf16 v[220:223], a[188:191], a[124:127], v[220:223]
    s_waitcnt vmcnt(2)
    s_waitcnt lgkmcnt(0)
    v_mfma_f32_16x16x32_bf16 v[128:131], a[192:195], a[128:131], v[128:131]
    ds_read_b64_tr_b16 a[160:161], v10 offset:32768
    ds_read_b64_tr_b16 a[162:163], v10 offset:33280
    v_mfma_f32_16x16x32_bf16 v[132:135], a[192:195], a[132:135], v[132:135]
    ds_read_b64_tr_b16 a[164:165], v10 offset:36864
    v_mfma_f32_16x16x32_bf16 v[136:139], a[192:195], a[136:139], v[136:139]
    ds_read_b64_tr_b16 a[166:167], v10 offset:37376
    s_add_u32 m0, s56, 8192
    s_add_u32 s57, s59, 81920
    buffer_load_dwordx4 v16, s[16:19], s57 offen lds
    v_mfma_f32_16x16x32_bf16 v[140:143], a[192:195], a[140:143], v[140:143]
    ds_read_b64_tr_b16 a[168:169], v11 offset:32768
    v_mfma_f32_16x16x32_bf16 v[192:195], a[196:199], a[128:131], v[192:195]
    ds_read_b64_tr_b16 a[170:171], v11 offset:33280
    ds_read_b64_tr_b16 a[172:173], v11 offset:36864
    v_mfma_f32_16x16x32_bf16 v[196:199], a[196:199], a[132:135], v[196:199]
    ds_read_b64_tr_b16 a[174:175], v11 offset:37376
    v_mfma_f32_16x16x32_bf16 v[200:203], a[196:199], a[136:139], v[200:203]
    ds_read_b64_tr_b16 a[176:177], v10 offset:40960
    ds_read_b64_tr_b16 a[178:179], v10 offset:41472
    v_mfma_f32_16x16x32_bf16 v[204:207], a[196:199], a[140:143], v[204:207]
    ds_read_b64_tr_b16 a[180:181], v10 offset:45056
    v_mfma_f32_16x16x32_bf16 v[144:147], a[200:203], a[128:131], v[144:147]
    ds_read_b64_tr_b16 a[182:183], v10 offset:45568
    s_add_u32 m0, s56, 9216
    s_add_u32 s57, s59, 92160
    buffer_load_dwordx4 v16, s[16:19], s57 offen lds
    v_mfma_f32_16x16x32_bf16 v[148:151], a[200:203], a[132:135], v[148:151]
    ds_read_b64_tr_b16 a[184:185], v11 offset:40960
    v_mfma_f32_16x16x32_bf16 v[152:155], a[200:203], a[136:139], v[152:155]
    ds_read_b64_tr_b16 a[186:187], v11 offset:41472
    ds_read_b64_tr_b16 a[188:189], v11 offset:45056
    v_mfma_f32_16x16x32_bf16 v[156:159], a[200:203], a[140:143], v[156:159]
    ds_read_b64_tr_b16 a[190:191], v11 offset:45568
    v_mfma_f32_16x16x32_bf16 v[208:211], a[204:207], a[128:131], v[208:211]
    v_add_u32 v23, -1, v21
    v_max3_u32 v23, v23, v56, v57
    v_mfma_f32_16x16x32_bf16 v[212:215], a[204:207], a[132:135], v[212:215]
    s_add_u32 m0, s56, 16384
    s_add_u32 s57, s59, 163840
    buffer_load_dwordx4 v16, s[16:19], s57 offen lds
    v_mfma_f32_16x16x32_bf16 v[216:219], a[204:207], a[136:139], v[216:219]
    v_max3_u32 v23, v23, v58, v59
    v_max3_u32 v23, v23, v60, v61
    v_mfma_f32_16x16x32_bf16 v[220:223], a[204:207], a[140:143], v[220:223]
    v_max3_u32 v23, v23, v62, v63
    v_mfma_f32_16x16x32_bf16 v[128:131], a[208:211], a[144:147], v[128:131]
    v_max3_u32 v23, v23, v64, v65
    v_max3_u32 v23, v23, v66, v67
    v_mfma_f32_16x16x32_bf16 v[132:135], a[208:211], a[148:151], v[132:135]
    v_max3_u32 v23, v23, v68, v69
    v_mfma_f32_16x16x32_bf16 v[136:139], a[208:211], a[152:155], v[136:139]
    v_max3_u32 v23, v23, v70, v71
    s_add_u32 m0, s56, 17408
    s_add_u32 s57, s59, 174080
    buffer_load_dwordx4 v16, s[16:19], s57 offen lds
    v_mfma_f32_16x16x32_bf16 v[140:143], a[208:211], a[156:159], v[140:143]
    v_max3_u32 v23, v23, v72, v73
    v_mfma_f32_16x16x32_bf16 v[192:195], a[212:215], a[144:147], v[192:195]
    v_max3_u32 v23, v23, v74, v75
    v_max3_u32 v23, v23, v76, v77
    v_mfma_f32_16x16x32_bf16 v[196:199], a[212:215], a[148:151], v[196:199]
    v_max3_u32 v23, v23, v78, v79
    v_mfma_f32_16x16x32_bf16 v[200:203], a[212:215], a[152:155], v[200:203]
    v_max3_u32 v23, v23, v80, v81
    v_max3_u32 v23, v23, v82, v83
    v_mfma_f32_16x16x32_bf16 v[204:207], a[212:215], a[156:159], v[204:207]
    v_max3_u32 v23, v23, v84, v85
    v_mfma_f32_16x16x32_bf16 v[144:147], a[216:219], a[144:147], v[144:147]
    v_max3_u32 v23, v23, v86, v87
    s_add_u32 m0, s56, 24576
    s_add_u32 s57, s59, 245760
    buffer_load_dwordx4 v16, s[16:19], s57 offen lds
    v_mfma_f32_16x16x32_bf16 v[148:151], a[216:219], a[148:151], v[148:151]
    v_cmp_eq_u32 vcc, -1, v23
    v_mfma_f32_16x16x32_bf16 v[152:155], a[216:219], a[152:155], v[152:155]
    v_nop
    s_cbranch_vccnz g_poll
g_ready:
    v_mfma_f32_16x16x32_bf16 v[156:159], a[216:219], a[156:159], v[156:159]
    v_rsq_f32 v22, v21
    s_nop 0
    v_mfma_f32_16x16x32_bf16 v[208:211], a[220:223], a[144:147], v[208:211]
    v_mul_f32 v22, 0xbfb8aa3b, v22
    s_add_u32 m0, s56, 25600
    s_add_u32 s57, s59, 256000
    buffer_load_dwordx4 v16, s[16:19], s57 offen lds
    v_mfma_f32_16x16x32_bf16 v[212:215], a[220:223], a[148:151], v[212:215]
    ds_bpermute_b32 v36, v53, v20 offset:0
    v_mfma_f32_16x16x32_bf16 v[216:219], a[220:223], a[152:155], v[216:219]
    ds_bpermute_b32 v37, v53, v22 offset:0
    ds_bpermute_b32 v38, v53, v21 offset:0
    v_mfma_f32_16x16x32_bf16 v[220:223], a[220:223], a[156:159], v[220:223]
    s_waitcnt lgkmcnt(0)
    v_mfma_f32_16x16x32_bf16 v[160:163], a[160:163], a[32:35], v[160:163]
    ds_read_b64_tr_b16 a[192:193], v10 offset:49152
    ds_read_b64_tr_b16 a[194:195], v10 offset:49664
    ds_read_b64_tr_b16 a[196:197], v10 offset:53248
    v_mfma_f32_16x16x32_bf16 v[164:167], a[160:163], a[36:39], v[164:167]
    ds_read_b64_tr_b16 a[198:199], v10 offset:53760
    ds_read_b64_tr_b16 a[200:201], v11 offset:49152
    ds_read_b64_tr_b16 a[202:203], v11 offset:49664
    ds_read_b64_tr_b16 a[204:205], v11 offset:53248
    v_mfma_f32_16x16x32_bf16 v[168:171], a[160:163], a[40:43], v[168:171]
    ds_read_b64_tr_b16 a[206:207], v11 offset:53760
    v_fmac_f32 v128, v56, v36
    v_fmac_f32 v129, v57, v36
    v_mfma_f32_16x16x32_bf16 v[172:175], a[160:163], a[44:47], v[172:175]
    ds_read_b64_tr_b16 a[208:209], v10 offset:57344
    v_fmac_f32 v130, v58, v36
    s_add_u32 m0, s56, 32768
    s_add_u32 s57, s59, 327680
    buffer_load_dwordx4 v16, s[16:19], s57 offen lds
    v_fmac_f32 v131, v59, v36
    v_mfma_f32_16x16x32_bf16 v[224:227], a[164:167], a[32:35], v[224:227]
    v_fmac_f32 v144, v60, v36
    v_fmac_f32 v145, v61, v36
    ds_read_b64_tr_b16 a[210:211], v10 offset:57856
    v_mfma_f32_16x16x32_bf16 v[228:231], a[164:167], a[36:39], v[228:231]
    v_fmac_f32 v146, v62, v36
    v_fmac_f32 v147, v63, v36
    v_mul_f32 v88, v128, v37
    v_mul_f32 v89, v129, v37
    v_mfma_f32_16x16x32_bf16 v[232:235], a[164:167], a[40:43], v[232:235]
    ds_read_b64_tr_b16 a[212:213], v10 offset:61440
    v_mul_f32 v90, v130, v37
    v_mul_f32 v91, v131, v37
    v_mfma_f32_16x16x32_bf16 v[236:239], a[164:167], a[44:47], v[236:239]
    v_mul_f32 v92, v144, v37
    ds_read_b64_tr_b16 a[214:215], v10 offset:61952
    v_mul_f32 v93, v145, v37
    v_mul_f32 v94, v146, v37
    v_mfma_f32_16x16x32_bf16 v[176:179], a[168:171], a[32:35], v[176:179]
    v_mul_f32 v95, v147, v37
    v_exp_f32 v88, v88
    v_mfma_f32_16x16x32_bf16 v[180:183], a[168:171], a[36:39], v[180:183]
    ds_read_b64_tr_b16 a[216:217], v11 offset:57344
    v_fmac_f32 v192, v72, v36
    v_exp_f32 v89, v89
    v_mfma_f32_16x16x32_bf16 v[184:187], a[168:171], a[40:43], v[184:187]
    v_fmac_f32 v193, v73, v36
    v_exp_f32 v90, v90
    s_add_u32 m0, s56, 33792
    s_add_u32 s57, s59, 337920
    v_mfma_f32_16x16x32_bf16 v[188:191], a[168:171], a[44:47], v[188:191]
    buffer_load_dwordx4 v16, s[16:19], s57 offen lds
    ds_read_b64_tr_b16 a[218:219], v11 offset:57856
    v_fmac_f32 v194, v74, v36
    v_mfma_f32_16x16x32_bf16 v[240:243], a[172:175], a[32:35], v[240:243]
    v_exp_f32 v91, v91
    v_fmac_f32 v195, v75, v36
    ds_read_b64_tr_b16 a[220:221], v11 offset:61440
    v_mfma_f32_16x16x32_bf16 v[244:247], a[172:175], a[36:39], v[244:247]
    v_exp_f32 v92, v92
    v_fmac_f32 v208, v76, v36
    v_mfma_f32_16x16x32_bf16 v[248:251], a[172:175], a[40:43], v[248:251]
    v_exp_f32 v93, v93
    v_fmac_f32 v209, v77, v36
    ds_read_b64_tr_b16 a[222:223], v11 offset:61952
    v_mfma_f32_16x16x32_bf16 v[252:255], a[172:175], a[44:47], v[252:255]
    v_exp_f32 v94, v94
    v_fmac_f32 v210, v78, v36
    v_mfma_f32_16x16x32_bf16 v[160:163], a[176:179], a[48:51], v[160:163]
    v_exp_f32 v95, v95
    ds_bpermute_b32 v40, v53, v20 offset:64
    v_fmac_f32 v211, v79, v36
    v_mfma_f32_16x16x32_bf16 v[164:167], a[176:179], a[52:55], v[164:167]
    v_fma_f32 v88, v88, v38, v38
    v_fma_f32 v89, v89, v38, v38
    v_fma_f32 v90, v90, v38, v38
    ds_bpermute_b32 v41, v53, v22 offset:64
    v_mfma_f32_16x16x32_bf16 v[168:171], a[176:179], a[56:59], v[168:171]
    v_fma_f32 v91, v91, v38, v38
    v_fma_f32 v92, v92, v38, v38
    v_fma_f32 v93, v93, v38, v38
    s_add_u32 m0, s56, 40960
    s_add_u32 s57, s59, 409600
    v_mfma_f32_16x16x32_bf16 v[172:175], a[176:179], a[60:63], v[172:175]
    buffer_load_dwordx4 v16, s[16:19], s57 offen lds
    v_fma_f32 v94, v94, v38, v38
    ds_bpermute_b32 v42, v53, v21 offset:64
    v_fma_f32 v95, v95, v38, v38
    v_mfma_f32_16x16x32_bf16 v[224:227], a[180:183], a[48:51], v[224:227]
    v_rcp_f32 v88, v88
    v_mul_f32 v128, v128, v192
    v_mfma_f32_16x16x32_bf16 v[228:231], a[180:183], a[52:55], v[228:231]
    v_rcp_f32 v89, v89
    v_mul_f32 v129, v129, v193
    v_mfma_f32_16x16x32_bf16 v[232:235], a[180:183], a[56:59], v[232:235]
    v_rcp_f32 v90, v90
    v_mul_f32 v130, v130, v194
    v_rcp_f32 v91, v91
    v_mfma_f32_16x16x32_bf16 v[236:239], a[180:183], a[60:63], v[236:239]
    v_mul_f32 v131, v131, v195
    v_rcp_f32 v92, v92
    v_mfma_f32_16x16x32_bf16 v[176:179], a[184:187], a[48:51], v[176:179]
    v_mul_f32 v144, v144, v208
    v_rcp_f32 v93, v93
    v_mfma_f32_16x16x32_bf16 v[180:183], a[184:187], a[52:55], v[180:183]
    v_mul_f32 v145, v145, v209
    v_rcp_f32 v94, v94
    v_mul_f32 v146, v146, v210
    v_mfma_f32_16x16x32_bf16 v[184:187], a[184:187], a[56:59], v[184:187]
    v_rcp_f32 v95, v95
    v_mul_f32 v147, v147, v211
    v_mfma_f32_16x16x32_bf16 v[188:191], a[184:187], a[60:63], v[188:191]
    v_mul_f32 v88, v88, v128
    v_mul_f32 v89, v89, v129
    v_mul_f32 v90, v90, v130
    s_add_u32 m0, s56, 41984
    s_add_u32 s57, s59, 419840
    buffer_load_dwordx4 v16, s[16:19], s57 offen lds
    v_mfma_f32_16x16x32_bf16 v[240:243], a[188:191], a[48:51], v[240:243]
    v_mul_f32 v91, v91, v131
    v_mul_f32 v92, v92, v144
    v_mul_f32 v93, v93, v145
    v_mfma_f32_16x16x32_bf16 v[244:247], a[188:191], a[52:55], v[244:247]
    v_mul_f32 v94, v94, v146
    v_mul_f32 v95, v95, v147
    v_cvt_pk_bf16_f32 v112, v88, v89
    v_cvt_pk_bf16_f32 v113, v90, v91
    v_mfma_f32_16x16x32_bf16 v[248:251], a[188:191], a[56:59], v[248:251]
    v_cvt_pk_bf16_f32 v114, v92, v93
    v_cvt_pk_bf16_f32 v115, v94, v95
    buffer_store_dwordx4 v[112:115], v2, s[24:27], s44 offen offset:0 sc1
    v_mfma_f32_16x16x32_bf16 v[252:255], a[188:191], a[60:63], v[252:255]
    s_waitcnt lgkmcnt(0)
    v_mfma_f32_16x16x32_bf16 v[160:163], a[192:195], a[64:67], v[160:163]
    ds_read_b64_tr_b16 a[160:161], v14 offset:0
    ds_read_b64_tr_b16 a[162:163], v14 offset:512
    ds_read_b64_tr_b16 a[164:165], v14 offset:4096
    v_mfma_f32_16x16x32_bf16 v[164:167], a[192:195], a[68:71], v[164:167]
    ds_read_b64_tr_b16 a[166:167], v14 offset:4608
    ds_read_b64_tr_b16 a[168:169], v15 offset:0
    ds_read_b64_tr_b16 a[170:171], v15 offset:512
    ds_read_b64_tr_b16 a[172:173], v15 offset:4096
    v_mfma_f32_16x16x32_bf16 v[168:171], a[192:195], a[72:75], v[168:171]
    ds_read_b64_tr_b16 a[174:175], v15 offset:4608
    v_fmac_f32 v132, v56, v40
    v_fmac_f32 v133, v57, v40
    v_mfma_f32_16x16x32_bf16 v[172:175], a[192:195], a[76:79], v[172:175]
    ds_read_b64_tr_b16 a[176:177], v14 offset:8192
    v_fmac_f32 v134, v58, v40
    s_add_u32 m0, s56, 49152
    s_add_u32 s57, s59, 491520
    buffer_load_dwordx4 v16, s[16:19], s57 offen lds
    v_fmac_f32 v135, v59, v40
    v_mfma_f32_16x16x32_bf16 v[224:227], a[196:199], a[64:67], v[224:227]
    v_fmac_f32 v148, v60, v40
    v_fmac_f32 v149, v61, v40
    ds_read_b64_tr_b16 a[178:179], v14 offset:8704
    v_mfma_f32_16x16x32_bf16 v[228:231], a[196:199], a[68:71], v[228:231]
    v_fmac_f32 v150, v62, v40
    v_fmac_f32 v151, v63, v40
    v_mul_f32 v88, v132, v41
    v_mul_f32 v89, v133, v41
    v_mfma_f32_16x16x32_bf16 v[232:235], a[196:199], a[72:75], v[232:235]
    ds_read_b64_tr_b16 a[180:181], v14 offset:12288
    v_mul_f32 v90, v134, v41
    v_mul_f32 v91, v135, v41
    v_mfma_f32_16x16x32_bf16 v[236:239], a[196:199], a[76:79], v[236:239]
    v_mul_f32 v92, v148, v41
    ds_read_b64_tr_b16 a[182:183], v14 offset:12800
    v_mul_f32 v93, v149, v41
    v_mul_f32 v94, v150, v41
    v_mfma_f32_16x16x32_bf16 v[176:179], a[200:203], a[64:67], v[176:179]
    v_mul_f32 v95, v151, v41
    v_exp_f32 v88, v88
    v_mfma_f32_16x16x32_bf16 v[180:183], a[200:203], a[68:71], v[180:183]
    ds_read_b64_tr_b16 a[184:185], v15 offset:8192
    v_fmac_f32 v196, v72, v40
    v_exp_f32 v89, v89
    v_mfma_f32_16x16x32_bf16 v[184:187], a[200:203], a[72:75], v[184:187]
    v_fmac_f32 v197, v73, v40
    v_exp_f32 v90, v90
    s_add_u32 m0, s56, 50176
    s_add_u32 s57, s59, 501760
    v_mfma_f32_16x16x32_bf16 v[188:191], a[200:203], a[76:79], v[188:191]
    buffer_load_dwordx4 v16, s[16:19], s57 offen lds
    ds_read_b64_tr_b16 a[186:187], v15 offset:8704
    v_fmac_f32 v198, v74, v40
    v_mfma_f32_16x16x32_bf16 v[240:243], a[204:207], a[64:67], v[240:243]
    v_exp_f32 v91, v91
    v_fmac_f32 v199, v75, v40
    ds_read_b64_tr_b16 a[188:189], v15 offset:12288
    v_mfma_f32_16x16x32_bf16 v[244:247], a[204:207], a[68:71], v[244:247]
    v_exp_f32 v92, v92
    v_fmac_f32 v212, v76, v40
    v_mfma_f32_16x16x32_bf16 v[248:251], a[204:207], a[72:75], v[248:251]
    v_exp_f32 v93, v93
    v_fmac_f32 v213, v77, v40
    ds_read_b64_tr_b16 a[190:191], v15 offset:12800
    v_mfma_f32_16x16x32_bf16 v[252:255], a[204:207], a[76:79], v[252:255]
    v_exp_f32 v94, v94
    v_fmac_f32 v214, v78, v40
    v_mfma_f32_16x16x32_bf16 v[160:163], a[208:211], a[80:83], v[160:163]
    v_exp_f32 v95, v95
    ds_bpermute_b32 v44, v53, v20 offset:128
    v_fmac_f32 v215, v79, v40
    v_mfma_f32_16x16x32_bf16 v[164:167], a[208:211], a[84:87], v[164:167]
    v_fma_f32 v88, v88, v42, v42
    v_fma_f32 v89, v89, v42, v42
    v_fma_f32 v90, v90, v42, v42
    ds_bpermute_b32 v45, v53, v22 offset:128
    v_mfma_f32_16x16x32_bf16 v[168:171], a[208:211], a[88:91], v[168:171]
    v_fma_f32 v91, v91, v42, v42
    v_fma_f32 v92, v92, v42, v42
    v_fma_f32 v93, v93, v42, v42
    s_add_u32 m0, s56, 57344
    s_add_u32 s57, s59, 573440
    v_mfma_f32_16x16x32_bf16 v[172:175], a[208:211], a[92:95], v[172:175]
    buffer_load_dwordx4 v16, s[16:19], s57 offen lds
    v_fma_f32 v94, v94, v42, v42
    ds_bpermute_b32 v46, v53, v21 offset:128
    v_fma_f32 v95, v95, v42, v42
    v_mfma_f32_16x16x32_bf16 v[224:227], a[212:215], a[80:83], v[224:227]
    v_rcp_f32 v88, v88
    v_mul_f32 v132, v132, v196
    v_mfma_f32_16x16x32_bf16 v[228:231], a[212:215], a[84:87], v[228:231]
    v_rcp_f32 v89, v89
    v_mul_f32 v133, v133, v197
    v_mfma_f32_16x16x32_bf16 v[232:235], a[212:215], a[88:91], v[232:235]
    v_rcp_f32 v90, v90
    v_mul_f32 v134, v134, v198
    v_rcp_f32 v91, v91
    v_mfma_f32_16x16x32_bf16 v[236:239], a[212:215], a[92:95], v[236:239]
    v_mul_f32 v135, v135, v199
    v_rcp_f32 v92, v92
    v_mfma_f32_16x16x32_bf16 v[176:179], a[216:219], a[80:83], v[176:179]
    v_mul_f32 v148, v148, v212
    v_rcp_f32 v93, v93
    v_mfma_f32_16x16x32_bf16 v[180:183], a[216:219], a[84:87], v[180:183]
    v_mul_f32 v149, v149, v213
    v_rcp_f32 v94, v94
    v_mul_f32 v150, v150, v214
    v_mfma_f32_16x16x32_bf16 v[184:187], a[216:219], a[88:91], v[184:187]
    v_rcp_f32 v95, v95
    v_mul_f32 v151, v151, v215
    v_mfma_f32_16x16x32_bf16 v[188:191], a[216:219], a[92:95], v[188:191]
    v_mul_f32 v88, v88, v132
    v_mul_f32 v89, v89, v133
    v_mul_f32 v90, v90, v134
    s_add_u32 m0, s56, 58368
    s_add_u32 s57, s59, 583680
    buffer_load_dwordx4 v16, s[16:19], s57 offen lds
    v_mfma_f32_16x16x32_bf16 v[240:243], a[220:223], a[80:83], v[240:243]
    v_mul_f32 v91, v91, v135
    v_mul_f32 v92, v92, v148
    v_mul_f32 v93, v93, v149
    v_mfma_f32_16x16x32_bf16 v[244:247], a[220:223], a[84:87], v[244:247]
    v_mul_f32 v94, v94, v150
    v_mul_f32 v95, v95, v151
    v_cvt_pk_bf16_f32 v116, v88, v89
    v_cvt_pk_bf16_f32 v117, v90, v91
    v_mfma_f32_16x16x32_bf16 v[248:251], a[220:223], a[88:91], v[248:251]
    v_cvt_pk_bf16_f32 v118, v92, v93
    v_cvt_pk_bf16_f32 v119, v94, v95
    buffer_store_dwordx4 v[116:119], v2, s[24:27], s44 offen offset:256 sc1
    v_mfma_f32_16x16x32_bf16 v[252:255], a[220:223], a[92:95], v[252:255]
    s_waitcnt lgkmcnt(0)
    v_mfma_f32_16x16x32_bf16 v[160:163], a[160:163], a[96:99], v[160:163]
    ds_read_b64_tr_b16 a[192:193], v14 offset:16384
    ds_read_b64_tr_b16 a[194:195], v14 offset:16896
    ds_read_b64_tr_b16 a[196:197], v14 offset:20480
    v_mfma_f32_16x16x32_bf16 v[164:167], a[160:163], a[100:103], v[164:167]
    ds_read_b64_tr_b16 a[198:199], v14 offset:20992
    ds_read_b64_tr_b16 a[200:201], v15 offset:16384
    ds_read_b64_tr_b16 a[202:203], v15 offset:16896
    ds_read_b64_tr_b16 a[204:205], v15 offset:20480
    v_mfma_f32_16x16x32_bf16 v[168:171], a[160:163], a[104:107], v[168:171]
    ds_read_b64_tr_b16 a[206:207], v15 offset:20992
    v_fmac_f32 v136, v56, v44
    v_fmac_f32 v137, v57, v44
    v_mfma_f32_16x16x32_bf16 v[172:175], a[160:163], a[108:111], v[172:175]
    ds_read_b64_tr_b16 a[208:209], v14 offset:24576
    v_fmac_f32 v138, v58, v44
    s_add_u32 m0, s56, 65536
    s_add_u32 s57, s59, 655360
    buffer_load_dwordx4 v16, s[16:19], s57 offen lds
    v_fmac_f32 v139, v59, v44
    v_mfma_f32_16x16x32_bf16 v[224:227], a[164:167], a[96:99], v[224:227]
    v_fmac_f32 v152, v60, v44
    v_fmac_f32 v153, v61, v44
    ds_read_b64_tr_b16 a[210:211], v14 offset:25088
    v_mfma_f32_16x16x32_bf16 v[228:231], a[164:167], a[100:103], v[228:231]
    v_fmac_f32 v154, v62, v44
    v_fmac_f32 v155, v63, v44
    v_mul_f32 v88, v136, v45
    v_mul_f32 v89, v137, v45
    v_mfma_f32_16x16x32_bf16 v[232:235], a[164:167], a[104:107], v[232:235]
    ds_read_b64_tr_b16 a[212:213], v14 offset:28672
    v_mul_f32 v90, v138, v45
    v_mul_f32 v91, v139, v45
    v_mfma_f32_16x16x32_bf16 v[236:239], a[164:167], a[108:111], v[236:239]
    v_mul_f32 v92, v152, v45
    ds_read_b64_tr_b16 a[214:215], v14 offset:29184
    v_mul_f32 v93, v153, v45
    v_mul_f32 v94, v154, v45
    v_mfma_f32_16x16x32_bf16 v[176:179], a[168:171], a[96:99], v[176:179]
    v_mul_f32 v95, v155, v45
    v_exp_f32 v88, v88
    v_mfma_f32_16x16x32_bf16 v[180:183], a[168:171], a[100:103], v[180:183]
    ds_read_b64_tr_b16 a[216:217], v15 offset:24576
    v_fmac_f32 v200, v72, v44
    v_exp_f32 v89, v89
    v_mfma_f32_16x16x32_bf16 v[184:187], a[168:171], a[104:107], v[184:187]
    v_fmac_f32 v201, v73, v44
    v_exp_f32 v90, v90
    s_add_u32 m0, s56, 66560
    s_add_u32 s57, s59, 665600
    v_mfma_f32_16x16x32_bf16 v[188:191], a[168:171], a[108:111], v[188:191]
    buffer_load_dwordx4 v16, s[16:19], s57 offen lds
    ds_read_b64_tr_b16 a[218:219], v15 offset:25088
    v_fmac_f32 v202, v74, v44
    v_mfma_f32_16x16x32_bf16 v[240:243], a[172:175], a[96:99], v[240:243]
    v_exp_f32 v91, v91
    v_fmac_f32 v203, v75, v44
    ds_read_b64_tr_b16 a[220:221], v15 offset:28672
    v_mfma_f32_16x16x32_bf16 v[244:247], a[172:175], a[100:103], v[244:247]
    v_exp_f32 v92, v92
    v_fmac_f32 v216, v76, v44
    v_mfma_f32_16x16x32_bf16 v[248:251], a[172:175], a[104:107], v[248:251]
    v_exp_f32 v93, v93
    v_fmac_f32 v217, v77, v44
    ds_read_b64_tr_b16 a[222:223], v15 offset:29184
    v_mfma_f32_16x16x32_bf16 v[252:255], a[172:175], a[108:111], v[252:255]
    v_exp_f32 v94, v94
    v_fmac_f32 v218, v78, v44
    v_mfma_f32_16x16x32_bf16 v[160:163], a[176:179], a[112:115], v[160:163]
    v_exp_f32 v95, v95
    ds_bpermute_b32 v48, v53, v20 offset:192
    v_fmac_f32 v219, v79, v44
    v_mfma_f32_16x16x32_bf16 v[164:167], a[176:179], a[116:119], v[164:167]
    v_fma_f32 v88, v88, v46, v46
    v_fma_f32 v89, v89, v46, v46
    v_fma_f32 v90, v90, v46, v46
    ds_bpermute_b32 v49, v53, v22 offset:192
    v_mfma_f32_16x16x32_bf16 v[168:171], a[176:179], a[120:123], v[168:171]
    v_fma_f32 v91, v91, v46, v46
    v_fma_f32 v92, v92, v46, v46
    v_fma_f32 v93, v93, v46, v46
    s_add_u32 m0, s56, 73728
    s_add_u32 s57, s59, 737280
    v_mfma_f32_16x16x32_bf16 v[172:175], a[176:179], a[124:127], v[172:175]
    buffer_load_dwordx4 v16, s[16:19], s57 offen lds
    v_fma_f32 v94, v94, v46, v46
    ds_bpermute_b32 v50, v53, v21 offset:192
    v_fma_f32 v95, v95, v46, v46
    v_mfma_f32_16x16x32_bf16 v[224:227], a[180:183], a[112:115], v[224:227]
    v_rcp_f32 v88, v88
    v_mul_f32 v136, v136, v200
    v_mfma_f32_16x16x32_bf16 v[228:231], a[180:183], a[116:119], v[228:231]
    v_rcp_f32 v89, v89
    v_mul_f32 v137, v137, v201
    v_mfma_f32_16x16x32_bf16 v[232:235], a[180:183], a[120:123], v[232:235]
    v_rcp_f32 v90, v90
    v_mul_f32 v138, v138, v202
    v_rcp_f32 v91, v91
    v_mfma_f32_16x16x32_bf16 v[236:239], a[180:183], a[124:127], v[236:239]
    v_mul_f32 v139, v139, v203
    v_rcp_f32 v92, v92
    v_mfma_f32_16x16x32_bf16 v[176:179], a[184:187], a[112:115], v[176:179]
    v_mul_f32 v152, v152, v216
    v_rcp_f32 v93, v93
    v_mfma_f32_16x16x32_bf16 v[180:183], a[184:187], a[116:119], v[180:183]
    v_mul_f32 v153, v153, v217
    v_rcp_f32 v94, v94
    v_mul_f32 v154, v154, v218
    v_mfma_f32_16x16x32_bf16 v[184:187], a[184:187], a[120:123], v[184:187]
    v_rcp_f32 v95, v95
    v_mul_f32 v155, v155, v219
    v_mfma_f32_16x16x32_bf16 v[188:191], a[184:187], a[124:127], v[188:191]
    v_mul_f32 v88, v88, v136
    v_mul_f32 v89, v89, v137
    v_mul_f32 v90, v90, v138
    s_add_u32 m0, s56, 74752
    s_add_u32 s57, s59, 747520
    buffer_load_dwordx4 v16, s[16:19], s57 offen lds
    v_mfma_f32_16x16x32_bf16 v[240:243], a[188:191], a[112:115], v[240:243]
    v_mul_f32 v91, v91, v139
    v_mul_f32 v92, v92, v152
    v_mul_f32 v93, v93, v153
    v_mfma_f32_16x16x32_bf16 v[244:247], a[188:191], a[116:119], v[244:247]
    v_mul_f32 v94, v94, v154
    v_mul_f32 v95, v95, v155
    v_cvt_pk_bf16_f32 v112, v88, v89
    v_cvt_pk_bf16_f32 v113, v90, v91
    v_mfma_f32_16x16x32_bf16 v[248:251], a[188:191], a[120:123], v[248:251]
    v_cvt_pk_bf16_f32 v114, v92, v93
    v_cvt_pk_bf16_f32 v115, v94, v95
    buffer_store_dwordx4 v[112:115], v2, s[24:27], s44 offen offset:512 sc1
    v_mfma_f32_16x16x32_bf16 v[252:255], a[188:191], a[124:127], v[252:255]
    s_waitcnt lgkmcnt(0)
    v_mfma_f32_16x16x32_bf16 v[160:163], a[192:195], a[128:131], v[160:163]
    v_fmac_f32 v140, v56, v48
    v_fmac_f32 v141, v57, v48
    v_fmac_f32 v142, v58, v48
    v_mfma_f32_16x16x32_bf16 v[164:167], a[192:195], a[132:135], v[164:167]
    v_fmac_f32 v143, v59, v48
    v_fmac_f32 v156, v60, v48
    v_fmac_f32 v157, v61, v48
    v_mfma_f32_16x16x32_bf16 v[168:171], a[192:195], a[136:139], v[168:171]
    v_fmac_f32 v158, v62, v48
    v_fmac_f32 v159, v63, v48
    v_mul_f32 v88, v140, v49
    v_mfma_f32_16x16x32_bf16 v[172:175], a[192:195], a[140:143], v[172:175]
    s_add_u32 m0, s56, 81920
    s_add_u32 s57, s59, 819200
    buffer_load_dwordx4 v16, s[16:19], s57 offen lds
    v_mul_f32 v89, v141, v49
    v_mfma_f32_16x16x32_bf16 v[224:227], a[196:199], a[128:131], v[224:227]
    v_mul_f32 v90, v142, v49
    v_mul_f32 v91, v143, v49
    v_mul_f32 v92, v156, v49
    v_mfma_f32_16x16x32_bf16 v[228:231], a[196:199], a[132:135], v[228:231]
    v_mul_f32 v93, v157, v49
    v_mul_f32 v94, v158, v49
    v_mul_f32 v95, v159, v49
    v_mfma_f32_16x16x32_bf16 v[232:235], a[196:199], a[136:139], v[232:235]
    v_exp_f32 v88, v88
    v_fmac_f32 v204, v72, v48
    v_mfma_f32_16x16x32_bf16 v[236:239], a[196:199], a[140:143], v[236:239]
    v_exp_f32 v89, v89
    v_fmac_f32 v205, v73, v48
    v_mfma_f32_16x16x32_bf16 v[176:179], a[200:203], a[128:131], v[176:179]
    v_exp_f32 v90, v90
    v_fmac_f32 v206, v74, v48
    v_mfma_f32_16x16x32_bf16 v[180:183], a[200:203], a[132:135], v[180:183]
    v_exp_f32 v91, v91
    v_fmac_f32 v207, v75, v48
    v_mfma_f32_16x16x32_bf16 v[184:187], a[200:203], a[136:139], v[184:187]
    v_exp_f32 v92, v92
    v_fmac_f32 v220, v76, v48
    v_mfma_f32_16x16x32_bf16 v[188:191], a[200:203], a[140:143], v[188:191]
    s_add_u32 m0, s56, 82944
    s_add_u32 s57, s59, 829440
    buffer_load_dwordx4 v16, s[16:19], s57 offen lds
    v_exp_f32 v93, v93
    v_mfma_f32_16x16x32_bf16 v[240:243], a[204:207], a[128:131], v[240:243]
    v_fmac_f32 v221, v77, v48
    v_exp_f32 v94, v94
    v_mfma_f32_16x16x32_bf16 v[244:247], a[204:207], a[132:135], v[244:247]
    v_fmac_f32 v222, v78, v48
    v_exp_f32 v95, v95
    v_mfma_f32_16x16x32_bf16 v[248:251], a[204:207], a[136:139], v[248:251]
    v_fmac_f32 v223, v79, v48
    v_fma_f32 v88, v88, v50, v50
    v_mfma_f32_16x16x32_bf16 v[252:255], a[204:207], a[140:143], v[252:255]
    v_fma_f32 v89, v89, v50, v50
    v_fma_f32 v90, v90, v50, v50
    v_fma_f32 v91, v91, v50, v50
    v_mfma_f32_16x16x32_bf16 v[160:163], a[208:211], a[144:147], v[160:163]
    v_fma_f32 v92, v92, v50, v50
    v_fma_f32 v93, v93, v50, v50
    v_fma_f32 v94, v94, v50, v50
    v_mfma_f32_16x16x32_bf16 v[164:167], a[208:211], a[148:151], v[164:167]
    v_fma_f32 v95, v95, v50, v50
    v_rcp_f32 v88, v88
    v_mfma_f32_16x16x32_bf16 v[168:171], a[208:211], a[152:155], v[168:171]
    v_mul_f32 v140, v140, v204
    v_rcp_f32 v89, v89
    v_mfma_f32_16x16x32_bf16 v[172:175], a[208:211], a[156:159], v[172:175]
    v_mul_f32 v141, v141, v205
    s_add_u32 m0, s56, 90112
    s_add_u32 s57, s59, 901120
    buffer_load_dwordx4 v16, s[16:19], s57 offen lds
    v_mfma_f32_16x16x32_bf16 v[224:227], a[212:215], a[144:147], v[224:227]
    v_rcp_f32 v90, v90
    v_mul_f32 v142, v142, v206
    v_mfma_f32_16x16x32_bf16 v[228:231], a[212:215], a[148:151], v[228:231]
    v_rcp_f32 v91, v91
    v_mul_f32 v143, v143, v207
    v_mfma_f32_16x16x32_bf16 v[232:235], a[212:215], a[152:155], v[232:235]
    v_rcp_f32 v92, v92
    v_mul_f32 v156, v156, v220
    v_mfma_f32_16x16x32_bf16 v[236:239], a[212:215], a[156:159], v[236:239]
    v_rcp_f32 v93, v93
    v_mul_f32 v157, v157, v221
    v_mfma_f32_16x16x32_bf16 v[176:179], a[216:219], a[144:147], v[176:179]
    v_rcp_f32 v94, v94
    v_mul_f32 v158, v158, v222
    v_mfma_f32_16x16x32_bf16 v[180:183], a[216:219], a[148:151], v[180:183]
    v_rcp_f32 v95, v95
    v_mul_f32 v159, v159, v223
    v_mfma_f32_16x16x32_bf16 v[184:187], a[216:219], a[152:155], v[184:187]
    v_mul_f32 v88, v88, v140
    v_mul_f32 v89, v89, v141
    v_mul_f32 v90, v90, v142
    v_mfma_f32_16x16x32_bf16 v[188:191], a[216:219], a[156:159], v[188:191]
    v_mul_f32 v91, v91, v143
    v_mul_f32 v92, v92, v156
    s_add_u32 m0, s56, 91136
    s_add_u32 s57, s59, 911360
    v_mfma_f32_16x16x32_bf16 v[240:243], a[220:223], a[144:147], v[240:243]
    buffer_load_dwordx4 v16, s[16:19], s57 offen lds
    v_mul_f32 v93, v93, v157
    v_mul_f32 v94, v94, v158
    v_mfma_f32_16x16x32_bf16 v[244:247], a[220:223], a[148:151], v[244:247]
    v_mul_f32 v95, v95, v159
    v_cvt_pk_bf16_f32 v116, v88, v89
    v_cvt_pk_bf16_f32 v117, v90, v91
    v_mfma_f32_16x16x32_bf16 v[248:251], a[220:223], a[152:155], v[248:251]
    v_cvt_pk_bf16_f32 v118, v92, v93
    v_cvt_pk_bf16_f32 v119, v94, v95
    buffer_store_dwordx4 v[116:119], v2, s[24:27], s44 offen offset:768 sc1
    v_mfma_f32_16x16x32_bf16 v[252:255], a[220:223], a[156:159], v[252:255]
    s_waitcnt vmcnt(11)
    s_waitcnt lgkmcnt(0)
    s_barrier
    v_pk_fma_f32 v[160:161], v[64:65], v[36:37], v[160:161] op_sel_hi:[1,0,1]
    v_pk_fma_f32 v[162:163], v[66:67], v[36:37], v[162:163] op_sel_hi:[1,0,1]
    ds_read_b64_tr_b16 a[0:1], v120 offset:0
    v_pk_fma_f32 v[176:177], v[68:69], v[36:37], v[176:177] op_sel_hi:[1,0,1]
    v_pk_fma_f32 v[178:179], v[70:71], v[36:37], v[178:179] op_sel_hi:[1,0,1]
    ds_read_b64_tr_b16 a[2:3], v120 offset:2048
    v_pk_fma_f32 v[224:225], v[80:81], v[36:37], v[224:225] op_sel_hi:[1,0,1]
    v_pk_fma_f32 v[226:227], v[82:83], v[36:37], v[226:227] op_sel_hi:[1,0,1]
    ds_read_b64_tr_b16 a[4:5], v121 offset:0
    v_pk_fma_f32 v[240:241], v[84:85], v[36:37], v[240:241] op_sel_hi:[1,0,1]
    v_pk_fma_f32 v[242:243], v[86:87], v[36:37], v[242:243] op_sel_hi:[1,0,1]
    s_add_u32 m0, s56, 98304
    s_add_u32 s57, s59, 983040
    buffer_load_dwordx4 v16, s[16:19], s57 offen lds
    v_pk_mul_f32 v[88:89], v[160:161], v[36:37] op_sel:[0,1] op_sel_hi:[1,1]
    v_pk_mul_f32 v[90:91], v[162:163], v[36:37] op_sel:[0,1] op_sel_hi:[1,1]
    ds_read_b64_tr_b16 a[6:7], v121 offset:2048
    v_pk_mul_f32 v[92:93], v[176:177], v[36:37] op_sel:[0,1] op_sel_hi:[1,1]
    v_pk_mul_f32 v[94:95], v[178:179], v[36:37] op_sel:[0,1] op_sel_hi:[1,1]
    ds_read_b64_tr_b16 a[8:9], v122 offset:0
    v_exp_f32 v88, v88
    v_exp_f32 v89, v89
    ds_read_b64_tr_b16 a[10:11], v122 offset:2048
    v_exp_f32 v90, v90
    v_exp_f32 v91, v91
    ds_read_b64_tr_b16 a[12:13], v123 offset:0
    v_exp_f32 v92, v92
    v_exp_f32 v93, v93
    s_add_u32 m0, s56, 99328
    s_add_u32 s57, s59, 993280
    buffer_load_dwordx4 v16, s[16:19], s57 offen lds
    v_exp_f32 v94, v94
    v_exp_f32 v95, v95
    ds_read_b64_tr_b16 a[14:15], v123 offset:2048
    v_pk_mul_f32 v[96:97], v[160:161], v[224:225]
    v_pk_mul_f32 v[98:99], v[162:163], v[226:227]
    ds_read_b64_tr_b16 a[16:17], v120 offset:8192
    v_pk_mul_f32 v[100:101], v[176:177], v[240:241]
    v_pk_mul_f32 v[102:103], v[178:179], v[242:243]
    ds_read_b64_tr_b16 a[18:19], v120 offset:10240
    v_pk_fma_f32 v[88:89], v[88:89], v[38:39], v[38:39] op_sel_hi:[1,0,0]
    v_pk_fma_f32 v[90:91], v[90:91], v[38:39], v[38:39] op_sel_hi:[1,0,0]
    ds_read_b64_tr_b16 a[20:21], v121 offset:8192
    v_pk_fma_f32 v[92:93], v[92:93], v[38:39], v[38:39] op_sel_hi:[1,0,0]
    v_pk_fma_f32 v[94:95], v[94:95], v[38:39], v[38:39] op_sel_hi:[1,0,0]
    s_add_u32 m0, s56, 106496
    s_add_u32 s57, s60, 0
    buffer_load_dwordx4 v16, s[16:19], s57 offen lds
    v_rcp_f32 v88, v88
    v_rcp_f32 v89, v89
    ds_read_b64_tr_b16 a[22:23], v121 offset:10240
    v_rcp_f32 v90, v90
    v_rcp_f32 v91, v91
    ds_read_b64_tr_b16 a[24:25], v122 offset:8192
    v_rcp_f32 v92, v92
    v_rcp_f32 v93, v93
    ds_read_b64_tr_b16 a[26:27], v122 offset:10240
    v_rcp_f32 v94, v94
    v_rcp_f32 v95, v95
    ds_read_b64_tr_b16 a[28:29], v123 offset:8192
    v_pk_mul_f32 v[88:89], v[88:89], v[96:97]
    v_pk_mul_f32 v[90:91], v[90:91], v[98:99]
    s_add_u32 m0, s56, 107520
    s_add_u32 s57, s60, 10240
    buffer_load_dwordx4 v16, s[16:19], s57 offen lds
    v_pk_mul_f32 v[92:93], v[92:93], v[100:101]
    v_pk_mul_f32 v[94:95], v[94:95], v[102:103]
    ds_read_b64_tr_b16 a[30:31], v123 offset:10240
    v_cvt_pk_bf16_f32 v112, v88, v89
    v_cvt_pk_bf16_f32 v113, v90, v91
    v_cvt_pk_bf16_f32 v114, v92, v93
    v_cvt_pk_bf16_f32 v115, v94, v95
    buffer_store_dwordx4 v[112:115], v2, s[24:27], s45 offen offset:0 sc1
    s_waitcnt vmcnt(5)
    s_barrier
    s_mov_b64 exec, s[36:37]
    buffer_store_dword v24, v25, s[24:27], s48 offen offset:0 sc1
    s_mov_b64 exec, -1
    v_pk_fma_f32 v[164:165], v[64:65], v[40:41], v[164:165] op_sel_hi:[1,0,1]
    v_pk_fma_f32 v[166:167], v[66:67], v[40:41], v[166:167] op_sel_hi:[1,0,1]
    ds_read_b64_tr_b16 a[32:33], v120 offset:16384
    v_pk_fma_f32 v[180:181], v[68:69], v[40:41], v[180:181] op_sel_hi:[1,0,1]
    v_pk_fma_f32 v[182:183], v[70:71], v[40:41], v[182:183] op_sel_hi:[1,0,1]
    ds_read_b64_tr_b16 a[34:35], v120 offset:18432
    v_pk_fma_f32 v[228:229], v[80:81], v[40:41], v[228:229] op_sel_hi:[1,0,1]
    v_pk_fma_f32 v[230:231], v[82:83], v[40:41], v[230:231] op_sel_hi:[1,0,1]
    ds_read_b64_tr_b16 a[36:37], v121 offset:16384
    v_pk_fma_f32 v[244:245], v[84:85], v[40:41], v[244:245] op_sel_hi:[1,0,1]
    v_pk_fma_f32 v[246:247], v[86:87], v[40:41], v[246:247] op_sel_hi:[1,0,1]
    s_add_u32 m0, s56, 114688
    s_add_u32 s57, s59, 40960
    buffer_load_dwordx4 v16, s[16:19], s57 offen lds
    v_pk_mul_f32 v[88:89], v[164:165], v[40:41] op_sel:[0,1] op_sel_hi:[1,1]
    v_pk_mul_f32 v[90:91], v[166:167], v[40:41] op_sel:[0,1] op_sel_hi:[1,1]
    ds_read_b64_tr_b16 a[38:39], v121 offset:18432
    v_pk_mul_f32 v[92:93], v[180:181], v[40:41] op_sel:[0,1] op_sel_hi:[1,1]
    v_pk_mul_f32 v[94:95], v[182:183], v[40:41] op_sel:[0,1] op_sel_hi:[1,1]
    ds_read_b64_tr_b16 a[40:41], v122 offset:16384
    v_exp_f32 v88, v88
    v_exp_f32 v89, v89
    ds_read_b64_tr_b16 a[42:43], v122 offset:18432
    v_exp_f32 v90, v90
    v_exp_f32 v91, v91
    ds_read_b64_tr_b16 a[44:45], v123 offset:16384
    v_exp_f32 v92, v92
    v_exp_f32 v93, v93
    s_add_u32 m0, s56, 115712
    s_add_u32 s57, s59, 51200
    buffer_load_dwordx4 v16, s[16:19], s57 offen lds
    v_exp_f32 v94, v94
    v_exp_f32 v95, v95
    ds_read_b64_tr_b16 a[46:47], v123 offset:18432
    v_pk_mul_f32 v[96:97], v[164:165], v[228:229]
    v_pk_mul_f32 v[98:99], v[166:167], v[230:231]
    ds_read_b64_tr_b16 a[48:49], v120 offset:24576
    v_pk_mul_f32 v[100:101], v[180:181], v[244:245]
    v_pk_mul_f32 v[102:103], v[182:183], v[246:247]
    ds_read_b64_tr_b16 a[50:51], v120 offset:26624
    v_pk_fma_f32 v[88:89], v[88:89], v[42:43], v[42:43] op_sel_hi:[1,0,0]
    v_pk_fma_f32 v[90:91], v[90:91], v[42:43], v[42:43] op_sel_hi:[1,0,0]
    ds_read_b64_tr_b16 a[52:53], v121 offset:24576
    v_pk_fma_f32 v[92:93], v[92:93], v[42:43], v[42:43] op_sel_hi:[1,0,0]
    v_pk_fma_f32 v[94:95], v[94:95], v[42:43], v[42:43] op_sel_hi:[1,0,0]
    s_add_u32 m0, s56, 122880
    s_add_u32 s57, s59, 122880
    buffer_load_dwordx4 v16, s[16:19], s57 offen lds
    v_rcp_f32 v88, v88
    v_rcp_f32 v89, v89
    ds_read_b64_tr_b16 a[54:55], v121 offset:26624
    v_rcp_f32 v90, v90
    v_rcp_f32 v91, v91
    ds_read_b64_tr_b16 a[56:57], v122 offset:24576
    v_rcp_f32 v92, v92
    v_rcp_f32 v93, v93
    ds_read_b64_tr_b16 a[58:59], v122 offset:26624
    v_rcp_f32 v94, v94
    v_rcp_f32 v95, v95
    ds_read_b64_tr_b16 a[60:61], v123 offset:24576
    v_pk_mul_f32 v[88:89], v[88:89], v[96:97]
    v_pk_mul_f32 v[90:91], v[90:91], v[98:99]
    s_add_u32 m0, s56, 123904
    s_add_u32 s57, s59, 133120
    buffer_load_dwordx4 v16, s[16:19], s57 offen lds
    v_pk_mul_f32 v[92:93], v[92:93], v[100:101]
    v_pk_mul_f32 v[94:95], v[94:95], v[102:103]
    ds_read_b64_tr_b16 a[62:63], v123 offset:26624
    v_cvt_pk_bf16_f32 v116, v88, v89
    v_cvt_pk_bf16_f32 v117, v90, v91
    v_cvt_pk_bf16_f32 v118, v92, v93
    v_cvt_pk_bf16_f32 v119, v94, v95
    buffer_store_dwordx4 v[116:119], v2, s[24:27], s45 offen offset:256 sc1
    v_pk_fma_f32 v[168:169], v[64:65], v[44:45], v[168:169] op_sel_hi:[1,0,1]
    v_pk_fma_f32 v[170:171], v[66:67], v[44:45], v[170:171] op_sel_hi:[1,0,1]
    ds_read_b64_tr_b16 a[64:65], v120 offset:32768
    v_pk_fma_f32 v[184:185], v[68:69], v[44:45], v[184:185] op_sel_hi:[1,0,1]
    v_pk_fma_f32 v[186:187], v[70:71], v[44:45], v[186:187] op_sel_hi:[1,0,1]
    ds_read_b64_tr_b16 a[66:67], v120 offset:34816
    v_pk_fma_f32 v[232:233], v[80:81], v[44:45], v[232:233] op_sel_hi:[1,0,1]
    v_pk_fma_f32 v[234:235], v[82:83], v[44:45], v[234:235] op_sel_hi:[1,0,1]
    ds_read_b64_tr_b16 a[68:69], v121 offset:32768
    v_pk_fma_f32 v[248:249], v[84:85], v[44:45], v[248:249] op_sel_hi:[1,0,1]
    v_pk_fma_f32 v[250:251], v[86:87], v[44:45], v[250:251] op_sel_hi:[1,0,1]
    s_add_u32 m0, s56, 131072
    s_add_u32 s57, s59, 204800
    buffer_load_dwordx4 v16, s[16:19], s57 offen lds
    v_pk_mul_f32 v[88:89], v[168:169], v[44:45] op_sel:[0,1] op_sel_hi:[1,1]
    v_pk_mul_f32 v[90:91], v[170:171], v[44:45] op_sel:[0,1] op_sel_hi:[1,1]
    ds_read_b64_tr_b16 a[70:71], v121 offset:34816
    v_pk_mul_f32 v[92:93], v[184:185], v[44:45] op_sel:[0,1] op_sel_hi:[1,1]
    v_pk_mul_f32 v[94:95], v[186:187], v[44:45] op_sel:[0,1] op_sel_hi:[1,1]
    ds_read_b64_tr_b16 a[72:73], v122 offset:32768
    v_exp_f32 v88, v88
    v_exp_f32 v89, v89
    ds_read_b64_tr_b16 a[74:75], v122 offset:34816
    v_exp_f32 v90, v90
    v_exp_f32 v91, v91
    ds_read_b64_tr_b16 a[76:77], v123 offset:32768
    v_exp_f32 v92, v92
    v_exp_f32 v93, v93
    s_add_u32 m0, s56, 132096
    s_add_u32 s57, s59, 215040
    buffer_load_dwordx4 v16, s[16:19], s57 offen lds
    v_exp_f32 v94, v94
    v_exp_f32 v95, v95
    ds_read_b64_tr_b16 a[78:79], v123 offset:34816
    v_pk_mul_f32 v[96:97], v[168:169], v[232:233]
    v_pk_mul_f32 v[98:99], v[170:171], v[234:235]
    ds_read_b64_tr_b16 a[80:81], v120 offset:40960
    v_pk_mul_f32 v[100:101], v[184:185], v[248:249]
    v_pk_mul_f32 v[102:103], v[186:187], v[250:251]
    ds_read_b64_tr_b16 a[82:83], v120 offset:43008
    v_pk_fma_f32 v[88:89], v[88:89], v[46:47], v[46:47] op_sel_hi:[1,0,0]
    v_pk_fma_f32 v[90:91], v[90:91], v[46:47], v[46:47] op_sel_hi:[1,0,0]
    ds_read_b64_tr_b16 a[84:85], v121 offset:40960
    v_pk_fma_f32 v[92:93], v[92:93], v[46:47], v[46:47] op_sel_hi:[1,0,0]
    v_pk_fma_f32 v[94:95], v[94:95], v[46:47], v[46:47] op_sel_hi:[1,0,0]
    s_add_u32 m0, s56, 139264
    s_add_u32 s57, s59, 286720
    buffer_load_dwordx4 v16, s[16:19], s57 offen lds
    v_rcp_f32 v88, v88
    v_rcp_f32 v89, v89
    ds_read_b64_tr_b16 a[86:87], v121 offset:43008
    v_rcp_f32 v90, v90
    v_rcp_f32 v91, v91
    ds_read_b64_tr_b16 a[88:89], v122 offset:40960
    v_rcp_f32 v92, v92
    v_rcp_f32 v93, v93
    ds_read_b64_tr_b16 a[90:91], v122 offset:43008
    v_rcp_f32 v94, v94
    v_rcp_f32 v95, v95
    ds_read_b64_tr_b16 a[92:93], v123 offset:40960
    v_pk_mul_f32 v[88:89], v[88:89], v[96:97]
    v_pk_mul_f32 v[90:91], v[90:91], v[98:99]
    s_add_u32 m0, s56, 140288
    s_add_u32 s57, s59, 296960
    buffer_load_dwordx4 v16, s[16:19], s57 offen lds
    v_pk_mul_f32 v[92:93], v[92:93], v[100:101]
    v_pk_mul_f32 v[94:95], v[94:95], v[102:103]
    ds_read_b64_tr_b16 a[94:95], v123 offset:43008
    v_cvt_pk_bf16_f32 v112, v88, v89
    v_cvt_pk_bf16_f32 v113, v90, v91
    v_cvt_pk_bf16_f32 v114, v92, v93
    v_cvt_pk_bf16_f32 v115, v94, v95
    buffer_store_dwordx4 v[112:115], v2, s[24:27], s45 offen offset:512 sc1
    v_pk_fma_f32 v[172:173], v[64:65], v[48:49], v[172:173] op_sel_hi:[1,0,1]
    ds_read_b64_tr_b16 a[96:97], v120 offset:49152
    v_pk_fma_f32 v[174:175], v[66:67], v[48:49], v[174:175] op_sel_hi:[1,0,1]
    v_pk_fma_f32 v[188:189], v[68:69], v[48:49], v[188:189] op_sel_hi:[1,0,1]
    ds_read_b64_tr_b16 a[98:99], v120 offset:51200
    v_pk_fma_f32 v[190:191], v[70:71], v[48:49], v[190:191] op_sel_hi:[1,0,1]
    v_pk_fma_f32 v[236:237], v[80:81], v[48:49], v[236:237] op_sel_hi:[1,0,1]
    ds_read_b64_tr_b16 a[100:101], v121 offset:49152
    v_pk_fma_f32 v[238:239], v[82:83], v[48:49], v[238:239] op_sel_hi:[1,0,1]
    v_pk_fma_f32 v[252:253], v[84:85], v[48:49], v[252:253] op_sel_hi:[1,0,1]
    s_add_u32 m0, s56, 147456
    s_add_u32 s57, s59, 368640
    buffer_load_dwordx4 v16, s[16:19], s57 offen lds
    v_pk_fma_f32 v[254:255], v[86:87], v[48:49], v[254:255] op_sel_hi:[1,0,1]
    v_pk_mul_f32 v[88:89], v[172:173], v[48:49] op_sel:[0,1] op_sel_hi:[1,1]
    ds_read_b64_tr_b16 a[102:103], v121 offset:51200
    v_pk_mul_f32 v[90:91], v[174:175], v[48:49] op_sel:[0,1] op_sel_hi:[1,1]
    v_pk_mul_f32 v[92:93], v[188:189], v[48:49] op_sel:[0,1] op_sel_hi:[1,1]
    ds_read_b64_tr_b16 a[104:105], v122 offset:49152
    v_pk_mul_f32 v[94:95], v[190:191], v[48:49] op_sel:[0,1] op_sel_hi:[1,1]
    v_exp_f32 v88, v88
    ds_read_b64_tr_b16 a[106:107], v122 offset:51200
    v_exp_f32 v89, v89
    v_exp_f32 v90, v90
    ds_read_b64_tr_b16 a[108:109], v123 offset:49152
    v_exp_f32 v91, v91
    v_exp_f32 v92, v92
    s_add_u32 m0, s56, 148480
    s_add_u32 s57, s59, 378880
    buffer_load_dwordx4 v16, s[16:19], s57 offen lds
    v_exp_f32 v93, v93
    v_exp_f32 v94, v94
    ds_read_b64_tr_b16 a[110:111], v123 offset:51200
    v_exp_f32 v95, v95
    v_pk_mul_f32 v[96:97], v[172:173], v[236:237]
    ds_read_b64_tr_b16 a[112:113], v120 offset:57344
    v_pk_mul_f32 v[98:99], v[174:175], v[238:239]
    ds_read_b64_tr_b16 a[114:115], v120 offset:59392
    v_pk_mul_f32 v[100:101], v[188:189], v[252:253]
    v_pk_mul_f32 v[102:103], v[190:191], v[254:255]
    ds_read_b64_tr_b16 a[116:117], v121 offset:57344
    v_pk_fma_f32 v[88:89], v[88:89], v[50:51], v[50:51] op_sel_hi:[1,0,0]
    v_pk_fma_f32 v[90:91], v[90:91], v[50:51], v[50:51] op_sel_hi:[1,0,0]
    s_add_u32 m0, s56, 155648
    s_add_u32 s57, s59, 450560
    buffer_load_dwordx4 v16, s[16:19], s57 offen lds
    v_pk_fma_f32 v[92:93], v[92:93], v[50:51], v[50:51] op_sel_hi:[1,0,0]
    v_pk_fma_f32 v[94:95], v[94:95], v[50:51], v[50:51] op_sel_hi:[1,0,0]
    ds_read_b64_tr_b16 a[118:119], v121 offset:59392
    v_rcp_f32 v88, v88
    v_rcp_f32 v89, v89
    ds_read_b64_tr_b16 a[120:121], v122 offset:57344
    v_rcp_f32 v90, v90
    v_rcp_f32 v91, v91
    ds_read_b64_tr_b16 a[122:123], v122 offset:59392
    v_rcp_f32 v92, v92
    v_rcp_f32 v93, v93
    ds_read_b64_tr_b16 a[124:125], v123 offset:57344
    v_rcp_f32 v94, v94
    v_rcp_f32 v95, v95
    s_add_u32 m0, s56, 156672
    s_add_u32 s57, s59, 460800
    buffer_load_dwordx4 v16, s[16:19], s57 offen lds
    v_pk_mul_f32 v[88:89], v[88:89], v[96:97]
    v_pk_mul_f32 v[90:91], v[90:91], v[98:99]
    ds_read_b64_tr_b16 a[126:127], v123 offset:59392
    v_pk_mul_f32 v[92:93], v[92:93], v[100:101]
    v_pk_mul_f32 v[94:95], v[94:95], v[102:103]
    buffer_load_dword v23, v31, s[24:27], s49 offen offset:0 sc1
    v_cvt_pk_bf16_f32 v116, v88, v89
    v_cvt_pk_bf16_f32 v117, v90, v91
    v_cvt_pk_bf16_f32 v118, v92, v93
    v_cvt_pk_bf16_f32 v119, v94, v95
    buffer_store_dwordx4 v[116:119], v2, s[24:27], s45 offen offset:768 sc1
    s_waitcnt lgkmcnt(0)
    s_waitcnt vmcnt(1)
    v_cmp_eq_u32 vcc, 0, v23
    s_nop 1
    s_cbranch_vccnz g_waita
g_go:
    s_add_u32 s42, s61, 5390336
    buffer_load_dwordx4 v[128:131], v17, s[24:27], s42 offen offset:0 sc1
    buffer_load_dwordx4 v[132:135], v17, s[24:27], s42 offen offset:256 sc1
    buffer_load_dwordx4 v[136:139], v17, s[24:27], s42 offen offset:512 sc1
    s_add_u32 s42, s61, 5652480
    buffer_load_dwordx4 v[140:143], v17, s[24:27], s42 offen offset:0 sc1
    buffer_load_dwordx4 v[144:147], v17, s[24:27], s42 offen offset:256 sc1
    buffer_load_dwordx4 v[148:151], v17, s[24:27], s42 offen offset:512 sc1
    s_add_u32 s42, s61, 5914624
    buffer_load_dwordx4 v[152:155], v17, s[24:27], s42 offen offset:0 sc1
    buffer_load_dwordx4 v[156:159], v17, s[24:27], s42 offen offset:256 sc1
    buffer_load_dwordx4 v[160:163], v17, s[24:27], s42 offen offset:512 sc1
    s_add_u32 s42, s61, 6176768
    buffer_load_dwordx4 v[164:167], v17, s[24:27], s42 offen offset:0 sc1
    buffer_load_dwordx4 v[168:171], v17, s[24:27], s42 offen offset:256 sc1
    buffer_load_dwordx4 v[172:175], v17, s[24:27], s42 offen offset:512 sc1
    s_mov_b32 s43, 2768896
    v_add_u32 v4, 0x20000, v120
    v_add_u32 v5, 0x20000, v121
    v_add_u32 v6, 0x20000, v122
    v_add_u32 v7, 0x20000, v123
    s_waitcnt vmcnt(9)
    s_barrier
    s_mov_b64 exec, s[36:37]
    buffer_store_dword v24, v25, s[24:27], s48 offen offset:1024 sc1
    s_mov_b64 exec, -1
    v_mfma_f32_16x16x32_bf16 v[56:59], a[0:3], v[128:131], 0
    v_mfma_f32_16x16x32_bf16 v[60:63], a[0:3], v[132:135], 0
    s_add_u32 s42, s61, 6438912
    buffer_load_dwordx4 v[176:179], v17, s[24:27], s42 offen offset:0 sc1
    v_mfma_f32_16x16x32_bf16 v[64:67], a[0:3], v[136:139], 0
    buffer_load_dwordx4 v[180:183], v17, s[24:27], s42 offen offset:256 sc1
    v_mfma_f32_16x16x32_bf16 v[68:71], a[4:7], v[128:131], 0
    v_mfma_f32_16x16x32_bf16 v[72:75], a[4:7], v[132:135], 0
    buffer_load_dwordx4 v[184:187], v17, s[24:27], s42 offen offset:512 sc1
    v_mfma_f32_16x16x32_bf16 v[76:79], a[4:7], v[136:139], 0
    s_add_u32 m0, s56, 0
    s_add_u32 s57, s59, 532480
    buffer_load_dwordx4 v16, s[16:19], s57 offen lds
    v_mfma_f32_16x16x32_bf16 v[80:83], a[8:11], v[128:131], 0
    v_mfma_f32_16x16x32_bf16 v[84:87], a[8:11], v[132:135], 0
    s_add_u32 m0, s56, 1024
    s_add_u32 s57, s59, 542720
    buffer_load_dwordx4 v16, s[16:19], s57 offen lds
    v_mfma_f32_16x16x32_bf16 v[88:91], a[8:11], v[136:139], 0
    buffer_load_dwordx4 v[104:107], v18, s[24:27], s43 offen offset:0
    v_mfma_f32_16x16x32_bf16 v[92:95], a[12:15], v[128:131], 0
    v_mfma_f32_16x16x32_bf16 v[96:99], a[12:15], v[132:135], 0
    buffer_load_dwordx4 v[108:111], v18, s[24:27], s43 offen offset:256
    v_mfma_f32_16x16x32_bf16 v[100:103], a[12:15], v[136:139], 0
    buffer_load_dwordx4 v[112:115], v18, s[24:27], s43 offen offset:512
    s_waitcnt vmcnt(14)
    v_mfma_f32_16x16x32_bf16 v[56:59], a[16:19], v[140:143], v[56:59]
    v_mfma_f32_16x16x32_bf16 v[60:63], a[16:19], v[144:147], v[60:63]
    s_add_u32 s42, s61, 6701056
    buffer_load_dwordx4 v[188:191], v17, s[24:27], s42 offen offset:0 sc1
    v_mfma_f32_16x16x32_bf16 v[64:67], a[16:19], v[148:151], v[64:67]
    v_mfma_f32_16x16x32_bf16 v[68:71], a[20:23], v[140:143], v[68:71]
    v_mfma_f32_16x16x32_bf16 v[72:75], a[20:23], v[144:147], v[72:75]
    buffer_load_dwordx4 v[192:195], v17, s[24:27], s42 offen offset:256 sc1
    v_mfma_f32_16x16x32_bf16 v[76:79], a[20:23], v[148:151], v[76:79]
    v_mfma_f32_16x16x32_bf16 v[80:83], a[24:27], v[140:143], v[80:83]
    buffer_load_dwordx4 v[196:199], v17, s[24:27], s42 offen offset:512 sc1
    v_mfma_f32_16x16x32_bf16 v[84:87], a[24:27], v[144:147], v[84:87]
    v_mfma_f32_16x16x32_bf16 v[88:91], a[24:27], v[148:151], v[88:91]
    s_add_u32 m0, s56, 8192
    s_add_u32 s57, s59, 614400
    buffer_load_dwordx4 v16, s[16:19], s57 offen lds
    v_mfma_f32_16x16x32_bf16 v[92:95], a[28:31], v[140:143], v[92:95]
    v_mfma_f32_16x16x32_bf16 v[96:99], a[28:31], v[144:147], v[96:99]
    v_mfma_f32_16x16x32_bf16 v[100:103], a[28:31], v[148:151], v[100:103]
    s_add_u32 m0, s56, 9216
    s_add_u32 s57, s59, 624640
    buffer_load_dwordx4 v16, s[16:19], s57 offen lds
    s_waitcnt vmcnt(16)
    v_mfma_f32_16x16x32_bf16 v[56:59], a[32:35], v[152:155], v[56:59]
    v_mfma_f32_16x16x32_bf16 v[60:63], a[32:35], v[156:159], v[60:63]
    s_add_u32 s42, s61, 6963200
    buffer_load_dwordx4 v[200:203], v17, s[24:27], s42 offen offset:0 sc1
    v_mfma_f32_16x16x32_bf16 v[64:67], a[32:35], v[160:163], v[64:67]
    v_mfma_f32_16x16x32_bf16 v[68:71], a[36:39], v[152:155], v[68:71]
    v_mfma_f32_16x16x32_bf16 v[72:75], a[36:39], v[156:159], v[72:75]
    buffer_load_dwordx4 v[204:207], v17, s[24:27], s42 offen offset:256 sc1
    v_mfma_f32_16x16x32_bf16 v[76:79], a[36:39], v[160:163], v[76:79]
    v_mfma_f32_16x16x32_bf16 v[80:83], a[40:43], v[152:155], v[80:83]
    buffer_load_dwordx4 v[208:211], v17, s[24:27], s42 offen offset:512 sc1
    v_mfma_f32_16x16x32_bf16 v[84:87], a[40:43], v[156:159], v[84:87]
    v_mfma_f32_16x16x32_bf16 v[88:91], a[40:43], v[160:163], v[88:91]
    s_add_u32 m0, s56, 16384
    s_add_u32 s57, s59, 696320
    buffer_load_dwordx4 v16, s[16:19], s57 offen lds
    v_mfma_f32_16x16x32_bf16 v[92:95], a[44:47], v[152:155], v[92:95]
    v_mfma_f32_16x16x32_bf16 v[96:99], a[44:47], v[156:159], v[96:99]
    v_mfma_f32_16x16x32_bf16 v[100:103], a[44:47], v[160:163], v[100:103]
    s_add_u32 m0, s56, 17408
    s_add_u32 s57, s59, 706560
    buffer_load_dwordx4 v16, s[16:19], s57 offen lds
    s_waitcnt vmcnt(18)
    v_mfma_f32_16x16x32_bf16 v[56:59], a[48:51], v[164:167], v[56:59]
    v_mfma_f32_16x16x32_bf16 v[60:63], a[48:51], v[168:171], v[60:63]
    s_add_u32 s42, s61, 7225344
    buffer_load_dwordx4 v[212:215], v17, s[24:27], s42 offen offset:0 sc1
    v_mfma_f32_16x16x32_bf16 v[64:67], a[48:51], v[172:175], v[64:67]
    v_mfma_f32_16x16x32_bf16 v[68:71], a[52:55], v[164:167], v[68:71]
    v_mfma_f32_16x16x32_bf16 v[72:75], a[52:55], v[168:171], v[72:75]
    buffer_load_dwordx4 v[216:219], v17, s[24:27], s42 offen offset:256 sc1
    v_mfma_f32_16x16x32_bf16 v[76:79], a[52:55], v[172:175], v[76:79]
    v_mfma_f32_16x16x32_bf16 v[80:83], a[56:59], v[164:167], v[80:83]
    buffer_load_dwordx4 v[220:223], v17, s[24:27], s42 offen offset:512 sc1
    v_mfma_f32_16x16x32_bf16 v[84:87], a[56:59], v[168:171], v[84:87]
    v_mfma_f32_16x16x32_bf16 v[88:91], a[56:59], v[172:175], v[88:91]
    s_add_u32 m0, s56, 24576
    s_add_u32 s57, s59, 778240
    buffer_load_dwordx4 v16, s[16:19], s57 offen lds
    v_mfma_f32_16x16x32_bf16 v[92:95], a[60:63], v[164:167], v[92:95]
    v_mfma_f32_16x16x32_bf16 v[96:99], a[60:63], v[168:171], v[96:99]
    v_mfma_f32_16x16x32_bf16 v[100:103], a[60:63], v[172:175], v[100:103]
    s_add_u32 m0, s56, 25600
    s_add_u32 s57, s59, 788480
    buffer_load_dwordx4 v16, s[16:19], s57 offen lds
    s_waitcnt vmcnt(20)
    v_mfma_f32_16x16x32_bf16 v[56:59], a[64:67], v[176:179], v[56:59]
    v_mfma_f32_16x16x32_bf16 v[60:63], a[64:67], v[180:183], v[60:63]
    s_add_u32 s42, s61, 7487488
    buffer_load_dwordx4 v[224:227], v17, s[24:27], s42 offen offset:0 sc1
    v_mfma_f32_16x16x32_bf16 v[64:67], a[64:67], v[184:187], v[64:67]
    v_mfma_f32_16x16x32_bf16 v[68:71], a[68:71], v[176:179], v[68:71]
    v_mfma_f32_16x16x32_bf16 v[72:75], a[68:71], v[180:183], v[72:75]
    buffer_load_dwordx4 v[228:231], v17, s[24:27], s42 offen offset:256 sc1
    v_mfma_f32_16x16x32_bf16 v[76:79], a[68:71], v[184:187], v[76:79]
    v_mfma_f32_16x16x32_bf16 v[80:83], a[72:75], v[176:179], v[80:83]
    buffer_load_dwordx4 v[232:235], v17, s[24:27], s42 offen offset:512 sc1
    v_mfma_f32_16x16x32_bf16 v[84:87], a[72:75], v[180:183], v[84:87]
    v_mfma_f32_16x16x32_bf16 v[88:91], a[72:75], v[184:187], v[88:91]
    s_add_u32 m0, s56, 32768
    s_add_u32 s57, s59, 860160
    buffer_load_dwordx4 v16, s[16:19], s57 offen lds
    v_mfma_f32_16x16x32_bf16 v[92:95], a[76:79], v[176:179], v[92:95]
    v_mfma_f32_16x16x32_bf16 v[96:99], a[76:79], v[180:183], v[96:99]
    v_mfma_f32_16x16x32_bf16 v[100:103], a[76:79], v[184:187], v[100:103]
    s_add_u32 m0, s56, 33792
    s_add_u32 s57, s59, 870400
    buffer_load_dwordx4 v16, s[16:19], s57 offen lds
    s_waitcnt vmcnt(17)
    v_mfma_f32_16x16x32_bf16 v[56:59], a[80:83], v[188:191], v[56:59]
    v_mfma_f32_16x16x32_bf16 v[60:63], a[80:83], v[192:195], v[60:63]
    s_add_u32 s42, s61, 7749632
    buffer_load_dwordx4 v[236:239], v17, s[24:27], s42 offen offset:0 sc1
    v_mfma_f32_16x16x32_bf16 v[64:67], a[80:83], v[196:199], v[64:67]
    v_mfma_f32_16x16x32_bf16 v[68:71], a[84:87], v[188:191], v[68:71]
    v_mfma_f32_16x16x32_bf16 v[72:75], a[84:87], v[192:195], v[72:75]
    buffer_load_dwordx4 v[240:243], v17, s[24:27], s42 offen offset:256 sc1
    v_mfma_f32_16x16x32_bf16 v[76:79], a[84:87], v[196:199], v[76:79]
    v_mfma_f32_16x16x32_bf16 v[80:83], a[88:91], v[188:191], v[80:83]
    buffer_load_dwordx4 v[244:247], v17, s[24:27], s42 offen offset:512 sc1
    v_mfma_f32_16x16x32_bf16 v[84:87], a[88:91], v[192:195], v[84:87]
    v_mfma_f32_16x16x32_bf16 v[88:91], a[88:91], v[196:199], v[88:91]
    s_add_u32 m0, s56, 40960
    s_add_u32 s57, s59, 942080
    buffer_load_dwordx4 v16, s[16:19], s57 offen lds
    v_mfma_f32_16x16x32_bf16 v[92:95], a[92:95], v[188:191], v[92:95]
    v_mfma_f32_16x16x32_bf16 v[96:99], a[92:95], v[192:195], v[96:99]
    v_mfma_f32_16x16x32_bf16 v[100:103], a[92:95], v[196:199], v[100:103]
    s_add_u32 m0, s56, 41984
    s_add_u32 s57, s59, 952320
    buffer_load_dwordx4 v16, s[16:19], s57 offen lds
    s_waitcnt vmcnt(17)
    v_mfma_f32_16x16x32_bf16 v[56:59], a[96:99], v[200:203], v[56:59]
    v_mfma_f32_16x16x32_bf16 v[60:63], a[96:99], v[204:207], v[60:63]
    s_add_u32 s42, s61, 8011776
    buffer_load_dwordx4 v[128:131], v17, s[24:27], s42 offen offset:0 sc1
    v_mfma_f32_16x16x32_bf16 v[64:67], a[96:99], v[208:211], v[64:67]
    v_mfma_f32_16x16x32_bf16 v[68:71], a[100:103], v[200:203], v[68:71]
    v_mfma_f32_16x16x32_bf16 v[72:75], a[100:103], v[204:207], v[72:75]
    buffer_load_dwordx4 v[132:135], v17, s[24:27], s42 offen offset:256 sc1
    v_mfma_f32_16x16x32_bf16 v[76:79], a[100:103], v[208:211], v[76:79]
    v_mfma_f32_16x16x32_bf16 v[80:83], a[104:107], v[200:203], v[80:83]
    buffer_load_dwordx4 v[136:139], v17, s[24:27], s42 offen offset:512 sc1
    v_mfma_f32_16x16x32_bf16 v[84:87], a[104:107], v[204:207], v[84:87]
    v_mfma_f32_16x16x32_bf16 v[88:91], a[104:107], v[208:211], v[88:91]
    s_add_u32 m0, s56, 49152
    s_add_u32 s57, s59, 1024000
    buffer_load_dwordx4 v16, s[16:19], s57 offen lds
    v_mfma_f32_16x16x32_bf16 v[92:95], a[108:111], v[200:203], v[92:95]
    v_mfma_f32_16x16x32_bf16 v[96:99], a[108:111], v[204:207], v[96:99]
    v_mfma_f32_16x16x32_bf16 v[100:103], a[108:111], v[208:211], v[100:103]
    s_add_u32 m0, s56, 50176
    s_add_u32 s57, s59, 1034240
    buffer_load_dwordx4 v16, s[16:19], s57 offen lds
    s_waitcnt vmcnt(17)
    v_mfma_f32_16x16x32_bf16 v[56:59], a[112:115], v[212:215], v[56:59]
    ds_read_b64_tr_b16 a[128:129], v124 offset:0
    v_mfma_f32_16x16x32_bf16 v[60:63], a[112:115], v[216:219], v[60:63]
    ds_read_b64_tr_b16 a[130:131], v124 offset:2048
    v_mfma_f32_16x16x32_bf16 v[64:67], a[112:115], v[220:223], v[64:67]
    buffer_load_dword v23, v31, s[24:27], s49 offen offset:1024 sc1
    v_mfma_f32_16x16x32_bf16 v[68:71], a[116:119], v[212:215], v[68:71]
    ds_read_b64_tr_b16 a[132:133], v125 offset:0
    v_mfma_f32_16x16x32_bf16 v[72:75], a[116:119], v[216:219], v[72:75]
    ds_read_b64_tr_b16 a[134:135], v125 offset:2048
    v_mfma_f32_16x16x32_bf16 v[76:79], a[116:119], v[220:223], v[76:79]
    s_add_u32 s42, s61, 8273920
    buffer_load_dwordx4 v[140:143], v17, s[24:27], s42 offen offset:0 sc1
    v_mfma_f32_16x16x32_bf16 v[80:83], a[120:123], v[212:215], v[80:83]
    ds_read_b64_tr_b16 a[136:137], v126 offset:0
    v_mfma_f32_16x16x32_bf16 v[84:87], a[120:123], v[216:219], v[84:87]
    ds_read_b64_tr_b16 a[138:139], v126 offset:2048
    v_mfma_f32_16x16x32_bf16 v[88:91], a[120:123], v[220:223], v[88:91]
    buffer_load_dwordx4 v[144:147], v17, s[24:27], s42 offen offset:256 sc1
    v_mfma_f32_16x16x32_bf16 v[92:95], a[124:127], v[212:215], v[92:95]
    ds_read_b64_tr_b16 a[140:141], v127 offset:0
    v_mfma_f32_16x16x32_bf16 v[96:99], a[124:127], v[216:219], v[96:99]
    ds_read_b64_tr_b16 a[142:143], v127 offset:2048
    v_mfma_f32_16x16x32_bf16 v[100:103], a[124:127], v[220:223], v[100:103]
    buffer_load_dwordx4 v[148:151], v17, s[24:27], s42 offen offset:512 sc1
    s_waitcnt vmcnt(16)
    s_waitcnt lgkmcnt(0)
    v_mfma_f32_16x16x32_bf16 v[56:59], a[128:131], v[224:227], v[56:59]
    ds_read_b64_tr_b16 a[144:145], v124 offset:8192
    v_mfma_f32_16x16x32_bf16 v[60:63], a[128:131], v[228:231], v[60:63]
    ds_read_b64_tr_b16 a[146:147], v124 offset:10240
    v_mfma_f32_16x16x32_bf16 v[64:67], a[128:131], v[232:235], v[64:67]
    s_add_u32 s42, s61, 8536064
    buffer_load_dwordx4 v[152:155], v17, s[24:27], s42 offen offset:0 sc1
    v_mfma_f32_16x16x32_bf16 v[68:71], a[132:135], v[224:227], v[68:71]
    ds_read_b64_tr_b16 a[148:149], v125 offset:8192
    v_mfma_f32_16x16x32_bf16 v[72:75], a[132:135], v[228:231], v[72:75]
    ds_read_b64_tr_b16 a[150:151], v125 offset:10240
    v_mfma_f32_16x16x32_bf16 v[76:79], a[132:135], v[232:235], v[76:79]
    ds_read_b64_tr_b16 a[152:153], v126 offset:8192
    v_mfma_f32_16x16x32_bf16 v[80:83], a[136:139], v[224:227], v[80:83]
    buffer_load_dwordx4 v[156:159], v17, s[24:27], s42 offen offset:256 sc1
    v_mfma_f32_16x16x32_bf16 v[84:87], a[136:139], v[228:231], v[84:87]
    ds_read_b64_tr_b16 a[154:155], v126 offset:10240
    v_mfma_f32_16x16x32_bf16 v[88:91], a[136:139], v[232:235], v[88:91]
    ds_read_b64_tr_b16 a[156:157], v127 offset:8192
    v_mfma_f32_16x16x32_bf16 v[92:95], a[140:143], v[224:227], v[92:95]
    ds_read_b64_tr_b16 a[158:159], v127 offset:10240
    v_mfma_f32_16x16x32_bf16 v[96:99], a[140:143], v[228:231], v[96:99]
    buffer_load_dwordx4 v[160:163], v17, s[24:27], s42 offen offset:512 sc1
    v_mfma_f32_16x16x32_bf16 v[100:103], a[140:143], v[232:235], v[100:103]
    s_waitcnt vmcnt(14)
    s_waitcnt lgkmcnt(0)
    s_waitcnt vmcnt(6)
    v_cmp_eq_u32 vcc, 0, v23
    s_nop 1
    s_cbranch_vccnz g_waitb
g_gob:
    v_mfma_f32_16x16x32_bf16 v[56:59], a[144:147], v[236:239], v[56:59]
    ds_read_b64_tr_b16 a[128:129], v124 offset:16384
    v_mfma_f32_16x16x32_bf16 v[60:63], a[144:147], v[240:243], v[60:63]
    ds_read_b64_tr_b16 a[130:131], v124 offset:18432
    v_mfma_f32_16x16x32_bf16 v[64:67], a[144:147], v[244:247], v[64:67]
    s_add_u32 s42, s62, 5390336
    buffer_load_dwordx4 v[164:167], v17, s[24:27], s42 offen offset:0 sc1
    v_mfma_f32_16x16x32_bf16 v[68:71], a[148:151], v[236:239], v[68:71]
    ds_read_b64_tr_b16 a[132:133], v125 offset:16384
    v_mfma_f32_16x16x32_bf16 v[72:75], a[148:151], v[240:243], v[72:75]
    ds_read_b64_tr_b16 a[134:135], v125 offset:18432
    v_mfma_f32_16x16x32_bf16 v[76:79], a[148:151], v[244:247], v[76:79]
    buffer_load_dwordx4 v[168:171], v17, s[24:27], s42 offen offset:256 sc1
    v_mfma_f32_16x16x32_bf16 v[80:83], a[152:155], v[236:239], v[80:83]
    ds_read_b64_tr_b16 a[136:137], v126 offset:16384
    v_mfma_f32_16x16x32_bf16 v[84:87], a[152:155], v[240:243], v[84:87]
    ds_read_b64_tr_b16 a[138:139], v126 offset:18432
    v_mfma_f32_16x16x32_bf16 v[88:91], a[152:155], v[244:247], v[88:91]
    buffer_load_dwordx4 v[172:175], v17, s[24:27], s42 offen offset:512 sc1
    v_mfma_f32_16x16x32_bf16 v[92:95], a[156:159], v[236:239], v[92:95]
    ds_read_b64_tr_b16 a[140:141], v127 offset:16384
    v_mfma_f32_16x16x32_bf16 v[96:99], a[156:159], v[240:243], v[96:99]
    ds_read_b64_tr_b16 a[142:143], v127 offset:18432
    v_mfma_f32_16x16x32_bf16 v[100:103], a[156:159], v[244:247], v[100:103]
    s_add_u32 s42, s61, 5521408
    buffer_load_dwordx4 v[176:179], v17, s[24:27], s42 offen offset:0 sc1
    s_waitcnt lgkmcnt(0)
    v_mfma_f32_16x16x32_bf16 v[56:59], a[128:131], v[128:131], v[56:59]
    ds_read_b64_tr_b16 a[144:145], v124 offset:24576
    v_mfma_f32_16x16x32_bf16 v[60:63], a[128:131], v[132:135], v[60:63]
    ds_read_b64_tr_b16 a[146:147], v124 offset:26624
    v_mfma_f32_16x16x32_bf16 v[64:67], a[128:131], v[136:139], v[64:67]
    buffer_load_dwordx4 v[180:183], v17, s[24:27], s42 offen offset:256 sc1
    v_mfma_f32_16x16x32_bf16 v[68:71], a[132:135], v[128:131], v[68:71]
    ds_read_b64_tr_b16 a[148:149], v125 offset:24576
    v_mfma_f32_16x16x32_bf16 v[72:75], a[132:135], v[132:135], v[72:75]
    ds_read_b64_tr_b16 a[150:151], v125 offset:26624
    v_mfma_f32_16x16x32_bf16 v[76:79], a[132:135], v[136:139], v[76:79]
    buffer_load_dwordx4 v[184:187], v17, s[24:27], s42 offen offset:512 sc1
    v_mfma_f32_16x16x32_bf16 v[80:83], a[136:139], v[128:131], v[80:83]
    ds_read_b64_tr_b16 a[152:153], v126 offset:24576
    v_mfma_f32_16x16x32_bf16 v[84:87], a[136:139], v[132:135], v[84:87]
    ds_read_b64_tr_b16 a[154:155], v126 offset:26624
    v_mfma_f32_16x16x32_bf16 v[88:91], a[136:139], v[136:139], v[88:91]
    s_add_u32 s42, s61, 5783552
    buffer_load_dwordx4 v[188:191], v17, s[24:27], s42 offen offset:0 sc1
    v_mfma_f32_16x16x32_bf16 v[92:95], a[140:143], v[128:131], v[92:95]
    ds_read_b64_tr_b16 a[156:157], v127 offset:24576
    v_mfma_f32_16x16x32_bf16 v[96:99], a[140:143], v[132:135], v[96:99]
    ds_read_b64_tr_b16 a[158:159], v127 offset:26624
    v_mfma_f32_16x16x32_bf16 v[100:103], a[140:143], v[136:139], v[100:103]
    buffer_load_dwordx4 v[192:195], v17, s[24:27], s42 offen offset:256 sc1
    s_waitcnt vmcnt(11)
    s_waitcnt lgkmcnt(0)
    v_mfma_f32_16x16x32_bf16 v[56:59], a[144:147], v[140:143], v[56:59]
    ds_read_b64_tr_b16 a[128:129], v124 offset:32768
    v_mfma_f32_16x16x32_bf16 v[60:63], a[144:147], v[144:147], v[60:63]
    ds_read_b64_tr_b16 a[130:131], v124 offset:34816
    v_mfma_f32_16x16x32_bf16 v[64:67], a[144:147], v[148:151], v[64:67]
    buffer_load_dwordx4 v[196:199], v17, s[24:27], s42 offen offset:512 sc1
    v_mfma_f32_16x16x32_bf16 v[68:71], a[148:151], v[140:143], v[68:71]
    ds_read_b64_tr_b16 a[132:133], v125 offset:32768
    v_mfma_f32_16x16x32_bf16 v[72:75], a[148:151], v[144:147], v[72:75]
    ds_read_b64_tr_b16 a[134:135], v125 offset:34816
    v_mfma_f32_16x16x32_bf16 v[76:79], a[148:151], v[148:151], v[76:79]
    s_add_u32 s42, s61, 6045696
    buffer_load_dwordx4 v[200:203], v17, s[24:27], s42 offen offset:0 sc1
    v_mfma_f32_16x16x32_bf16 v[80:83], a[152:155], v[140:143], v[80:83]
    ds_read_b64_tr_b16 a[136:137], v126 offset:32768
    v_mfma_f32_16x16x32_bf16 v[84:87], a[152:155], v[144:147], v[84:87]
    ds_read_b64_tr_b16 a[138:139], v126 offset:34816
    v_mfma_f32_16x16x32_bf16 v[88:91], a[152:155], v[148:151], v[88:91]
    buffer_load_dwordx4 v[204:207], v17, s[24:27], s42 offen offset:256 sc1
    v_mfma_f32_16x16x32_bf16 v[92:95], a[156:159], v[140:143], v[92:95]
    ds_read_b64_tr_b16 a[140:141], v127 offset:32768
    v_mfma_f32_16x16x32_bf16 v[96:99], a[156:159], v[144:147], v[96:99]
    ds_read_b64_tr_b16 a[142:143], v127 offset:34816
    v_mfma_f32_16x16x32_bf16 v[100:103], a[156:159], v[148:151], v[100:103]
    buffer_load_dwordx4 v[208:211], v17, s[24:27], s42 offen offset:512 sc1
    s_waitcnt vmcnt(12)
    s_waitcnt lgkmcnt(0)
    v_mfma_f32_16x16x32_bf16 v[56:59], a[128:131], v[152:155], v[56:59]
    ds_read_b64_tr_b16 a[144:145], v124 offset:40960
    v_mfma_f32_16x16x32_bf16 v[60:63], a[128:131], v[156:159], v[60:63]
    ds_read_b64_tr_b16 a[146:147], v124 offset:43008
    v_mfma_f32_16x16x32_bf16 v[64:67], a[128:131], v[160:163], v[64:67]
    s_add_u32 s42, s61, 6307840
    buffer_load_dwordx4 v[212:215], v17, s[24:27], s42 offen offset:0 sc1
    v_mfma_f32_16x16x32_bf16 v[68:71], a[132:135], v[152:155], v[68:71]
    ds_read_b64_tr_b16 a[148:149], v125 offset:40960
    v_mfma_f32_16x16x32_bf16 v[72:75], a[132:135], v[156:159], v[72:75]
    ds_read_b64_tr_b16 a[150:151], v125 offset:43008
    v_mfma_f32_16x16x32_bf16 v[76:79], a[132:135], v[160:163], v[76:79]
    buffer_load_dwordx4 v[216:219], v17, s[24:27], s42 offen offset:256 sc1
    v_mfma_f32_16x16x32_bf16 v[80:83], a[136:139], v[152:155], v[80:83]
    ds_read_b64_tr_b16 a[152:153], v126 offset:40960
    v_mfma_f32_16x16x32_bf16 v[84:87], a[136:139], v[156:159], v[84:87]
    ds_read_b64_tr_b16 a[154:155], v126 offset:43008
    v_mfma_f32_16x16x32_bf16 v[88:91], a[136:139], v[160:163], v[88:91]
    buffer_load_dwordx4 v[220:223], v17, s[24:27], s42 offen offset:512 sc1
    v_mfma_f32_16x16x32_bf16 v[92:95], a[140:143], v[152:155], v[92:95]
    ds_read_b64_tr_b16 a[156:157], v127 offset:40960
    v_mfma_f32_16x16x32_bf16 v[96:99], a[140:143], v[156:159], v[96:99]
    ds_read_b64_tr_b16 a[158:159], v127 offset:43008
    v_mfma_f32_16x16x32_bf16 v[100:103], a[140:143], v[160:163], v[100:103]
    s_add_u32 s42, s61, 6569984
    buffer_load_dwordx4 v[224:227], v17, s[24:27], s42 offen offset:0 sc1
    s_waitcnt vmcnt(13)
    s_waitcnt lgkmcnt(0)
    v_mfma_f32_16x16x32_bf16 v[56:59], a[144:147], v[164:167], v[56:59]
    ds_read_b64_tr_b16 a[128:129], v124 offset:49152
    v_mfma_f32_16x16x32_bf16 v[60:63], a[144:147], v[168:171], v[60:63]
    ds_read_b64_tr_b16 a[130:131], v124 offset:51200
    v_mfma_f32_16x16x32_bf16 v[64:67], a[144:147], v[172:175], v[64:67]
    buffer_load_dwordx4 v[228:231], v17, s[24:27], s42 offen offset:256 sc1
    v_mfma_f32_16x16x32_bf16 v[68:71], a[148:151], v[164:167], v[68:71]
    ds_read_b64_tr_b16 a[132:133], v125 offset:49152
    v_mfma_f32_16x16x32_bf16 v[72:75], a[148:151], v[168:171], v[72:75]
    ds_read_b64_tr_b16 a[134:135], v125 offset:51200
    v_mfma_f32_16x16x32_bf16 v[76:79], a[148:151], v[172:175], v[76:79]
    buffer_load_dwordx4 v[232:235], v17, s[24:27], s42 offen offset:512 sc1
    v_mfma_f32_16x16x32_bf16 v[80:83], a[152:155], v[164:167], v[80:83]
    ds_read_b64_tr_b16 a[136:137], v126 offset:49152
    v_mfma_f32_16x16x32_bf16 v[84:87], a[152:155], v[168:171], v[84:87]
    ds_read_b64_tr_b16 a[138:139], v126 offset:51200
    v_mfma_f32_16x16x32_bf16 v[88:91], a[152:155], v[172:175], v[88:91]
    s_add_u32 s42, s61, 6832128
    buffer_load_dwordx4 v[236:239], v17, s[24:27], s42 offen offset:0 sc1
    v_mfma_f32_16x16x32_bf16 v[92:95], a[156:159], v[164:167], v[92:95]
    ds_read_b64_tr_b16 a[140:141], v127 offset:49152
    v_mfma_f32_16x16x32_bf16 v[96:99], a[156:159], v[168:171], v[96:99]
    ds_read_b64_tr_b16 a[142:143], v127 offset:51200
    v_mfma_f32_16x16x32_bf16 v[100:103], a[156:159], v[172:175], v[100:103]
    buffer_load_dwordx4 v[240:243], v17, s[24:27], s42 offen offset:256 sc1
    s_waitcnt vmcnt(14)
    s_waitcnt lgkmcnt(0)
    v_mfma_f32_16x16x32_bf16 v[56:59], a[128:131], v[176:179], v[56:59]
    ds_read_b64_tr_b16 a[144:145], v124 offset:57344
    v_mfma_f32_16x16x32_bf16 v[60:63], a[128:131], v[180:183], v[60:63]
    ds_read_b64_tr_b16 a[146:147], v124 offset:59392
    v_mfma_f32_16x16x32_bf16 v[64:67], a[128:131], v[184:187], v[64:67]
    buffer_load_dwordx4 v[244:247], v17, s[24:27], s42 offen offset:512 sc1
    v_mfma_f32_16x16x32_bf16 v[68:71], a[132:135], v[176:179], v[68:71]
    ds_read_b64_tr_b16 a[148:149], v125 offset:57344
    v_mfma_f32_16x16x32_bf16 v[72:75], a[132:135], v[180:183], v[72:75]
    ds_read_b64_tr_b16 a[150:151], v125 offset:59392
    v_mfma_f32_16x16x32_bf16 v[76:79], a[132:135], v[184:187], v[76:79]
    s_add_u32 s42, s61, 7094272
    buffer_load_dwordx4 v[128:131], v17, s[24:27], s42 offen offset:0 sc1
    v_mfma_f32_16x16x32_bf16 v[80:83], a[136:139], v[176:179], v[80:83]
    ds_read_b64_tr_b16 a[152:153], v126 offset:57344
    v_mfma_f32_16x16x32_bf16 v[84:87], a[136:139], v[180:183], v[84:87]
    ds_read_b64_tr_b16 a[154:155], v126 offset:59392
    v_mfma_f32_16x16x32_bf16 v[88:91], a[136:139], v[184:187], v[88:91]
    buffer_load_dwordx4 v[132:135], v17, s[24:27], s42 offen offset:256 sc1
    v_mfma_f32_16x16x32_bf16 v[92:95], a[140:143], v[176:179], v[92:95]
    ds_read_b64_tr_b16 a[156:157], v127 offset:57344
    v_mfma_f32_16x16x32_bf16 v[96:99], a[140:143], v[180:183], v[96:99]
    ds_read_b64_tr_b16 a[158:159], v127 offset:59392
    v_mfma_f32_16x16x32_bf16 v[100:103], a[140:143], v[184:187], v[100:103]
    buffer_load_dwordx4 v[136:139], v17, s[24:27], s42 offen offset:512 sc1
    s_waitcnt vmcnt(15)
    s_waitcnt lgkmcnt(0)
    v_mfma_f32_16x16x32_bf16 v[56:59], a[144:147], v[188:191], v[56:59]
    ds_read_b64_tr_b16 a[128:129], v4 offset:0
    v_mfma_f32_16x16x32_bf16 v[60:63], a[144:147], v[192:195], v[60:63]
    ds_read_b64_tr_b16 a[130:131], v4 offset:2048
    v_mfma_f32_16x16x32_bf16 v[64:67], a[144:147], v[196:199], v[64:67]
    s_add_u32 s42, s61, 7356416
    buffer_load_dwordx4 v[140:143], v17, s[24:27], s42 offen offset:0 sc1
    v_mfma_f32_16x16x32_bf16 v[68:71], a[148:151], v[188:191], v[68:71]
    ds_read_b64_tr_b16 a[132:133], v5 offset:0
    v_mfma_f32_16x16x32_bf16 v[72:75], a[148:151], v[192:195], v[72:75]
    ds_read_b64_tr_b16 a[134:135], v5 offset:2048
    v_mfma_f32_16x16x32_bf16 v[76:79], a[148:151], v[196:199], v[76:79]
    buffer_load_dwordx4 v[144:147], v17, s[24:27], s42 offen offset:256 sc1
    v_mfma_f32_16x16x32_bf16 v[80:83], a[152:155], v[188:191], v[80:83]
    ds_read_b64_tr_b16 a[136:137], v6 offset:0
    v_mfma_f32_16x16x32_bf16 v[84:87], a[152:155], v[192:195], v[84:87]
    ds_read_b64_tr_b16 a[138:139], v6 offset:2048
    v_mfma_f32_16x16x32_bf16 v[88:91], a[152:155], v[196:199], v[88:91]
    buffer_load_dwordx4 v[148:151], v17, s[24:27], s42 offen offset:512 sc1
    v_mfma_f32_16x16x32_bf16 v[92:95], a[156:159], v[188:191], v[92:95]
    ds_read_b64_tr_b16 a[140:141], v7 offset:0
    v_mfma_f32_16x16x32_bf16 v[96:99], a[156:159], v[192:195], v[96:99]
    ds_read_b64_tr_b16 a[142:143], v7 offset:2048
    v_mfma_f32_16x16x32_bf16 v[100:103], a[156:159], v[196:199], v[100:103]
    s_add_u32 s42, s61, 7618560
    buffer_load_dwordx4 v[152:155], v17, s[24:27], s42 offen offset:0 sc1
    s_waitcnt vmcnt(16)
    s_waitcnt lgkmcnt(0)
    v_mfma_f32_16x16x32_bf16 v[56:59], a[128:131], v[200:203], v[56:59]
    ds_read_b64_tr_b16 a[144:145], v4 offset:8192
    v_mfma_f32_16x16x32_bf16 v[60:63], a[128:131], v[204:207], v[60:63]
    ds_read_b64_tr_b16 a[146:147], v4 offset:10240
    v_mfma_f32_16x16x32_bf16 v[64:67], a[128:131], v[208:211], v[64:67]
    buffer_load_dwordx4 v[156:159], v17, s[24:27], s42 offen offset:256 sc1
    v_mfma_f32_16x16x32_bf16 v[68:71], a[132:135], v[200:203], v[68:71]
    ds_read_b64_tr_b16 a[148:149], v5 offset:8192
    v_mfma_f32_16x16x32_bf16 v[72:75], a[132:135], v[204:207], v[72:75]
    ds_read_b64_tr_b16 a[150:151], v5 offset:10240
    v_mfma_f32_16x16x32_bf16 v[76:79], a[132:135], v[208:211], v[76:79]
    buffer_load_dwordx4 v[160:163], v17, s[24:27], s42 offen offset:512 sc1
    v_mfma_f32_16x16x32_bf16 v[80:83], a[136:139], v[200:203], v[80:83]
    ds_read_b64_tr_b16 a[152:153], v6 offset:8192
    v_mfma_f32_16x16x32_bf16 v[84:87], a[136:139], v[204:207], v[84:87]
    ds_read_b64_tr_b16 a[154:155], v6 offset:10240
    v_mfma_f32_16x16x32_bf16 v[88:91], a[136:139], v[208:211], v[88:91]
    s_add_u32 s42, s61, 7880704
    buffer_load_dwordx4 v[164:167], v17, s[24:27], s42 offen offset:0 sc1
    v_mfma_f32_16x16x32_bf16 v[92:95], a[140:143], v[200:203], v[92:95]
    ds_read_b64_tr_b16 a[156:157], v7 offset:8192
    v_mfma_f32_16x16x32_bf16 v[96:99], a[140:143], v[204:207], v[96:99]
    ds_read_b64_tr_b16 a[158:159], v7 offset:10240
    v_mfma_f32_16x16x32_bf16 v[100:103], a[140:143], v[208:211], v[100:103]
    buffer_load_dwordx4 v[168:171], v17, s[24:27], s42 offen offset:256 sc1
    s_waitcnt vmcnt(17)
    s_waitcnt lgkmcnt(0)
    v_mfma_f32_16x16x32_bf16 v[56:59], a[144:147], v[212:215], v[56:59]
    ds_read_b64_tr_b16 a[128:129], v4 offset:16384
    v_mfma_f32_16x16x32_bf16 v[60:63], a[144:147], v[216:219], v[60:63]
    ds_read_b64_tr_b16 a[130:131], v4 offset:18432
    v_mfma_f32_16x16x32_bf16 v[64:67], a[144:147], v[220:223], v[64:67]
    buffer_load_dwordx4 v[172:175], v17, s[24:27], s42 offen offset:512 sc1
    v_mfma_f32_16x16x32_bf16 v[68:71], a[148:151], v[212:215], v[68:71]
    ds_read_b64_tr_b16 a[132:133], v5 offset:16384
    v_mfma_f32_16x16x32_bf16 v[72:75], a[148:151], v[216:219], v[72:75]
    ds_read_b64_tr_b16 a[134:135], v5 offset:18432
    v_mfma_f32_16x16x32_bf16 v[76:79], a[148:151], v[220:223], v[76:79]
    s_add_u32 s42, s61, 8142848
    buffer_load_dwordx4 v[176:179], v17, s[24:27], s42 offen offset:0 sc1
    v_mfma_f32_16x16x32_bf16 v[80:83], a[152:155], v[212:215], v[80:83]
    ds_read_b64_tr_b16 a[136:137], v6 offset:16384
    v_mfma_f32_16x16x32_bf16 v[84:87], a[152:155], v[216:219], v[84:87]
    ds_read_b64_tr_b16 a[138:139], v6 offset:18432
    v_mfma_f32_16x16x32_bf16 v[88:91], a[152:155], v[220:223], v[88:91]
    buffer_load_dwordx4 v[180:183], v17, s[24:27], s42 offen offset:256 sc1
    v_mfma_f32_16x16x32_bf16 v[92:95], a[156:159], v[212:215], v[92:95]
    ds_read_b64_tr_b16 a[140:141], v7 offset:16384
    v_mfma_f32_16x16x32_bf16 v[96:99], a[156:159], v[216:219], v[96:99]
    ds_read_b64_tr_b16 a[142:143], v7 offset:18432
    v_mfma_f32_16x16x32_bf16 v[100:103], a[156:159], v[220:223], v[100:103]
    buffer_load_dwordx4 v[184:187], v17, s[24:27], s42 offen offset:512 sc1
    s_waitcnt vmcnt(18)
    s_waitcnt lgkmcnt(0)
    s_barrier
    v_mfma_f32_16x16x32_bf16 v[56:59], a[128:131], v[224:227], v[56:59]
    ds_read_b64_tr_b16 a[144:145], v4 offset:24576
    v_mfma_f32_16x16x32_bf16 v[60:63], a[128:131], v[228:231], v[60:63]
    ds_read_b64_tr_b16 a[146:147], v4 offset:26624
    v_mfma_f32_16x16x32_bf16 v[64:67], a[128:131], v[232:235], v[64:67]
    s_add_u32 s42, s61, 8404992
    buffer_load_dwordx4 v[188:191], v17, s[24:27], s42 offen offset:0 sc1
    v_mfma_f32_16x16x32_bf16 v[68:71], a[132:135], v[224:227], v[68:71]
    ds_read_b64_tr_b16 a[148:149], v5 offset:24576
    v_mfma_f32_16x16x32_bf16 v[72:75], a[132:135], v[228:231], v[72:75]
    ds_read_b64_tr_b16 a[150:151], v5 offset:26624
    v_mfma_f32_16x16x32_bf16 v[76:79], a[132:135], v[232:235], v[76:79]
    ds_read_b64_tr_b16 a[152:153], v6 offset:24576
    v_mfma_f32_16x16x32_bf16 v[80:83], a[136:139], v[224:227], v[80:83]
    buffer_load_dwordx4 v[192:195], v17, s[24:27], s42 offen offset:256 sc1
    v_mfma_f32_16x16x32_bf16 v[84:87], a[136:139], v[228:231], v[84:87]
    ds_read_b64_tr_b16 a[154:155], v6 offset:26624
    v_mfma_f32_16x16x32_bf16 v[88:91], a[136:139], v[232:235], v[88:91]
    ds_read_b64_tr_b16 a[156:157], v7 offset:24576
    v_mfma_f32_16x16x32_bf16 v[92:95], a[140:143], v[224:227], v[92:95]
    ds_read_b64_tr_b16 a[158:159], v7 offset:26624
    v_mfma_f32_16x16x32_bf16 v[96:99], a[140:143], v[228:231], v[96:99]
    buffer_load_dwordx4 v[196:199], v17, s[24:27], s42 offen offset:512 sc1
    v_mfma_f32_16x16x32_bf16 v[100:103], a[140:143], v[232:235], v[100:103]
    s_waitcnt vmcnt(18)
    s_waitcnt lgkmcnt(0)
    v_mfma_f32_16x16x32_bf16 v[56:59], a[144:147], v[236:239], v[56:59]
    ds_read_b64_tr_b16 a[128:129], v120 offset:0
    v_mfma_f32_16x16x32_bf16 v[60:63], a[144:147], v[240:243], v[60:63]
    ds_read_b64_tr_b16 a[130:131], v120 offset:2048
    v_mfma_f32_16x16x32_bf16 v[64:67], a[144:147], v[244:247], v[64:67]
    s_add_u32 s42, s61, 8667136
    buffer_load_dwordx4 v[200:203], v17, s[24:27], s42 offen offset:0 sc1
    v_mfma_f32_16x16x32_bf16 v[68:71], a[148:151], v[236:239], v[68:71]
    ds_read_b64_tr_b16 a[132:133], v121 offset:0
    v_mfma_f32_16x16x32_bf16 v[72:75], a[148:151], v[240:243], v[72:75]
    ds_read_b64_tr_b16 a[134:135], v121 offset:2048
    v_mfma_f32_16x16x32_bf16 v[76:79], a[148:151], v[244:247], v[76:79]
    ds_read_b64_tr_b16 a[136:137], v122 offset:0
    v_mfma_f32_16x16x32_bf16 v[80:83], a[152:155], v[236:239], v[80:83]
    buffer_load_dwordx4 v[204:207], v17, s[24:27], s42 offen offset:256 sc1
    v_mfma_f32_16x16x32_bf16 v[84:87], a[152:155], v[240:243], v[84:87]
    ds_read_b64_tr_b16 a[138:139], v122 offset:2048
    v_mfma_f32_16x16x32_bf16 v[88:91], a[152:155], v[244:247], v[88:91]
    ds_read_b64_tr_b16 a[140:141], v123 offset:0
    v_mfma_f32_16x16x32_bf16 v[92:95], a[156:159], v[236:239], v[92:95]
    ds_read_b64_tr_b16 a[142:143], v123 offset:2048
    v_mfma_f32_16x16x32_bf16 v[96:99], a[156:159], v[240:243], v[96:99]
    buffer_load_dwordx4 v[208:211], v17, s[24:27], s42 offen offset:512 sc1
    v_mfma_f32_16x16x32_bf16 v[100:103], a[156:159], v[244:247], v[100:103]
    s_waitcnt vmcnt(18)
    s_waitcnt lgkmcnt(0)
    v_mfma_f32_16x16x32_bf16 v[56:59], a[128:131], v[128:131], v[56:59]
    ds_read_b64_tr_b16 a[144:145], v120 offset:8192
    v_mfma_f32_16x16x32_bf16 v[60:63], a[128:131], v[132:135], v[60:63]
    ds_read_b64_tr_b16 a[146:147], v120 offset:10240
    v_mfma_f32_16x16x32_bf16 v[64:67], a[128:131], v[136:139], v[64:67]
    v_lshlrev_b32 v20, 16, v104
    v_and_b32 v21, 0xffff0000, v104
    v_mfma_f32_16x16x32_bf16 v[68:71], a[132:135], v[128:131], v[68:71]
    ds_read_b64_tr_b16 a[148:149], v121 offset:8192
    v_mfma_f32_16x16x32_bf16 v[72:75], a[132:135], v[132:135], v[72:75]
    ds_read_b64_tr_b16 a[150:151], v121 offset:10240
    v_mfma_f32_16x16x32_bf16 v[76:79], a[132:135], v[136:139], v[76:79]
    v_lshlrev_b32 v22, 16, v105
    v_and_b32 v23, 0xffff0000, v105
    v_mfma_f32_16x16x32_bf16 v[80:83], a[136:139], v[128:131], v[80:83]
    ds_read_b64_tr_b16 a[152:153], v122 offset:8192
    v_mfma_f32_16x16x32_bf16 v[84:87], a[136:139], v[132:135], v[84:87]
    ds_read_b64_tr_b16 a[154:155], v122 offset:10240
    v_mfma_f32_16x16x32_bf16 v[88:91], a[136:139], v[136:139], v[88:91]
    v_lshlrev_b32 v24, 16, v106
    v_and_b32 v25, 0xffff0000, v106
    v_mfma_f32_16x16x32_bf16 v[92:95], a[140:143], v[128:131], v[92:95]
    ds_read_b64_tr_b16 a[156:157], v123 offset:8192
    v_mfma_f32_16x16x32_bf16 v[96:99], a[140:143], v[132:135], v[96:99]
    ds_read_b64_tr_b16 a[158:159], v123 offset:10240
    v_mfma_f32_16x16x32_bf16 v[100:103], a[140:143], v[136:139], v[100:103]
    v_lshlrev_b32 v26, 16, v107
    v_and_b32 v27, 0xffff0000, v107
    s_waitcnt vmcnt(15)
    s_waitcnt lgkmcnt(0)
    v_mfma_f32_16x16x32_bf16 v[56:59], a[144:147], v[140:143], v[56:59]
    ds_read_b64_tr_b16 a[128:129], v120 offset:16384
    v_mfma_f32_16x16x32_bf16 v[60:63], a[144:147], v[144:147], v[60:63]
    ds_read_b64_tr_b16 a[130:131], v120 offset:18432
    v_mfma_f32_16x16x32_bf16 v[64:67], a[144:147], v[148:151], v[64:67]
    v_lshlrev_b32 v28, 16, v108
    v_and_b32 v29, 0xffff0000, v108
    v_mfma_f32_16x16x32_bf16 v[68:71], a[148:151], v[140:143], v[68:71]
    ds_read_b64_tr_b16 a[132:133], v121 offset:16384
    v_mfma_f32_16x16x32_bf16 v[72:75], a[148:151], v[144:147], v[72:75]
    ds_read_b64_tr_b16 a[134:135], v121 offset:18432
    v_mfma_f32_16x16x32_bf16 v[76:79], a[148:151], v[148:151], v[76:79]
    v_lshlrev_b32 v30, 16, v109
    v_and_b32 v31, 0xffff0000, v109
    v_mfma_f32_16x16x32_bf16 v[80:83], a[152:155], v[140:143], v[80:83]
    ds_read_b64_tr_b16 a[136:137], v122 offset:16384
    v_mfma_f32_16x16x32_bf16 v[84:87], a[152:155], v[144:147], v[84:87]
    ds_read_b64_tr_b16 a[138:139], v122 offset:18432
    v_mfma_f32_16x16x32_bf16 v[88:91], a[152:155], v[148:151], v[88:91]
    v_lshlrev_b32 v32, 16, v110
    v_and_b32 v33, 0xffff0000, v110
    v_mfma_f32_16x16x32_bf16 v[92:95], a[156:159], v[140:143], v[92:95]
    ds_read_b64_tr_b16 a[140:141], v123 offset:16384
    v_mfma_f32_16x16x32_bf16 v[96:99], a[156:159], v[144:147], v[96:99]
    ds_read_b64_tr_b16 a[142:143], v123 offset:18432
    v_mfma_f32_16x16x32_bf16 v[100:103], a[156:159], v[148:151], v[100:103]
    v_lshlrev_b32 v34, 16, v111
    v_and_b32 v35, 0xffff0000, v111
    s_waitcnt vmcnt(12)
    s_waitcnt lgkmcnt(0)
    v_mfma_f32_16x16x32_bf16 v[56:59], a[128:131], v[152:155], v[56:59]
    ds_read_b64_tr_b16 a[144:145], v120 offset:24576
    v_mfma_f32_16x16x32_bf16 v[60:63], a[128:131], v[156:159], v[60:63]
    ds_read_b64_tr_b16 a[146:147], v120 offset:26624
    v_mfma_f32_16x16x32_bf16 v[64:67], a[128:131], v[160:163], v[64:67]
    v_lshlrev_b32 v36, 16, v112
    v_and_b32 v37, 0xffff0000, v112
    v_mfma_f32_16x16x32_bf16 v[68:71], a[132:135], v[152:155], v[68:71]
    ds_read_b64_tr_b16 a[148:149], v121 offset:24576
    v_mfma_f32_16x16x32_bf16 v[72:75], a[132:135], v[156:159], v[72:75]
    ds_read_b64_tr_b16 a[150:151], v121 offset:26624
    v_mfma_f32_16x16x32_bf16 v[76:79], a[132:135], v[160:163], v[76:79]
    v_lshlrev_b32 v38, 16, v113
    v_and_b32 v39, 0xffff0000, v113
    v_mfma_f32_16x16x32_bf16 v[80:83], a[136:139], v[152:155], v[80:83]
    ds_read_b64_tr_b16 a[152:153], v122 offset:24576
    v_mfma_f32_16x16x32_bf16 v[84:87], a[136:139], v[156:159], v[84:87]
    ds_read_b64_tr_b16 a[154:155], v122 offset:26624
    v_mfma_f32_16x16x32_bf16 v[88:91], a[136:139], v[160:163], v[88:91]
    v_lshlrev_b32 v40, 16, v114
    v_and_b32 v41, 0xffff0000, v114
    v_mfma_f32_16x16x32_bf16 v[92:95], a[140:143], v[152:155], v[92:95]
    ds_read_b64_tr_b16 a[156:157], v123 offset:24576
    v_mfma_f32_16x16x32_bf16 v[96:99], a[140:143], v[156:159], v[96:99]
    ds_read_b64_tr_b16 a[158:159], v123 offset:26624
    v_mfma_f32_16x16x32_bf16 v[100:103], a[140:143], v[160:163], v[100:103]
    v_lshlrev_b32 v42, 16, v115
    v_and_b32 v43, 0xffff0000, v115
    s_waitcnt vmcnt(9)
    s_waitcnt lgkmcnt(0)
    v_mfma_f32_16x16x32_bf16 v[56:59], a[144:147], v[164:167], v[56:59]
    ds_read_b64_tr_b16 a[128:129], v120 offset:32768
    v_mfma_f32_16x16x32_bf16 v[60:63], a[144:147], v[168:171], v[60:63]
    ds_read_b64_tr_b16 a[130:131], v120 offset:34816
    v_mfma_f32_16x16x32_bf16 v[64:67], a[144:147], v[172:175], v[64:67]
    ds_read_b64_tr_b16 a[132:133], v121 offset:32768
    v_mfma_f32_16x16x32_bf16 v[68:71], a[148:151], v[164:167], v[68:71]
    ds_read_b64_tr_b16 a[134:135], v121 offset:34816
    v_mfma_f32_16x16x32_bf16 v[72:75], a[148:151], v[168:171], v[72:75]
    ds_read_b64_tr_b16 a[136:137], v122 offset:32768
    v_mfma_f32_16x16x32_bf16 v[76:79], a[148:151], v[172:175], v[76:79]
    ds_read_b64_tr_b16 a[138:139], v122 offset:34816
    v_mfma_f32_16x16x32_bf16 v[80:83], a[152:155], v[164:167], v[80:83]
    ds_read_b64_tr_b16 a[140:141], v123 offset:32768
    v_mfma_f32_16x16x32_bf16 v[84:87], a[152:155], v[168:171], v[84:87]
    ds_read_b64_tr_b16 a[142:143], v123 offset:34816
    v_mfma_f32_16x16x32_bf16 v[88:91], a[152:155], v[172:175], v[88:91]
    v_mfma_f32_16x16x32_bf16 v[92:95], a[156:159], v[164:167], v[92:95]
    v_mfma_f32_16x16x32_bf16 v[96:99], a[156:159], v[168:171], v[96:99]
    v_mfma_f32_16x16x32_bf16 v[100:103], a[156:159], v[172:175], v[100:103]
    s_waitcnt vmcnt(6)
    s_waitcnt lgkmcnt(0)
    v_mfma_f32_16x16x32_bf16 v[56:59], a[128:131], v[176:179], v[56:59]
    ds_read_b64_tr_b16 a[144:145], v120 offset:40960
    v_mfma_f32_16x16x32_bf16 v[60:63], a[128:131], v[180:183], v[60:63]
    ds_read_b64_tr_b16 a[146:147], v120 offset:43008
    v_mfma_f32_16x16x32_bf16 v[64:67], a[128:131], v[184:187], v[64:67]
    ds_read_b64_tr_b16 a[148:149], v121 offset:40960
    v_mfma_f32_16x16x32_bf16 v[68:71], a[132:135], v[176:179], v[68:71]
    ds_read_b64_tr_b16 a[150:151], v121 offset:43008
    v_mfma_f32_16x16x32_bf16 v[72:75], a[132:135], v[180:183], v[72:75]
    ds_read_b64_tr_b16 a[152:153], v122 offset:40960
    v_mfma_f32_16x16x32_bf16 v[76:79], a[132:135], v[184:187], v[76:79]
    ds_read_b64_tr_b16 a[154:155], v122 offset:43008
    v_mfma_f32_16x16x32_bf16 v[80:83], a[136:139], v[176:179], v[80:83]
    ds_read_b64_tr_b16 a[156:157], v123 offset:40960
    v_mfma_f32_16x16x32_bf16 v[84:87], a[136:139], v[180:183], v[84:87]
    ds_read_b64_tr_b16 a[158:159], v123 offset:43008
    v_mfma_f32_16x16x32_bf16 v[88:91], a[136:139], v[184:187], v[88:91]
    v_mfma_f32_16x16x32_bf16 v[92:95], a[140:143], v[176:179], v[92:95]
    v_mfma_f32_16x16x32_bf16 v[96:99], a[140:143], v[180:183], v[96:99]
    v_mfma_f32_16x16x32_bf16 v[100:103], a[140:143], v[184:187], v[100:103]
    s_waitcnt vmcnt(3)
    s_waitcnt lgkmcnt(0)
    v_mfma_f32_16x16x32_bf16 v[56:59], a[144:147], v[188:191], v[56:59]
    ds_read_b64_tr_b16 a[128:129], v120 offset:49152
    v_mfma_f32_16x16x32_bf16 v[60:63], a[144:147], v[192:195], v[60:63]
    ds_read_b64_tr_b16 a[130:131], v120 offset:51200
    v_mfma_f32_16x16x32_bf16 v[64:67], a[144:147], v[196:199], v[64:67]
    ds_read_b64_tr_b16 a[132:133], v121 offset:49152
    v_mfma_f32_16x16x32_bf16 v[68:71], a[148:151], v[188:191], v[68:71]
    ds_read_b64_tr_b16 a[134:135], v121 offset:51200
    v_mfma_f32_16x16x32_bf16 v[72:75], a[148:151], v[192:195], v[72:75]
    ds_read_b64_tr_b16 a[136:137], v122 offset:49152
    v_mfma_f32_16x16x32_bf16 v[76:79], a[148:151], v[196:199], v[76:79]
    ds_read_b64_tr_b16 a[138:139], v122 offset:51200
    v_mfma_f32_16x16x32_bf16 v[80:83], a[152:155], v[188:191], v[80:83]
    ds_read_b64_tr_b16 a[140:141], v123 offset:49152
    v_mfma_f32_16x16x32_bf16 v[84:87], a[152:155], v[192:195], v[84:87]
    ds_read_b64_tr_b16 a[142:143], v123 offset:51200
    v_mfma_f32_16x16x32_bf16 v[88:91], a[152:155], v[196:199], v[88:91]
    v_mfma_f32_16x16x32_bf16 v[92:95], a[156:159], v[188:191], v[92:95]
    v_mfma_f32_16x16x32_bf16 v[96:99], a[156:159], v[192:195], v[96:99]
    v_mfma_f32_16x16x32_bf16 v[100:103], a[156:159], v[196:199], v[100:103]
    s_waitcnt vmcnt(0)
    s_waitcnt lgkmcnt(0)
    v_mfma_f32_16x16x32_bf16 v[80:83], a[136:139], v[200:203], v[80:83]
    v_mfma_f32_16x16x32_bf16 v[84:87], a[136:139], v[204:207], v[84:87]
    v_mfma_f32_16x16x32_bf16 v[88:91], a[136:139], v[208:211], v[88:91]
    v_mfma_f32_16x16x32_bf16 v[92:95], a[140:143], v[200:203], v[92:95]
    v_mfma_f32_16x16x32_bf16 v[96:99], a[140:143], v[204:207], v[96:99]
    v_mfma_f32_16x16x32_bf16 v[100:103], a[140:143], v[208:211], v[100:103]
    v_mfma_f32_16x16x32_bf16 v[56:59], a[128:131], v[200:203], v[56:59]
    v_mfma_f32_16x16x32_bf16 v[60:63], a[128:131], v[204:207], v[60:63]
    v_mfma_f32_16x16x32_bf16 v[64:67], a[128:131], v[208:211], v[64:67]
    v_mfma_f32_16x16x32_bf16 v[68:71], a[132:135], v[200:203], v[68:71]
    v_mfma_f32_16x16x32_bf16 v[72:75], a[132:135], v[204:207], v[72:75]
    v_mfma_f32_16x16x32_bf16 v[76:79], a[132:135], v[208:211], v[76:79]
    s_nop 2
    ds_write_b128 v54, v[80:83] offset:0
    ds_write_b128 v54, v[84:87] offset:1024
    ds_write_b128 v54, v[88:91] offset:2048
    ds_write_b128 v54, v[92:95] offset:3072
    ds_write_b128 v54, v[96:99] offset:4096
    ds_write_b128 v54, v[100:103] offset:5120
    s_waitcnt lgkmcnt(0)
    s_barrier
    ds_read_b128 v[80:83], v55 offset:0
    ds_read_b128 v[92:95], v55 offset:3072
    ds_read_b128 v[84:87], v55 offset:1024
    ds_read_b128 v[96:99], v55 offset:4096
    ds_read_b128 v[88:91], v55 offset:2048
    ds_read_b128 v[100:103], v55 offset:5120
    s_waitcnt lgkmcnt(4)
    v_pk_add_f32 v[56:57], v[56:57], v[80:81]
    v_pk_add_f32 v[58:59], v[58:59], v[82:83]
    v_pk_add_f32 v[68:69], v[68:69], v[92:93]
    v_pk_add_f32 v[70:71], v[70:71], v[94:95]
    s_nop 1
    v_permlane16_swap_b32 v56, v68
    v_permlane16_swap_b32 v57, v69
    v_permlane16_swap_b32 v58, v70
    v_permlane16_swap_b32 v59, v71
    s_nop 1
    v_pk_add_f32 v[56:57], v[56:57], v[20:21]
    v_pk_add_f32 v[58:59], v[58:59], v[22:23]
    v_pk_add_f32 v[68:69], v[68:69], v[24:25]
    v_pk_add_f32 v[70:71], v[70:71], v[26:27]
    v_cvt_pk_bf16_f32 v104, v56, v57
    v_cvt_pk_bf16_f32 v105, v58, v59
    v_cvt_pk_bf16_f32 v106, v68, v69
    v_cvt_pk_bf16_f32 v107, v70, v71
    buffer_store_dwordx4 v[104:107], v19, s[20:23], 0 offen
    v_add_u32 v19, 20480, v19
    s_waitcnt lgkmcnt(2)
    v_pk_add_f32 v[60:61], v[60:61], v[84:85]
    v_pk_add_f32 v[62:63], v[62:63], v[86:87]
    v_pk_add_f32 v[72:73], v[72:73], v[96:97]
    v_pk_add_f32 v[74:75], v[74:75], v[98:99]
    s_nop 1
    v_permlane16_swap_b32 v60, v72
    v_permlane16_swap_b32 v61, v73
    v_permlane16_swap_b32 v62, v74
    v_permlane16_swap_b32 v63, v75
    s_nop 1
    v_pk_add_f32 v[60:61], v[60:61], v[28:29]
    v_pk_add_f32 v[62:63], v[62:63], v[30:31]
    v_pk_add_f32 v[72:73], v[72:73], v[32:33]
    v_pk_add_f32 v[74:75], v[74:75], v[34:35]
    v_cvt_pk_bf16_f32 v108, v60, v61
    v_cvt_pk_bf16_f32 v109, v62, v63
    v_cvt_pk_bf16_f32 v110, v72, v73
    v_cvt_pk_bf16_f32 v111, v74, v75
    buffer_store_dwordx4 v[108:111], v19, s[20:23], 0 offen
    v_add_u32 v19, 20480, v19
    s_waitcnt lgkmcnt(0)
    v_pk_add_f32 v[64:65], v[64:65], v[88:89]
    v_pk_add_f32 v[66:67], v[66:67], v[90:91]
    v_pk_add_f32 v[76:77], v[76:77], v[100:101]
    v_pk_add_f32 v[78:79], v[78:79], v[102:103]
    s_nop 1
    v_permlane16_swap_b32 v64, v76
    v_permlane16_swap_b32 v65, v77
    v_permlane16_swap_b32 v66, v78
    v_permlane16_swap_b32 v67, v79
    s_nop 1
    v_pk_add_f32 v[64:65], v[64:65], v[36:37]
    v_pk_add_f32 v[66:67], v[66:67], v[38:39]
    v_pk_add_f32 v[76:77], v[76:77], v[40:41]
    v_pk_add_f32 v[78:79], v[78:79], v[42:43]
    v_cvt_pk_bf16_f32 v112, v64, v65
    v_cvt_pk_bf16_f32 v113, v66, v67
    v_cvt_pk_bf16_f32 v114, v76, v77
    v_cvt_pk_bf16_f32 v115, v78, v79
    buffer_store_dwordx4 v[112:115], v19, s[20:23], 0 offen
    s_endpgm
g_poll:
    buffer_load_dwordx2 v[20:21], v52, s[24:27], s43 offen sc1
    buffer_load_dwordx4 v[56:59], v26, s[24:27], s46 offen offset:0 sc1
    buffer_load_dwordx4 v[60:63], v26, s[24:27], s46 offen offset:64 sc1
    buffer_load_dwordx4 v[64:67], v26, s[24:27], s46 offen offset:128 sc1
    buffer_load_dwordx4 v[68:71], v26, s[24:27], s46 offen offset:192 sc1
    buffer_load_dwordx4 v[72:75], v26, s[24:27], s47 offen offset:0 sc1
    buffer_load_dwordx4 v[76:79], v26, s[24:27], s47 offen offset:64 sc1
    buffer_load_dwordx4 v[80:83], v26, s[24:27], s47 offen offset:128 sc1
    buffer_load_dwordx4 v[84:87], v26, s[24:27], s47 offen offset:192 sc1
    s_waitcnt vmcnt(0)
    v_add_u32 v23, -1, v21
    v_max3_u32 v23, v23, v56, v57
    v_max3_u32 v23, v23, v58, v59
    v_max3_u32 v23, v23, v60, v61
    v_max3_u32 v23, v23, v62, v63
    v_max3_u32 v23, v23, v64, v65
    v_max3_u32 v23, v23, v66, v67
    v_max3_u32 v23, v23, v68, v69
    v_max3_u32 v23, v23, v70, v71
    v_max3_u32 v23, v23, v72, v73
    v_max3_u32 v23, v23, v74, v75
    v_max3_u32 v23, v23, v76, v77
    v_max3_u32 v23, v23, v78, v79
    v_max3_u32 v23, v23, v80, v81
    v_max3_u32 v23, v23, v82, v83
    v_max3_u32 v23, v23, v84, v85
    v_max3_u32 v23, v23, v86, v87
    v_cmp_eq_u32 vcc, -1, v23
    s_nop 1
    s_cbranch_vccnz g_poll
    s_branch g_ready
g_waita:
    buffer_load_dword v23, v31, s[24:27], s49 offen offset:0 sc1
    s_waitcnt vmcnt(0)
    v_cmp_eq_u32 vcc, 0, v23
    s_nop 1
    s_cbranch_vccnz g_waita
    s_branch g_go
g_waitb:
    buffer_load_dword v23, v31, s[24:27], s49 offen offset:1024 sc1
    s_waitcnt vmcnt(0)
    v_cmp_eq_u32 vcc, 0, v23
    s_nop 1
    s_cbranch_vccnz g_waitb
    s_branch g_gob
g_only2:
    s_and_b32 s30, s29, 3
    s_waitcnt lgkmcnt(0)
    s_lshl_b32 s31, s30, 2
    s_add_u32 s31, s31, s32
    s_mul_i32 s31, s31, 12
    v_min_u32 v2, 59, v1
    v_mul_u32_u24 v4, 52, v2
    v_lshrrev_b32 v4, 8, v4
    v_mul_u32_u24 v5, 5, v4
    v_sub_u32 v2, v2, v5
    v_add_u32 v4, s31, v4
    v_bfe_u32 v5, v4, 5, 1
    v_mul_u32_u24 v5, 896, v5
    v_and_b32 v4, 0xdf, v4
    v_add_u32 v4, v4, v5
    v_mul_u32_u24 v4, 1280, v4
    v_lshl_add_u32 v2, v2, 7, v4
    s_and_b32 s33, s2, 1
    s_mul_i32 s33, s33, 640
    v_add_u32 v2, s33, v2
    buffer_load_dword v248, v2, s[16:19], 0 offen
    v_add_u32 v2, 245760, v2
    buffer_load_dword v248, v2, s[16:19], 0 offen
    v_add_u32 v2, 245760, v2
    buffer_load_dword v248, v2, s[16:19], 0 offen
    v_add_u32 v2, 245760, v2
    buffer_load_dword v248, v2, s[16:19], 0 offen
    v_add_u32 v2, 245760, v2
    buffer_load_dword v248, v2, s[16:19], 0 offen
    v_add_u32 v2, -942080, v2
    buffer_load_dword v248, v2, s[16:19], 0 offen
    v_add_u32 v2, 245760, v2
    buffer_load_dword v248, v2, s[16:19], 0 offen
    v_add_u32 v2, 245760, v2
    buffer_load_dword v248, v2, s[16:19], 0 offen
    v_add_u32 v2, 245760, v2
    buffer_load_dword v248, v2, s[16:19], 0 offen
    v_add_u32 v2, 245760, v2
    buffer_load_dword v248, v2, s[16:19], 0 offen
    v_add_u32 v2, 245760, v2
    s_waitcnt vmcnt(0)
    s_cmp_ge_u32 s29, 26
    s_cbranch_scc1 g_end
    s_lshr_b32 s54, s28, 1
    s_mul_i32 s54, s54, 28
    s_add_u32 s54, s54, s29
    s_mul_i32 s51, s54, 205
    s_lshr_b32 s51, s51, 10
    s_mul_i32 s50, s51, 5
    s_sub_u32 s50, s54, s50
    s_and_b32 s54, s28, 1
    s_mul_i32 s54, s54, 5
    s_add_u32 s50, s50, s54
    s_and_b32 s52, s32, 1
    s_lshr_b32 s53, s32, 1
    v_lshrrev_b32 v24, 3, v1
    v_mul_u32_u24 v16, 1280, v24
    v_and_b32 v24, 6, v24
    v_and_b32 v25, 7, v1
    v_xor_b32 v24, v24, v25
    v_lshl_add_u32 v16, v24, 4, v16
    s_lshl_b32 s54, s50, 7
    s_mul_i32 s55, s52, 20480
    s_add_u32 s54, s54, s55
    s_mul_i32 s55, s53, 1105920
    s_add_u32 s54, s54, s55
    v_add_u32 v16, s54, v16
    s_lshl_b32 s56, s53, 12
    s_lshl_b32 s55, s52, 11
    s_add_u32 s56, s56, s55
    s_mul_i32 s59, s53, 40960
    s_lshl_b32 s61, s53, 17
    s_xor_b32 s55, s53, 1
    s_mul_i32 s60, s55, 1064960
    s_mul_i32 s62, s55, 3407872
    s_mul_i32 s58, s51, 96
    s_mul_i32 s55, s52, 48
    s_add_u32 s54, s58, s55
    s_min_u32 s54, s54, 2000
    v_and_b32 v24, 15, v1
    v_add_u32 v24, s54, v24
    v_lshlrev_b32 v25, 4, v24
    v_lshrrev_b32 v27, 4, v1
    v_lshl_add_u32 v17, v27, 15, v25
    s_mul_i32 s55, s53, 3538944
    v_add_u32 v17, s55, v17
    v_and_b32 v28, 1, v27
    v_lshrrev_b32 v29, 1, v27
    v_lshl_add_u32 v28, v28, 1, v29
    s_lshl_b32 s54, s53, 2
    s_lshl_b32 s55, s50, 3
    s_add_u32 s54, s54, s55
    v_add_u32 v28, s54, v28
    v_lshl_add_u32 v18, v28, 15, v25
    v_mul_u32_u24 v19, 1280, v24
    v_lshl_add_u32 v19, v28, 4, v19
    s_mul_i32 s54, s32, 6144
    s_add_u32 s54, s54, 65536
    v_lshlrev_b32 v27, 4, v1
    v_add_u32 v54, s54, v27
    s_xor_b32 s54, s32, 2
    s_mul_i32 s54, s54, 6144
    s_add_u32 s54, s54, 65536
    v_add_u32 v55, s54, v27
    v_bfe_u32 v27, v1, 2, 4
    v_lshlrev_b32 v28, 7, v27
    v_and_b32 v29, 3, v1
    v_lshl_add_u32 v28, v29, 3, v28
    s_lshl_b32 s54, s53, 12
    v_add_u32 v28, s54, v28
    v_bfe_u32 v27, v27, 1, 2
    s_lshl_b32 s54, s53, 1
    v_xor_b32 v27, s54, v27
    v_xor_b32 v29, 0, v27
    v_lshl_add_u32 v120, v29, 5, v28
    v_add_u32 v124, 0x10000, v120
    v_xor_b32 v29, 1, v27
    v_lshl_add_u32 v121, v29, 5, v28
    v_add_u32 v125, 0x10000, v121
    v_xor_b32 v29, 2, v27
    v_lshl_add_u32 v122, v29, 5, v28
    v_add_u32 v126, 0x10000, v122
    v_xor_b32 v29, 3, v27
    v_lshl_add_u32 v123, v29, 5, v28
    v_add_u32 v127, 0x10000, v123
    v_lshrrev_b32 v27, 5, v1
    v_mul_u32_u24 v27, 95, v27
    v_add_u32 v27, s58, v27
    v_lshrrev_b32 v27, 8, v27
    v_min_u32 v27, 7, v27
    v_and_b32 v28, 31, v1
    v_min_u32 v28, 26, v28
    v_mul_u32_u24 v28, 4, v28
    v_lshl_add_u32 v31, v27, 11, v28
    v_mov_b32 v24, 1
    v_mov_b32 v25, 0
    s_mov_b32 s49, 2670592
    s_cmp_eq_u32 s32, 0
    s_cselect_b32 s36, 1, 0
    s_mov_b32 s37, 0
    s_mov_b32 s48, 2671104
    s_add_u32 m0, s56, 0
    s_add_u32 s57, s59, 0
    buffer_load_dwordx4 v16, s[16:19], s57 offen lds
    s_add_u32 m0, s56, 1024
    s_add_u32 s57, s59, 10240
    buffer_load_dwordx4 v16, s[16:19], s57 offen lds
    s_add_u32 m0, s56, 8192
    s_add_u32 s57, s59, 81920
    buffer_load_dwordx4 v16, s[16:19], s57 offen lds
    s_add_u32 m0, s56, 9216
    s_add_u32 s57, s59, 92160
    buffer_load_dwordx4 v16, s[16:19], s57 offen lds
    s_add_u32 m0, s56, 16384
    s_add_u32 s57, s59, 163840
    buffer_load_dwordx4 v16, s[16:19], s57 offen lds
    s_add_u32 m0, s56, 17408
    s_add_u32 s57, s59, 174080
    buffer_load_dwordx4 v16, s[16:19], s57 offen lds
    s_add_u32 m0, s56, 24576
    s_add_u32 s57, s59, 245760
    buffer_load_dwordx4 v16, s[16:19], s57 offen lds
    s_add_u32 m0, s56, 25600
    s_add_u32 s57, s59, 256000
    buffer_load_dwordx4 v16, s[16:19], s57 offen lds
    s_add_u32 m0, s56, 32768
    s_add_u32 s57, s59, 327680
    buffer_load_dwordx4 v16, s[16:19], s57 offen lds
    s_add_u32 m0, s56, 33792
    s_add_u32 s57, s59, 337920
    buffer_load_dwordx4 v16, s[16:19], s57 offen lds
    s_add_u32 m0, s56, 40960
    s_add_u32 s57, s59, 409600
    buffer_load_dwordx4 v16, s[16:19], s57 offen lds
    s_add_u32 m0, s56, 41984
    s_add_u32 s57, s59, 419840
    buffer_load_dwordx4 v16, s[16:19], s57 offen lds
    s_add_u32 m0, s56, 49152
    s_add_u32 s57, s59, 491520
    buffer_load_dwordx4 v16, s[16:19], s57 offen lds
    s_add_u32 m0, s56, 50176
    s_add_u32 s57, s59, 501760
    buffer_load_dwordx4 v16, s[16:19], s57 offen lds
    s_add_u32 m0, s56, 57344
    s_add_u32 s57, s59, 573440
    buffer_load_dwordx4 v16, s[16:19], s57 offen lds
    s_add_u32 m0, s56, 58368
    s_add_u32 s57, s59, 583680
    buffer_load_dwordx4 v16, s[16:19], s57 offen lds
    s_add_u32 m0, s56, 65536
    s_add_u32 s57, s59, 655360
    buffer_load_dwordx4 v16, s[16:19], s57 offen lds
    s_add_u32 m0, s56, 66560
    s_add_u32 s57, s59, 665600
    buffer_load_dwordx4 v16, s[16:19], s57 offen lds
    s_add_u32 m0, s56, 73728
    s_add_u32 s57, s59, 737280
    buffer_load_dwordx4 v16, s[16:19], s57 offen lds
    s_add_u32 m0, s56, 74752
    s_add_u32 s57, s59, 747520
    buffer_load_dwordx4 v16, s[16:19], s57 offen lds
    s_add_u32 m0, s56, 81920
    s_add_u32 s57, s59, 819200
    buffer_load_dwordx4 v16, s[16:19], s57 offen lds
    s_add_u32 m0, s56, 82944
    s_add_u32 s57, s59, 829440
    buffer_load_dwordx4 v16, s[16:19], s57 offen lds
    s_add_u32 m0, s56, 90112
    s_add_u32 s57, s59, 901120
    buffer_load_dwordx4 v16, s[16:19], s57 offen lds
    s_add_u32 m0, s56, 91136
    s_add_u32 s57, s59, 911360
    buffer_load_dwordx4 v16, s[16:19], s57 offen lds
    s_add_u32 m0, s56, 98304
    s_add_u32 s57, s59, 983040
    buffer_load_dwordx4 v16, s[16:19], s57 offen lds
    s_add_u32 m0, s56, 99328
    s_add_u32 s57, s59, 993280
    buffer_load_dwordx4 v16, s[16:19], s57 offen lds
    s_add_u32 m0, s56, 106496
    s_add_u32 s57, s60, 0
    buffer_load_dwordx4 v16, s[16:19], s57 offen lds
    s_add_u32 m0, s56, 107520
    s_add_u32 s57, s60, 10240
    buffer_load_dwordx4 v16, s[16:19], s57 offen lds
    s_add_u32 m0, s56, 114688
    s_add_u32 s57, s59, 40960
    buffer_load_dwordx4 v16, s[16:19], s57 offen lds
    s_add_u32 m0, s56, 115712
    s_add_u32 s57, s59, 51200
    buffer_load_dwordx4 v16, s[16:19], s57 offen lds
    s_add_u32 m0, s56, 122880
    s_add_u32 s57, s59, 122880
    buffer_load_dwordx4 v16, s[16:19], s57 offen lds
    s_add_u32 m0, s56, 123904
    s_add_u32 s57, s59, 133120
    buffer_load_dwordx4 v16, s[16:19], s57 offen lds
    s_add_u32 m0, s56, 131072
    s_add_u32 s57, s59, 204800
    buffer_load_dwordx4 v16, s[16:19], s57 offen lds
    s_add_u32 m0, s56, 132096
    s_add_u32 s57, s59, 215040
    buffer_load_dwordx4 v16, s[16:19], s57 offen lds
    s_add_u32 m0, s56, 139264
    s_add_u32 s57, s59, 286720
    buffer_load_dwordx4 v16, s[16:19], s57 offen lds
    s_add_u32 m0, s56, 140288
    s_add_u32 s57, s59, 296960
    buffer_load_dwordx4 v16, s[16:19], s57 offen lds
    s_add_u32 m0, s56, 147456
    s_add_u32 s57, s59, 368640
    buffer_load_dwordx4 v16, s[16:19], s57 offen lds
    s_add_u32 m0, s56, 148480
    s_add_u32 s57, s59, 378880
    buffer_load_dwordx4 v16, s[16:19], s57 offen lds
    s_add_u32 m0, s56, 155648
    s_add_u32 s57, s59, 450560
    buffer_load_dwordx4 v16, s[16:19], s57 offen lds
    s_add_u32 m0, s56, 156672
    s_add_u32 s57, s59, 460800
    buffer_load_dwordx4 v16, s[16:19], s57 offen lds
    s_waitcnt vmcnt(0)
    s_barrier
    ds_read_b64_tr_b16 a[0:1], v120 offset:0
    ds_read_b64_tr_b16 a[2:3], v120 offset:2048
    ds_read_b64_tr_b16 a[4:5], v121 offset:0
    ds_read_b64_tr_b16 a[6:7], v121 offset:2048
    ds_read_b64_tr_b16 a[8:9], v122 offset:0
    ds_read_b64_tr_b16 a[10:11], v122 offset:2048
    ds_read_b64_tr_b16 a[12:13], v123 offset:0
    ds_read_b64_tr_b16 a[14:15], v123 offset:2048
    s_waitcnt lgkmcnt(0)
    ds_read_b64_tr_b16 a[16:17], v120 offset:8192
    ds_read_b64_tr_b16 a[18:19], v120 offset:10240
    ds_read_b64_tr_b16 a[20:21], v121 offset:8192
    ds_read_b64_tr_b16 a[22:23], v121 offset:10240
    ds_read_b64_tr_b16 a[24:25], v122 offset:8192
    ds_read_b64_tr_b16 a[26:27], v122 offset:10240
    ds_read_b64_tr_b16 a[28:29], v123 offset:8192
    ds_read_b64_tr_b16 a[30:31], v123 offset:10240
    s_waitcnt lgkmcnt(0)
    ds_read_b64_tr_b16 a[32:33], v120 offset:16384
    ds_read_b64_tr_b16 a[34:35], v120 offset:18432
    ds_read_b64_tr_b16 a[36:37], v121 offset:16384
    ds_read_b64_tr_b16 a[38:39], v121 offset:18432
    ds_read_b64_tr_b16 a[40:41], v122 offset:16384
    ds_read_b64_tr_b16 a[42:43], v122 offset:18432
    ds_read_b64_tr_b16 a[44:45], v123 offset:16384
    ds_read_b64_tr_b16 a[46:47], v123 offset:18432
    s_waitcnt lgkmcnt(0)
    ds_read_b64_tr_b16 a[48:49], v120 offset:24576
    ds_read_b64_tr_b16 a[50:51], v120 offset:26624
    ds_read_b64_tr_b16 a[52:53], v121 offset:24576
    ds_read_b64_tr_b16 a[54:55], v121 offset:26624
    ds_read_b64_tr_b16 a[56:57], v122 offset:24576
    ds_read_b64_tr_b16 a[58:59], v122 offset:26624
    ds_read_b64_tr_b16 a[60:61], v123 offset:24576
    ds_read_b64_tr_b16 a[62:63], v123 offset:26624
    s_waitcnt lgkmcnt(0)
    ds_read_b64_tr_b16 a[64:65], v120 offset:32768
    ds_read_b64_tr_b16 a[66:67], v120 offset:34816
    ds_read_b64_tr_b16 a[68:69], v121 offset:32768
    ds_read_b64_tr_b16 a[70:71], v121 offset:34816
    ds_read_b64_tr_b16 a[72:73], v122 offset:32768
    ds_read_b64_tr_b16 a[74:75], v122 offset:34816
    ds_read_b64_tr_b16 a[76:77], v123 offset:32768
    ds_read_b64_tr_b16 a[78:79], v123 offset:34816
    s_waitcnt lgkmcnt(0)
    ds_read_b64_tr_b16 a[80:81], v120 offset:40960
    ds_read_b64_tr_b16 a[82:83], v120 offset:43008
    ds_read_b64_tr_b16 a[84:85], v121 offset:40960
    ds_read_b64_tr_b16 a[86:87], v121 offset:43008
    ds_read_b64_tr_b16 a[88:89], v122 offset:40960
    ds_read_b64_tr_b16 a[90:91], v122 offset:43008
    ds_read_b64_tr_b16 a[92:93], v123 offset:40960
    ds_read_b64_tr_b16 a[94:95], v123 offset:43008
    s_waitcnt lgkmcnt(0)
    ds_read_b64_tr_b16 a[96:97], v120 offset:49152
    ds_read_b64_tr_b16 a[98:99], v120 offset:51200
    ds_read_b64_tr_b16 a[100:101], v121 offset:49152
    ds_read_b64_tr_b16 a[102:103], v121 offset:51200
    ds_read_b64_tr_b16 a[104:105], v122 offset:49152
    ds_read_b64_tr_b16 a[106:107], v122 offset:51200
    ds_read_b64_tr_b16 a[108:109], v123 offset:49152
    ds_read_b64_tr_b16 a[110:111], v123 offset:51200
    s_waitcnt lgkmcnt(0)
    ds_read_b64_tr_b16 a[112:113], v120 offset:57344
    ds_read_b64_tr_b16 a[114:115], v120 offset:59392
    ds_read_b64_tr_b16 a[116:117], v121 offset:57344
    ds_read_b64_tr_b16 a[118:119], v121 offset:59392
    ds_read_b64_tr_b16 a[120:121], v122 offset:57344
    ds_read_b64_tr_b16 a[122:123], v122 offset:59392
    ds_read_b64_tr_b16 a[124:125], v123 offset:57344
    ds_read_b64_tr_b16 a[126:127], v123 offset:59392
    s_waitcnt lgkmcnt(0)
    s_barrier
    s_branch g_waita
g_help:
    s_lshl_b32 s31, s2, 6
    v_add_u32 v3, s31, v1
    v_lshlrev_b32 v2, 4, v3
    s_mul_i32 s33, s32, 655360
    s_add_u32 s33, s33, 2768896
    s_mov_b32 s48, 0x3f803f80
    s_waitcnt lgkmcnt(0)
    buffer_load_dwordx4 v[8:11], v2, s[24:27], s33 offen
    s_add_u32 s33, s33, 32768
    buffer_load_dwordx4 v[12:15], v2, s[24:27], s33 offen
    s_add_u32 s33, s33, 32768
    buffer_load_dwordx4 v[16:19], v2, s[24:27], s33 offen
    s_add_u32 s33, s33, 32768
    buffer_load_dwordx4 v[20:23], v2, s[24:27], s33 offen
    s_add_u32 s33, s33, 32768
    buffer_load_dwordx4 v[24:27], v2, s[24:27], s33 offen
    s_add_u32 s33, s33, 32768
    buffer_load_dwordx4 v[28:31], v2, s[24:27], s33 offen
    s_add_u32 s33, s33, 32768
    buffer_load_dwordx4 v[32:35], v2, s[24:27], s33 offen
    s_add_u32 s33, s33, 32768
    buffer_load_dwordx4 v[36:39], v2, s[24:27], s33 offen
    s_add_u32 s33, s33, 32768
    buffer_load_dwordx4 v[40:43], v2, s[24:27], s33 offen
    s_add_u32 s33, s33, 32768
    buffer_load_dwordx4 v[44:47], v2, s[24:27], s33 offen
    s_add_u32 s33, s33, 32768
    buffer_load_dwordx4 v[48:51], v2, s[24:27], s33 offen
    s_add_u32 s33, s33, 32768
    buffer_load_dwordx4 v[52:55], v2, s[24:27], s33 offen
    s_add_u32 s33, s33, 32768
    buffer_load_dwordx4 v[56:59], v2, s[24:27], s33 offen
    s_add_u32 s33, s33, 32768
    buffer_load_dwordx4 v[60:63], v2, s[24:27], s33 offen
    s_add_u32 s33, s33, 32768
    buffer_load_dwordx4 v[64:67], v2, s[24:27], s33 offen
    s_add_u32 s33, s33, 32768
    buffer_load_dwordx4 v[68:71], v2, s[24:27], s33 offen
    s_add_u32 s33, s33, 32768
    buffer_load_dwordx4 v[72:75], v2, s[24:27], s33 offen
    s_add_u32 s33, s33, 32768
    buffer_load_dwordx4 v[76:79], v2, s[24:27], s33 offen
    s_add_u32 s33, s33, 32768
    buffer_load_dwordx4 v[80:83], v2, s[24:27], s33 offen
    s_add_u32 s33, s33, 32768
    buffer_load_dwordx4 v[84:87], v2, s[24:27], s33 offen
    s_add_u32 s33, s33, 32768
    s_lshr_b32 s29, s2, 3
    s_and_b32 s34, s2, 1
    s_lshl_b32 s29, s29, 1
    s_add_u32 s29, s29, s34
    s_min_u32 s29, s29, 6
    s_lshr_b32 s30, s28, 1
    s_mul_i32 s30, s30, 7
    s_add_u32 s30, s30, s29
    s_min_u32 s30, s30, 26
    v_lshrrev_b32 v4, 3, v0
    v_mul_u32_u24 v2, 3456, v4
    v_bfe_u32 v5, v4, 1, 1
    v_bfe_u32 v6, v4, 3, 1
    v_lshl_or_b32 v5, v6, 1, v5
    v_lshlrev_b32 v5, 1, v5
    v_and_b32 v6, 7, v0
    v_xor_b32 v5, v5, v6
    v_lshl_add_u32 v2, v5, 4, v2
    s_lshl_b32 s33, s30, 7
    v_add_u32 v2, s33, v2
    s_lshl_b32 s40, s32, 10
    v_lshrrev_b32 v90, 4, v1
    v_bfe_u32 v91, v1, 2, 2
    v_lshl_add_u32 v92, v90, 3, v91
    v_lshlrev_b32 v92, 7, v92
    v_and_b32 v93, 3, v1
    v_lshl_add_u32 v92, v93, 3, v92
    v_lshrrev_b32 v91, 1, v91
    v_and_b32 v93, 1, v90
    v_lshl_or_b32 v91, v93, 1, v91
    v_xor_b32 v91, s32, v91
    v_lshl_add_u32 v88, v91, 5, v92
    v_add_u32 v89, 0x10000, v88
    v_add_u32 v90, 0x20000, v88
    s_lshr_b32 s33, s32, 1
    s_mul_i32 s33, s33, 3072
    s_add_u32 s33, s33, 155648
    v_lshlrev_b32 v3, 3, v3
    v_lshlrev_b32 v6, 3, v0
    v_add_u32 v6, s33, v6
    v_mov_b32 v92, s48
    v_mov_b32 v93, s48
    v_mov_b32 v94, s48
    v_mov_b32 v95, s48
    s_waitcnt vmcnt(19)
    v_dot2_f32_bf16 v4, v8, s48, 0
    v_dot2_f32_bf16 v5, v8, v8, 0
    v_dot2_f32_bf16 v4, v9, s48, v4
    v_dot2_f32_bf16 v5, v9, v9, v5
    v_dot2_f32_bf16 v4, v10, s48, v4
    v_dot2_f32_bf16 v5, v10, v10, v5
    v_dot2_f32_bf16 v4, v11, s48, v4
    v_dot2_f32_bf16 v5, v11, v11, v5
    s_add_u32 m0, s40, 0
    s_mov_b32 s41, 0
    buffer_load_dwordx4 v2, s[8:11], s41 offen lds
    s_add_u32 m0, s40, 4096
    s_mov_b32 s41, 0
    buffer_load_dwordx4 v2, s[12:15], s41 offen lds
    s_waitcnt vmcnt(20)
    v_dot2_f32_bf16 v4, v12, s48, v4
    v_dot2_f32_bf16 v5, v12, v12, v5
    v_dot2_f32_bf16 v4, v13, s48, v4
    v_dot2_f32_bf16 v5, v13, v13, v5
    v_dot2_f32_bf16 v4, v14, s48, v4
    v_dot2_f32_bf16 v5, v14, v14, v5
    v_dot2_f32_bf16 v4, v15, s48, v4
    v_dot2_f32_bf16 v5, v15, v15, v5
    s_add_u32 m0, s40, 8192
    s_mov_b32 s41, 110592
    buffer_load_dwordx4 v2, s[8:11], s41 offen lds
    s_add_u32 m0, s40, 12288
    s_mov_b32 s41, 110592
    buffer_load_dwordx4 v2, s[12:15], s41 offen lds
    s_waitcnt vmcnt(21)
    v_dot2_f32_bf16 v4, v16, s48, v4
    v_dot2_f32_bf16 v5, v16, v16, v5
    v_dot2_f32_bf16 v4, v17, s48, v4
    v_dot2_f32_bf16 v5, v17, v17, v5
    v_dot2_f32_bf16 v4, v18, s48, v4
    v_dot2_f32_bf16 v5, v18, v18, v5
    v_dot2_f32_bf16 v4, v19, s48, v4
    v_dot2_f32_bf16 v5, v19, v19, v5
    s_add_u32 m0, s40, 16384
    s_mov_b32 s41, 221184
    buffer_load_dwordx4 v2, s[8:11], s41 offen lds
    s_add_u32 m0, s40, 20480
    s_mov_b32 s41, 221184
    buffer_load_dwordx4 v2, s[12:15], s41 offen lds
    s_waitcnt vmcnt(22)
    v_dot2_f32_bf16 v4, v20, s48, v4
    v_dot2_f32_bf16 v5, v20, v20, v5
    v_dot2_f32_bf16 v4, v21, s48, v4
    v_dot2_f32_bf16 v5, v21, v21, v5
    v_dot2_f32_bf16 v4, v22, s48, v4
    v_dot2_f32_bf16 v5, v22, v22, v5
    v_dot2_f32_bf16 v4, v23, s48, v4
    v_dot2_f32_bf16 v5, v23, v23, v5
    s_add_u32 m0, s40, 24576
    s_mov_b32 s41, 331776
    buffer_load_dwordx4 v2, s[8:11], s41 offen lds
    s_add_u32 m0, s40, 28672
    s_mov_b32 s41, 331776
    buffer_load_dwordx4 v2, s[12:15], s41 offen lds
    s_waitcnt vmcnt(23)
    v_dot2_f32_bf16 v4, v24, s48, v4
    v_dot2_f32_bf16 v5, v24, v24, v5
    v_dot2_f32_bf16 v4, v25, s48, v4
    v_dot2_f32_bf16 v5, v25, v25, v5
    v_dot2_f32_bf16 v4, v26, s48, v4
    v_dot2_f32_bf16 v5, v26, v26, v5
    v_dot2_f32_bf16 v4, v27, s48, v4
    v_dot2_f32_bf16 v5, v27, v27, v5
    s_add_u32 m0, s40, 32768
    s_mov_b32 s41, 442368
    buffer_load_dwordx4 v2, s[8:11], s41 offen lds
    s_add_u32 m0, s40, 36864
    s_mov_b32 s41, 442368
    buffer_load_dwordx4 v2, s[12:15], s41 offen lds
    s_waitcnt vmcnt(24)
    v_dot2_f32_bf16 v4, v28, s48, v4
    v_dot2_f32_bf16 v5, v28, v28, v5
    v_dot2_f32_bf16 v4, v29, s48, v4
    v_dot2_f32_bf16 v5, v29, v29, v5
    v_dot2_f32_bf16 v4, v30, s48, v4
    v_dot2_f32_bf16 v5, v30, v30, v5
    v_dot2_f32_bf16 v4, v31, s48, v4
    v_dot2_f32_bf16 v5, v31, v31, v5
    s_add_u32 m0, s40, 40960
    s_mov_b32 s41, 552960
    buffer_load_dwordx4 v2, s[8:11], s41 offen lds
    s_add_u32 m0, s40, 45056
    s_mov_b32 s41, 552960
    buffer_load_dwordx4 v2, s[12:15], s41 offen lds
    s_waitcnt vmcnt(25)
    v_dot2_f32_bf16 v4, v32, s48, v4
    v_dot2_f32_bf16 v5, v32, v32, v5
    v_dot2_f32_bf16 v4, v33, s48, v4
    v_dot2_f32_bf16 v5, v33, v33, v5
    v_dot2_f32_bf16 v4, v34, s48, v4
    v_dot2_f32_bf16 v5, v34, v34, v5
    v_dot2_f32_bf16 v4, v35, s48, v4
    v_dot2_f32_bf16 v5, v35, v35, v5
    s_add_u32 m0, s40, 49152
    s_mov_b32 s41, 663552
    buffer_load_dwordx4 v2, s[8:11], s41 offen lds
    s_add_u32 m0, s40, 53248
    s_mov_b32 s41, 663552
    buffer_load_dwordx4 v2, s[12:15], s41 offen lds
    s_waitcnt vmcnt(26)
    v_dot2_f32_bf16 v4, v36, s48, v4
    v_dot2_f32_bf16 v5, v36, v36, v5
    v_dot2_f32_bf16 v4, v37, s48, v4
    v_dot2_f32_bf16 v5, v37, v37, v5
    v_dot2_f32_bf16 v4, v38, s48, v4
    v_dot2_f32_bf16 v5, v38, v38, v5
    v_dot2_f32_bf16 v4, v39, s48, v4
    v_dot2_f32_bf16 v5, v39, v39, v5
    s_add_u32 m0, s40, 57344
    s_mov_b32 s41, 774144
    buffer_load_dwordx4 v2, s[8:11], s41 offen lds
    s_add_u32 m0, s40, 61440
    s_mov_b32 s41, 774144
    buffer_load_dwordx4 v2, s[12:15], s41 offen lds
    s_waitcnt vmcnt(27)
    v_dot2_f32_bf16 v4, v40, s48, v4
    v_dot2_f32_bf16 v5, v40, v40, v5
    v_dot2_f32_bf16 v4, v41, s48, v4
    v_dot2_f32_bf16 v5, v41, v41, v5
    v_dot2_f32_bf16 v4, v42, s48, v4
    v_dot2_f32_bf16 v5, v42, v42, v5
    v_dot2_f32_bf16 v4, v43, s48, v4
    v_dot2_f32_bf16 v5, v43, v43, v5
    s_add_u32 m0, s40, 65536
    s_mov_b32 s41, 884736
    buffer_load_dwordx4 v2, s[8:11], s41 offen lds
    s_add_u32 m0, s40, 69632
    s_mov_b32 s41, 884736
    buffer_load_dwordx4 v2, s[12:15], s41 offen lds
    s_waitcnt vmcnt(28)
    v_dot2_f32_bf16 v4, v44, s48, v4
    v_dot2_f32_bf16 v5, v44, v44, v5
    v_dot2_f32_bf16 v4, v45, s48, v4
    v_dot2_f32_bf16 v5, v45, v45, v5
    v_dot2_f32_bf16 v4, v46, s48, v4
    v_dot2_f32_bf16 v5, v46, v46, v5
    v_dot2_f32_bf16 v4, v47, s48, v4
    v_dot2_f32_bf16 v5, v47, v47, v5
    s_add_u32 m0, s40, 73728
    s_mov_b32 s41, 995328
    buffer_load_dwordx4 v2, s[8:11], s41 offen lds
    s_add_u32 m0, s40, 77824
    s_mov_b32 s41, 995328
    buffer_load_dwordx4 v2, s[12:15], s41 offen lds
    s_waitcnt vmcnt(29)
    v_dot2_f32_bf16 v4, v48, s48, v4
    v_dot2_f32_bf16 v5, v48, v48, v5
    v_dot2_f32_bf16 v4, v49, s48, v4
    v_dot2_f32_bf16 v5, v49, v49, v5
    v_dot2_f32_bf16 v4, v50, s48, v4
    v_dot2_f32_bf16 v5, v50, v50, v5
    v_dot2_f32_bf16 v4, v51, s48, v4
    v_dot2_f32_bf16 v5, v51, v51, v5
    s_add_u32 m0, s40, 81920
    s_mov_b32 s41, 1105920
    buffer_load_dwordx4 v2, s[8:11], s41 offen lds
    s_add_u32 m0, s40, 86016
    s_mov_b32 s41, 1105920
    buffer_load_dwordx4 v2, s[12:15], s41 offen lds
    s_waitcnt vmcnt(30)
    v_dot2_f32_bf16 v4, v52, s48, v4
    v_dot2_f32_bf16 v5, v52, v52, v5
    v_dot2_f32_bf16 v4, v53, s48, v4
    v_dot2_f32_bf16 v5, v53, v53, v5
    v_dot2_f32_bf16 v4, v54, s48, v4
    v_dot2_f32_bf16 v5, v54, v54, v5
    v_dot2_f32_bf16 v4, v55, s48, v4
    v_dot2_f32_bf16 v5, v55, v55, v5
    s_add_u32 m0, s40, 90112
    s_mov_b32 s41, 1216512
    buffer_load_dwordx4 v2, s[8:11], s41 offen lds
    s_add_u32 m0, s40, 94208
    s_mov_b32 s41, 1216512
    buffer_load_dwordx4 v2, s[12:15], s41 offen lds
    s_waitcnt vmcnt(31)
    v_dot2_f32_bf16 v4, v56, s48, v4
    v_dot2_f32_bf16 v5, v56, v56, v5
    v_dot2_f32_bf16 v4, v57, s48, v4
    v_dot2_f32_bf16 v5, v57, v57, v5
    v_dot2_f32_bf16 v4, v58, s48, v4
    v_dot2_f32_bf16 v5, v58, v58, v5
    v_dot2_f32_bf16 v4, v59, s48, v4
    v_dot2_f32_bf16 v5, v59, v59, v5
    s_add_u32 m0, s40, 98304
    s_mov_b32 s41, 1327104
    buffer_load_dwordx4 v2, s[8:11], s41 offen lds
    s_add_u32 m0, s40, 102400
    s_mov_b32 s41, 1327104
    buffer_load_dwordx4 v2, s[12:15], s41 offen lds
    s_waitcnt vmcnt(32)
    v_dot2_f32_bf16 v4, v60, s48, v4
    v_dot2_f32_bf16 v5, v60, v60, v5
    v_dot2_f32_bf16 v4, v61, s48, v4
    v_dot2_f32_bf16 v5, v61, v61, v5
    v_dot2_f32_bf16 v4, v62, s48, v4
    v_dot2_f32_bf16 v5, v62, v62, v5
    v_dot2_f32_bf16 v4, v63, s48, v4
    v_dot2_f32_bf16 v5, v63, v63, v5
    s_add_u32 m0, s40, 106496
    s_mov_b32 s41, 1437696
    buffer_load_dwordx4 v2, s[8:11], s41 offen lds
    s_add_u32 m0, s40, 110592
    s_mov_b32 s41, 1437696
    buffer_load_dwordx4 v2, s[12:15], s41 offen lds
    s_waitcnt vmcnt(33)
    v_dot2_f32_bf16 v4, v64, s48, v4
    v_dot2_f32_bf16 v5, v64, v64, v5
    v_dot2_f32_bf16 v4, v65, s48, v4
    v_dot2_f32_bf16 v5, v65, v65, v5
    v_dot2_f32_bf16 v4, v66, s48, v4
    v_dot2_f32_bf16 v5, v66, v66, v5
    v_dot2_f32_bf16 v4, v67, s48, v4
    v_dot2_f32_bf16 v5, v67, v67, v5
    s_add_u32 m0, s40, 114688
    s_mov_b32 s41, 1548288
    buffer_load_dwordx4 v2, s[8:11], s41 offen lds
    s_add_u32 m0, s40, 118784
    s_mov_b32 s41, 1548288
    buffer_load_dwordx4 v2, s[12:15], s41 offen lds
    s_waitcnt vmcnt(34)
    v_dot2_f32_bf16 v4, v68, s48, v4
    v_dot2_f32_bf16 v5, v68, v68, v5
    v_dot2_f32_bf16 v4, v69, s48, v4
    v_dot2_f32_bf16 v5, v69, v69, v5
    v_dot2_f32_bf16 v4, v70, s48, v4
    v_dot2_f32_bf16 v5, v70, v70, v5
    v_dot2_f32_bf16 v4, v71, s48, v4
    v_dot2_f32_bf16 v5, v71, v71, v5
    s_add_u32 m0, s40, 122880
    s_mov_b32 s41, 1658880
    buffer_load_dwordx4 v2, s[8:11], s41 offen lds
    s_add_u32 m0, s40, 126976
    s_mov_b32 s41, 1658880
    buffer_load_dwordx4 v2, s[12:15], s41 offen lds
    s_waitcnt vmcnt(35)
    v_dot2_f32_bf16 v4, v72, s48, v4
    v_dot2_f32_bf16 v5, v72, v72, v5
    v_dot2_f32_bf16 v4, v73, s48, v4
    v_dot2_f32_bf16 v5, v73, v73, v5
    v_dot2_f32_bf16 v4, v74, s48, v4
    v_dot2_f32_bf16 v5, v74, v74, v5
    v_dot2_f32_bf16 v4, v75, s48, v4
    v_dot2_f32_bf16 v5, v75, v75, v5
    s_add_u32 m0, s40, 131072
    s_mov_b32 s41, 1769472
    buffer_load_dwordx4 v2, s[8:11], s41 offen lds
    s_add_u32 m0, s40, 135168
    s_mov_b32 s41, 1769472
    buffer_load_dwordx4 v2, s[12:15], s41 offen lds
    s_waitcnt vmcnt(36)
    v_dot2_f32_bf16 v4, v76, s48, v4
    v_dot2_f32_bf16 v5, v76, v76, v5
    v_dot2_f32_bf16 v4, v77, s48, v4
    v_dot2_f32_bf16 v5, v77, v77, v5
    v_dot2_f32_bf16 v4, v78, s48, v4
    v_dot2_f32_bf16 v5, v78, v78, v5
    v_dot2_f32_bf16 v4, v79, s48, v4
    v_dot2_f32_bf16 v5, v79, v79, v5
    s_add_u32 m0, s40, 139264
    s_mov_b32 s41, 1880064
    buffer_load_dwordx4 v2, s[8:11], s41 offen lds
    s_add_u32 m0, s40, 143360
    s_mov_b32 s41, 1880064
    buffer_load_dwordx4 v2, s[12:15], s41 offen lds
    s_waitcnt vmcnt(37)
    v_dot2_f32_bf16 v4, v80, s48, v4
    v_dot2_f32_bf16 v5, v80, v80, v5
    v_dot2_f32_bf16 v4, v81, s48, v4
    v_dot2_f32_bf16 v5, v81, v81, v5
    v_dot2_f32_bf16 v4, v82, s48, v4
    v_dot2_f32_bf16 v5, v82, v82, v5
    v_dot2_f32_bf16 v4, v83, s48, v4
    v_dot2_f32_bf16 v5, v83, v83, v5
    s_add_u32 m0, s40, 147456
    s_mov_b32 s41, 1990656
    buffer_load_dwordx4 v2, s[8:11], s41 offen lds
    s_add_u32 m0, s40, 151552
    s_mov_b32 s41, 1990656
    buffer_load_dwordx4 v2, s[12:15], s41 offen lds
    s_waitcnt vmcnt(38)
    v_dot2_f32_bf16 v4, v84, s48, v4
    v_dot2_f32_bf16 v5, v84, v84, v5
    v_dot2_f32_bf16 v4, v85, s48, v4
    v_dot2_f32_bf16 v5, v85, v85, v5
    v_dot2_f32_bf16 v4, v86, s48, v4
    v_dot2_f32_bf16 v5, v86, v86, v5
    v_dot2_f32_bf16 v4, v87, s48, v4
    v_dot2_f32_bf16 v5, v87, v87, v5
    s_nop 2
    ds_write_b64 v6, v[4:5]
    s_waitcnt lgkmcnt(0)
    s_barrier
    s_cmp_lg_u32 s32, 0
    s_cbranch_scc1 g_cs
    ds_read_b64 v[8:9], v6 offset:512
    ds_read_b64 v[10:11], v6 offset:4096
    ds_read_b64 v[12:13], v6 offset:4608
    s_mov_b32 s43, 2637824
    s_waitcnt lgkmcnt(0)
    v_pk_add_f32 v[4:5], v[4:5], v[8:9]
    v_pk_add_f32 v[10:11], v[10:11], v[12:13]
    v_pk_add_f32 v[4:5], v[4:5], v[10:11]
    v_mul_f32 v4, 0xbacccccd, v4
    v_mul_f32 v5, 0x3acccccd, v5
    v_fma_f32 v5, -v4, v4, v5
    v_cmp_gt_f32 vcc, 0, v5
    v_cndmask_b32 v5, v5, 0, vcc
    v_add_f32 v5, 0x3727c5ac, v5
    buffer_store_dwordx2 v[4:5], v3, s[24:27], s43 offen sc0 sc1
g_cs:
    s_add_u32 m0, s40, 155648
    s_mov_b32 s41, 2101248
    buffer_load_dwordx4 v2, s[8:11], s41 offen lds
    s_add_u32 m0, s40, 159744
    s_mov_b32 s41, 2101248
    buffer_load_dwordx4 v2, s[12:15], s41 offen lds
    s_lshl_b32 s31, s30, 8
    s_lshl_b32 s33, s32, 6
    s_add_u32 s31, s31, s33
    s_add_u32 s31, s31, 2654208
    s_add_u32 s33, s31, 6912
    v_and_b32 v6, 15, v1
    v_cmp_eq_u32 vcc, 0, v6
    s_waitcnt vmcnt(0) lgkmcnt(0)
    s_barrier
    ds_read_b64_tr_b16 v[8:9], v88 offset:0
    ds_read_b64_tr_b16 v[10:11], v88 offset:512
    ds_read_b64_tr_b16 v[12:13], v88 offset:4096
    ds_read_b64_tr_b16 v[14:15], v88 offset:4608
    ds_read_b64_tr_b16 v[16:17], v88 offset:8192
    ds_read_b64_tr_b16 v[18:19], v88 offset:8704
    ds_read_b64_tr_b16 v[20:21], v88 offset:12288
    ds_read_b64_tr_b16 v[22:23], v88 offset:12800
    ds_read_b64_tr_b16 v[24:25], v88 offset:16384
    ds_read_b64_tr_b16 v[26:27], v88 offset:16896
    s_waitcnt lgkmcnt(8)
    v_mfma_f32_16x16x32_bf16 v[96:99], v[8:11], v[92:95], 0
    ds_read_b64_tr_b16 v[28:29], v88 offset:20480
    ds_read_b64_tr_b16 v[30:31], v88 offset:20992
    s_waitcnt lgkmcnt(8)
    v_mfma_f32_16x16x32_bf16 v[100:103], v[12:15], v[92:95], 0
    ds_read_b64_tr_b16 v[32:33], v88 offset:24576
    ds_read_b64_tr_b16 v[34:35], v88 offset:25088
    s_waitcnt lgkmcnt(8)
    v_mfma_f32_16x16x32_bf16 v[96:99], v[16:19], v[92:95], v[96:99]
    ds_read_b64_tr_b16 v[36:37], v88 offset:28672
    ds_read_b64_tr_b16 v[38:39], v88 offset:29184
    s_waitcnt lgkmcnt(8)
    v_mfma_f32_16x16x32_bf16 v[100:103], v[20:23], v[92:95], v[100:103]
    ds_read_b64_tr_b16 v[8:9], v88 offset:32768
    ds_read_b64_tr_b16 v[10:11], v88 offset:33280
    s_waitcnt lgkmcnt(8)
    v_mfma_f32_16x16x32_bf16 v[96:99], v[24:27], v[92:95], v[96:99]
    ds_read_b64_tr_b16 v[12:13], v88 offset:36864
    ds_read_b64_tr_b16 v[14:15], v88 offset:37376
    s_waitcnt lgkmcnt(8)
    v_mfma_f32_16x16x32_bf16 v[100:103], v[28:31], v[92:95], v[100:103]
    ds_read_b64_tr_b16 v[16:17], v88 offset:40960
    ds_read_b64_tr_b16 v[18:19], v88 offset:41472
    s_waitcnt lgkmcnt(8)
    v_mfma_f32_16x16x32_bf16 v[96:99], v[32:35], v[92:95], v[96:99]
    ds_read_b64_tr_b16 v[20:21], v88 offset:45056
    ds_read_b64_tr_b16 v[22:23], v88 offset:45568
    s_waitcnt lgkmcnt(8)
    v_mfma_f32_16x16x32_bf16 v[100:103], v[36:39], v[92:95], v[100:103]
    ds_read_b64_tr_b16 v[24:25], v88 offset:49152
    ds_read_b64_tr_b16 v[26:27], v88 offset:49664
    s_waitcnt lgkmcnt(8)
    v_mfma_f32_16x16x32_bf16 v[96:99], v[8:11], v[92:95], v[96:99]
    ds_read_b64_tr_b16 v[28:29], v88 offset:53248
    ds_read_b64_tr_b16 v[30:31], v88 offset:53760
    s_waitcnt lgkmcnt(8)
    v_mfma_f32_16x16x32_bf16 v[100:103], v[12:15], v[92:95], v[100:103]
    ds_read_b64_tr_b16 v[32:33], v88 offset:57344
    ds_read_b64_tr_b16 v[34:35], v88 offset:57856
    s_waitcnt lgkmcnt(8)
    v_mfma_f32_16x16x32_bf16 v[96:99], v[16:19], v[92:95], v[96:99]
    ds_read_b64_tr_b16 v[36:37], v88 offset:61440
    ds_read_b64_tr_b16 v[38:39], v88 offset:61952
    s_waitcnt lgkmcnt(8)
    v_mfma_f32_16x16x32_bf16 v[100:103], v[20:23], v[92:95], v[100:103]
    ds_read_b64_tr_b16 v[8:9], v89 offset:0
    ds_read_b64_tr_b16 v[10:11], v89 offset:512
    s_waitcnt lgkmcnt(8)
    v_mfma_f32_16x16x32_bf16 v[96:99], v[24:27], v[92:95], v[96:99]
    ds_read_b64_tr_b16 v[12:13], v89 offset:4096
    ds_read_b64_tr_b16 v[14:15], v89 offset:4608
    s_waitcnt lgkmcnt(8)
    v_mfma_f32_16x16x32_bf16 v[100:103], v[28:31], v[92:95], v[100:103]
    ds_read_b64_tr_b16 v[16:17], v89 offset:8192
    ds_read_b64_tr_b16 v[18:19], v89 offset:8704
    s_waitcnt lgkmcnt(8)
    v_mfma_f32_16x16x32_bf16 v[96:99], v[32:35], v[92:95], v[96:99]
    ds_read_b64_tr_b16 v[20:21], v89 offset:12288
    ds_read_b64_tr_b16 v[22:23], v89 offset:12800
    s_waitcnt lgkmcnt(8)
    v_mfma_f32_16x16x32_bf16 v[100:103], v[36:39], v[92:95], v[100:103]
    ds_read_b64_tr_b16 v[24:25], v89 offset:16384
    ds_read_b64_tr_b16 v[26:27], v89 offset:16896
    s_waitcnt lgkmcnt(8)
    v_mfma_f32_16x16x32_bf16 v[96:99], v[8:11], v[92:95], v[96:99]
    ds_read_b64_tr_b16 v[28:29], v89 offset:20480
    ds_read_b64_tr_b16 v[30:31], v89 offset:20992
    s_waitcnt lgkmcnt(8)
    v_mfma_f32_16x16x32_bf16 v[100:103], v[12:15], v[92:95], v[100:103]
    ds_read_b64_tr_b16 v[32:33], v89 offset:24576
    ds_read_b64_tr_b16 v[34:35], v89 offset:25088
    s_waitcnt lgkmcnt(8)
    v_mfma_f32_16x16x32_bf16 v[96:99], v[16:19], v[92:95], v[96:99]
    ds_read_b64_tr_b16 v[36:37], v89 offset:28672
    ds_read_b64_tr_b16 v[38:39], v89 offset:29184
    s_waitcnt lgkmcnt(8)
    v_mfma_f32_16x16x32_bf16 v[100:103], v[20:23], v[92:95], v[100:103]
    ds_read_b64_tr_b16 v[8:9], v89 offset:32768
    ds_read_b64_tr_b16 v[10:11], v89 offset:33280
    s_waitcnt lgkmcnt(8)
    v_mfma_f32_16x16x32_bf16 v[96:99], v[24:27], v[92:95], v[96:99]
    ds_read_b64_tr_b16 v[12:13], v89 offset:36864
    ds_read_b64_tr_b16 v[14:15], v89 offset:37376
    s_waitcnt lgkmcnt(8)
    v_mfma_f32_16x16x32_bf16 v[100:103], v[28:31], v[92:95], v[100:103]
    ds_read_b64_tr_b16 v[16:17], v89 offset:40960
    ds_read_b64_tr_b16 v[18:19], v89 offset:41472
    s_waitcnt lgkmcnt(8)
    v_mfma_f32_16x16x32_bf16 v[96:99], v[32:35], v[92:95], v[96:99]
    ds_read_b64_tr_b16 v[20:21], v89 offset:45056
    ds_read_b64_tr_b16 v[22:23], v89 offset:45568
    s_waitcnt lgkmcnt(8)
    v_mfma_f32_16x16x32_bf16 v[100:103], v[36:39], v[92:95], v[100:103]
    ds_read_b64_tr_b16 v[24:25], v89 offset:49152
    ds_read_b64_tr_b16 v[26:27], v89 offset:49664
    s_waitcnt lgkmcnt(8)
    v_mfma_f32_16x16x32_bf16 v[96:99], v[8:11], v[92:95], v[96:99]
    ds_read_b64_tr_b16 v[28:29], v89 offset:53248
    ds_read_b64_tr_b16 v[30:31], v89 offset:53760
    s_waitcnt lgkmcnt(8)
    v_mfma_f32_16x16x32_bf16 v[100:103], v[12:15], v[92:95], v[100:103]
    ds_read_b64_tr_b16 v[32:33], v89 offset:57344
    ds_read_b64_tr_b16 v[34:35], v89 offset:57856
    s_waitcnt lgkmcnt(8)
    v_mfma_f32_16x16x32_bf16 v[96:99], v[16:19], v[92:95], v[96:99]
    ds_read_b64_tr_b16 v[36:37], v89 offset:61440
    ds_read_b64_tr_b16 v[38:39], v89 offset:61952
    s_waitcnt lgkmcnt(8)
    v_mfma_f32_16x16x32_bf16 v[100:103], v[20:23], v[92:95], v[100:103]
    ds_read_b64_tr_b16 v[8:9], v90 offset:0
    ds_read_b64_tr_b16 v[10:11], v90 offset:512
    s_waitcnt lgkmcnt(8)
    v_mfma_f32_16x16x32_bf16 v[96:99], v[24:27], v[92:95], v[96:99]
    ds_read_b64_tr_b16 v[12:13], v90 offset:4096
    ds_read_b64_tr_b16 v[14:15], v90 offset:4608
    s_waitcnt lgkmcnt(8)
    v_mfma_f32_16x16x32_bf16 v[100:103], v[28:31], v[92:95], v[100:103]
    ds_read_b64_tr_b16 v[16:17], v90 offset:8192
    ds_read_b64_tr_b16 v[18:19], v90 offset:8704
    s_waitcnt lgkmcnt(8)
    v_mfma_f32_16x16x32_bf16 v[96:99], v[32:35], v[92:95], v[96:99]
    ds_read_b64_tr_b16 v[20:21], v90 offset:12288
    ds_read_b64_tr_b16 v[22:23], v90 offset:12800
    s_waitcnt lgkmcnt(8)
    v_mfma_f32_16x16x32_bf16 v[100:103], v[36:39], v[92:95], v[100:103]
    ds_read_b64_tr_b16 v[24:25], v90 offset:16384
    ds_read_b64_tr_b16 v[26:27], v90 offset:16896
    s_waitcnt lgkmcnt(8)
    v_mfma_f32_16x16x32_bf16 v[96:99], v[8:11], v[92:95], v[96:99]
    ds_read_b64_tr_b16 v[28:29], v90 offset:20480
    ds_read_b64_tr_b16 v[30:31], v90 offset:20992
    s_waitcnt lgkmcnt(8)
    v_mfma_f32_16x16x32_bf16 v[100:103], v[12:15], v[92:95], v[100:103]
    ds_read_b64_tr_b16 v[32:33], v90 offset:24576
    ds_read_b64_tr_b16 v[34:35], v90 offset:25088
    s_waitcnt lgkmcnt(8)
    v_mfma_f32_16x16x32_bf16 v[96:99], v[16:19], v[92:95], v[96:99]
    ds_read_b64_tr_b16 v[36:37], v90 offset:28672
    ds_read_b64_tr_b16 v[38:39], v90 offset:29184
    s_waitcnt lgkmcnt(8)
    v_mfma_f32_16x16x32_bf16 v[100:103], v[20:23], v[92:95], v[100:103]
    s_waitcnt lgkmcnt(6)
    v_mfma_f32_16x16x32_bf16 v[96:99], v[24:27], v[92:95], v[96:99]
    s_waitcnt lgkmcnt(4)
    v_mfma_f32_16x16x32_bf16 v[100:103], v[28:31], v[92:95], v[100:103]
    s_waitcnt lgkmcnt(2)
    v_mfma_f32_16x16x32_bf16 v[96:99], v[32:35], v[92:95], v[96:99]
    s_waitcnt lgkmcnt(0)
    v_mfma_f32_16x16x32_bf16 v[100:103], v[36:39], v[92:95], v[100:103]
    s_nop 7
    s_nop 7
    v_min_u32 v96, -2, v96
    v_min_u32 v97, -2, v97
    v_min_u32 v98, -2, v98
    v_min_u32 v99, -2, v99
    v_min_u32 v100, -2, v100
    v_min_u32 v101, -2, v101
    v_min_u32 v102, -2, v102
    v_min_u32 v103, -2, v103
    s_and_saveexec_b64 s[34:35], vcc
    buffer_store_dwordx4 v[96:99], v1, s[24:27], s31 offen sc0 sc1
    buffer_store_dwordx4 v[100:103], v1, s[24:27], s33 offen sc0 sc1
    s_mov_b64 exec, -1
    s_lshr_b32 s29, s2, 3
    s_lshl_b32 s31, s29, 2
    s_add_u32 s31, s31, s32
    s_mul_i32 s31, s31, 12
    v_min_u32 v2, 59, v1
    v_mul_u32_u24 v4, 52, v2
    v_lshrrev_b32 v4, 8, v4
    v_mul_u32_u24 v5, 5, v4
    v_sub_u32 v2, v2, v5
    v_add_u32 v4, s31, v4
    v_bfe_u32 v5, v4, 5, 1
    v_mul_u32_u24 v5, 896, v5
    v_and_b32 v4, 0xdf, v4
    v_add_u32 v4, v4, v5
    v_mul_u32_u24 v4, 1280, v4
    v_lshl_add_u32 v2, v2, 7, v4
    s_and_b32 s33, s2, 1
    s_mul_i32 s33, s33, 640
    v_add_u32 v2, s33, v2
    buffer_load_dword v248, v2, s[16:19], 0 offen
    v_add_u32 v2, 245760, v2
    buffer_load_dword v248, v2, s[16:19], 0 offen
    v_add_u32 v2, 245760, v2
    buffer_load_dword v248, v2, s[16:19], 0 offen
    v_add_u32 v2, 245760, v2
    buffer_load_dword v248, v2, s[16:19], 0 offen
    v_add_u32 v2, 245760, v2
    buffer_load_dword v248, v2, s[16:19], 0 offen
    v_add_u32 v2, -942080, v2
    buffer_load_dword v248, v2, s[16:19], 0 offen
    v_add_u32 v2, 245760, v2
    buffer_load_dword v248, v2, s[16:19], 0 offen
    v_add_u32 v2, 245760, v2
    buffer_load_dword v248, v2, s[16:19], 0 offen
    v_add_u32 v2, 245760, v2
    buffer_load_dword v248, v2, s[16:19], 0 offen
    v_add_u32 v2, 245760, v2
    buffer_load_dword v248, v2, s[16:19], 0 offen
    v_add_u32 v2, 245760, v2
    s_waitcnt vmcnt(0)
    s_endpgm
g_end:
    s_endpgm
.section .rodata,"a"
.p2align 6
.amdhsa_kernel p0_kernel
  .amdhsa_next_free_vgpr 96
  .amdhsa_next_free_sgpr 102
  .amdhsa_accum_offset 96
  .amdhsa_group_segment_fixed_size 0
  .amdhsa_kernarg_size 104
  .amdhsa_user_sgpr_count 2
  .amdhsa_user_sgpr_kernarg_segment_ptr 1
  .amdhsa_system_sgpr_workgroup_id_x 1
.end_amdhsa_kernel
.p2align 6
.amdhsa_kernel conv_kernel
  .amdhsa_next_free_vgpr 256
  .amdhsa_next_free_sgpr 102
  .amdhsa_accum_offset 128
  .amdhsa_group_segment_fixed_size 0
  .amdhsa_kernarg_size 104
  .amdhsa_user_sgpr_count 2
  .amdhsa_user_sgpr_kernarg_segment_ptr 1
  .amdhsa_system_sgpr_workgroup_id_x 1
.end_amdhsa_kernel
.p2align 6
.amdhsa_kernel g12_kernel
  .amdhsa_next_free_vgpr 480
  .amdhsa_next_free_sgpr 102
  .amdhsa_accum_offset 256
  .amdhsa_group_segment_fixed_size 0
  .amdhsa_kernarg_size 104
  .amdhsa_user_sgpr_count 2
  .amdhsa_user_sgpr_kernarg_segment_ptr 1
  .amdhsa_system_sgpr_workgroup_id_x 1
.end_amdhsa_kernel
```
